```python
import torch

def _softmax(x, axis=-1):
    return torch.softmax(x, dim=axis)
def _gelu(x):
    return torch.nn.functional.gelu(x, approximate="tanh")
def _silu(x):
    return torch.nn.functional.silu(x)
def _sigmoid(x):
    return torch.sigmoid(x)
def _layernorm(x, axis=-1, eps=1e-5):
    m = x.mean(dim=axis, keepdim=True)
    v = x.var(dim=axis, keepdim=True, unbiased=False)
    return (x - m) / torch.sqrt(v + eps)
def _scatter_add(tgt, idx, src, axis=0):
    return tgt.clone().index_add_(axis, idx, src)
def _segment_sum(src, seg, n):
    out = torch.zeros((n,) + src.shape[1:], dtype=src.dtype)
    return out.index_add_(0, seg, src)
def _pad(x, pw):
    flat = tuple(v for pair in reversed(pw) for v in pair)
    return torch.nn.functional.pad(x, flat)

kernel_name = 'standalone__gqa_softmax__near_ridge'

def setup_inputs():

    _w = (lambda a: (lambda t: t.to(torch.bfloat16) if t.is_floating_point() else t)(torch.as_tensor(a)))
    B, Hq, Hkv, Sq, Sk, D = 8, 32, 8, 80, 1024, 128
    return {
        "q": _w((lambda *s: torch.randn(*s, dtype=torch.bfloat16) * 0.8)(B, Hq, Sq, D)),
        "k": _w((lambda *s: torch.randn(*s, dtype=torch.bfloat16) * 0.8)(B, Hkv, Sk, D)),
        "v": _w((lambda *s: torch.randn(*s, dtype=torch.bfloat16) * 0.05)(B, Hkv, Sk, D)),
    }

def reference(q, k, v):
    B, Hq, Sq, D = q.shape
    Hkv = k.shape[1]
    rep = Hq // Hkv
    k = (lambda x, n, axis: torch.repeat_interleave(x, n, dim=axis))(k, rep, axis=1)
    v = (lambda x, n, axis: torch.repeat_interleave(x, n, dim=axis))(v, rep, axis=1)
    scale = D ** -0.5
    scores = torch.einsum("bhqd,bhkd->bhqk", q, k) * scale
    p = _softmax(scores, axis=-1)
    return torch.einsum("bhqk,bhkd->bhqd", p, v)
```

```asm
; @launch grid=(256,1,1) block=(256,1,1) lds=163840
.amdgcn_target "amdgcn-amd-amdhsa--gfx950"
.text
.globl standalone__gqa_softmax__near_ridge_kernel
.p2align 8
.type standalone__gqa_softmax__near_ridge_kernel,@function
standalone__gqa_softmax__near_ridge_kernel:
    s_cmp_ge_u32 s2, 256
    s_cbranch_scc1 L_end
    s_load_dwordx8 s[4:11], s[0:1], 0
    s_and_b32 s33, s2, 7
    s_lshl_b32 s33, s33, 3
    s_lshr_b32 s34, s2, 5
    s_add_u32 s33, s33, s34
    s_lshr_b32 s34, s2, 3
    s_and_b32 s34, s34, 3
    s_lshl_b32 s35, s33, 2
    s_add_u32 s35, s35, s34
    s_mul_i32 s36, s35, 20480
    s_lshl_b32 s37, s33, 18
    v_and_b32 v1, 63, v0
    v_lshrrev_b32 v7, 6, v0
    v_lshrrev_b32 v2, 4, v1
    v_and_b32 v3, 15, v1
    v_readfirstlane_b32 s28, v7
    s_mov_b32 s30, 0x3e0293ee
    s_mov_b32 s31, 0x427af233
    s_mul_i32 s29, s28, 35840
    s_add_u32 s29, s29, 20480
    s_lshl_b32 s32, s28, 16
    v_add_u32 v4, 0, v2
    v_and_b32 v4, 15, v4
    v_xor_b32 v4, v3, v4
    v_lshlrev_b32 v4, 4, v4
    v_lshl_add_u32 v8, v2, 8, v4
    v_add_u32 v4, 4, v2
    v_and_b32 v4, 15, v4
    v_xor_b32 v4, v3, v4
    v_lshlrev_b32 v4, 4, v4
    v_lshl_add_u32 v9, v2, 8, v4
    v_add_u32 v4, 8, v2
    v_and_b32 v4, 15, v4
    v_xor_b32 v4, v3, v4
    v_lshlrev_b32 v4, 4, v4
    v_lshl_add_u32 v10, v2, 8, v4
    v_add_u32 v4, 12, v2
    v_and_b32 v4, 15, v4
    v_xor_b32 v4, v3, v4
    v_lshlrev_b32 v4, 4, v4
    v_lshl_add_u32 v11, v2, 8, v4
    v_add_u32 v4, 0, v2
    v_xor_b32 v4, v3, v4
    v_lshlrev_b32 v4, 4, v4
    v_lshl_add_u32 v188, v3, 8, v4
    v_add_u32 v12, s29, v188
    v_add_u32 v4, 4, v2
    v_xor_b32 v4, v3, v4
    v_lshlrev_b32 v4, 4, v4
    v_lshl_add_u32 v189, v3, 8, v4
    v_add_u32 v13, s29, v189
    v_add_u32 v4, 8, v2
    v_xor_b32 v4, v3, v4
    v_lshlrev_b32 v4, 4, v4
    v_lshl_add_u32 v190, v3, 8, v4
    v_add_u32 v14, s29, v190
    v_add_u32 v4, 12, v2
    v_xor_b32 v4, v3, v4
    v_lshlrev_b32 v4, 4, v4
    v_lshl_add_u32 v191, v3, 8, v4
    v_add_u32 v15, s29, v191
    v_lshrrev_b32 v4, 2, v3
    v_lshl_add_u32 v4, v2, 2, v4
    v_and_b32 v5, 3, v1
    v_lshlrev_b32 v6, 2, v5
    v_xor_b32 v6, v6, v4
    v_lshlrev_b32 v6, 4, v6
    v_lshl_add_u32 v6, v4, 8, v6
    v_and_b32 v5, 1, v5
    v_lshl_add_u32 v6, v5, 3, v6
    v_xor_b32 v5, 0, v6
    v_add_u32 v16, s29, v5
    v_xor_b32 v5, 8, v6
    v_add_u32 v17, s29, v5
    v_xor_b32 v5, 16, v6
    v_add_u32 v18, s29, v5
    v_xor_b32 v5, 24, v6
    v_add_u32 v19, s29, v5
    v_xor_b32 v5, 32, v6
    v_add_u32 v20, s29, v5
    v_xor_b32 v5, 40, v6
    v_add_u32 v21, s29, v5
    v_xor_b32 v5, 48, v6
    v_add_u32 v22, s29, v5
    v_xor_b32 v5, 56, v6
    v_add_u32 v23, s29, v5
    v_mov_b32 v24, 0x3f803f80
    v_mov_b32 v25, 0x3f803f80
    v_mov_b32 v26, 0x3f803f80
    v_mov_b32 v27, 0x3f803f80
    v_lshl_add_u32 v4, v7, 2, v2
    v_and_b32 v4, 15, v4
    v_xor_b32 v4, v3, v4
    v_lshlrev_b32 v4, 4, v4
    v_lshl_add_u32 v192, v2, 8, v4
    s_waitcnt lgkmcnt(0)
    s_add_u32 s12, s4, s36
    s_addc_u32 s13, s5, 0
    s_mov_b32 s14, 20480
    s_mov_b32 s15, 0x00020000
    s_add_u32 s16, s6, s37
    s_addc_u32 s17, s7, 0
    s_mov_b32 s18, 262144
    s_mov_b32 s19, 0x00020000
    s_add_u32 s20, s8, s37
    s_addc_u32 s21, s9, 0
    s_mov_b32 s22, 262144
    s_mov_b32 s23, 0x00020000
    s_add_u32 s24, s10, s36
    s_addc_u32 s25, s11, 0
    s_mov_b32 s26, 20480
    s_mov_b32 s27, 0x00020000
    s_lshl_b32 s33, s28, 10
    s_add_u32 s34, s33, 0
    s_mov_b32 m0, s34
    s_nop 0
    buffer_load_dwordx4 v192, s[12:15], s34 offen lds
    s_add_u32 s34, s33, 4096
    s_mov_b32 m0, s34
    s_nop 0
    buffer_load_dwordx4 v192, s[12:15], s34 offen lds
    s_add_u32 s34, s33, 8192
    s_mov_b32 m0, s34
    s_nop 0
    buffer_load_dwordx4 v192, s[12:15], s34 offen lds
    s_add_u32 s34, s33, 12288
    s_mov_b32 m0, s34
    s_nop 0
    buffer_load_dwordx4 v192, s[12:15], s34 offen lds
    s_add_u32 s34, s33, 16384
    s_mov_b32 m0, s34
    s_nop 0
    buffer_load_dwordx4 v192, s[12:15], s34 offen lds
    s_add_u32 s35, s32, 0
    s_add_u32 m0, s29, 0
    s_nop 0
    buffer_load_dwordx4 v8, s[16:19], s35 offen lds
    buffer_load_dwordx4 v9, s[16:19], s35 offen offset:1024 lds
    buffer_load_dwordx4 v10, s[16:19], s35 offen offset:2048 lds
    buffer_load_dwordx4 v11, s[16:19], s35 offen offset:3072 lds
    s_add_u32 s36, s32, 4096
    s_add_u32 m0, s29, 4096
    s_nop 0
    buffer_load_dwordx4 v8, s[16:19], s36 offen lds
    buffer_load_dwordx4 v9, s[16:19], s36 offen offset:1024 lds
    buffer_load_dwordx4 v10, s[16:19], s36 offen offset:2048 lds
    buffer_load_dwordx4 v11, s[16:19], s36 offen offset:3072 lds
    s_add_u32 s37, s32, 0
    s_add_u32 m0, s29, 8192
    s_nop 0
    buffer_load_dwordx4 v8, s[20:23], s37 offen lds
    buffer_load_dwordx4 v9, s[20:23], s37 offen offset:1024 lds
    buffer_load_dwordx4 v10, s[20:23], s37 offen offset:2048 lds
    buffer_load_dwordx4 v11, s[20:23], s37 offen offset:3072 lds
    s_add_u32 s38, s32, 4096
    s_add_u32 m0, s29, 12288
    s_nop 0
    buffer_load_dwordx4 v8, s[20:23], s38 offen lds
    buffer_load_dwordx4 v9, s[20:23], s38 offen offset:1024 lds
    buffer_load_dwordx4 v10, s[20:23], s38 offen offset:2048 lds
    buffer_load_dwordx4 v11, s[20:23], s38 offen offset:3072 lds
    s_add_u32 s39, s32, 8192
    s_add_u32 m0, s29, 16384
    s_nop 0
    buffer_load_dwordx4 v8, s[16:19], s39 offen lds
    buffer_load_dwordx4 v9, s[16:19], s39 offen offset:1024 lds
    buffer_load_dwordx4 v10, s[16:19], s39 offen offset:2048 lds
    buffer_load_dwordx4 v11, s[16:19], s39 offen offset:3072 lds
    s_add_u32 s40, s32, 12288
    s_add_u32 m0, s29, 20480
    s_nop 0
    buffer_load_dwordx4 v8, s[16:19], s40 offen lds
    buffer_load_dwordx4 v9, s[16:19], s40 offen offset:1024 lds
    buffer_load_dwordx4 v10, s[16:19], s40 offen offset:2048 lds
    buffer_load_dwordx4 v11, s[16:19], s40 offen offset:3072 lds
    s_add_u32 s35, s32, 8192
    s_add_u32 m0, s29, 24576
    s_nop 0
    buffer_load_dwordx4 v8, s[20:23], s35 offen lds
    buffer_load_dwordx4 v9, s[20:23], s35 offen offset:1024 lds
    buffer_load_dwordx4 v10, s[20:23], s35 offen offset:2048 lds
    buffer_load_dwordx4 v11, s[20:23], s35 offen offset:3072 lds
    s_add_u32 s36, s32, 12288
    s_add_u32 m0, s29, 28672
    s_nop 0
    buffer_load_dwordx4 v8, s[20:23], s36 offen lds
    buffer_load_dwordx4 v9, s[20:23], s36 offen offset:1024 lds
    buffer_load_dwordx4 v10, s[20:23], s36 offen offset:2048 lds
    buffer_load_dwordx4 v11, s[20:23], s36 offen offset:3072 lds
    s_waitcnt vmcnt(32)
    s_barrier
    ds_read_b128 a[160:163], v188
    ds_read_b128 a[164:167], v189
    ds_read_b128 a[168:171], v190
    ds_read_b128 a[172:175], v191
    ds_read_b128 a[176:179], v188 offset:4096
    ds_read_b128 a[180:183], v189 offset:4096
    ds_read_b128 a[184:187], v190 offset:4096
    ds_read_b128 a[188:191], v191 offset:4096
    ds_read_b128 a[192:195], v188 offset:8192
    ds_read_b128 a[196:199], v189 offset:8192
    ds_read_b128 a[200:203], v190 offset:8192
    ds_read_b128 a[204:207], v191 offset:8192
    ds_read_b128 a[208:211], v188 offset:12288
    ds_read_b128 a[212:215], v189 offset:12288
    ds_read_b128 a[216:219], v190 offset:12288
    s_waitcnt lgkmcnt(14)
    ds_read_b128 a[220:223], v191 offset:12288
    s_waitcnt lgkmcnt(14)
    ds_read_b128 a[224:227], v188 offset:16384
    s_waitcnt lgkmcnt(14)
    ds_read_b128 a[228:231], v189 offset:16384
    s_waitcnt lgkmcnt(14)
    ds_read_b128 a[232:235], v190 offset:16384
    s_waitcnt lgkmcnt(14)
    ds_read_b128 a[236:239], v191 offset:16384
    s_waitcnt vmcnt(28) lgkmcnt(14)
    ds_read_b128 v[156:159], v12
    s_waitcnt lgkmcnt(14)
    ds_read_b128 v[160:163], v13
    s_waitcnt lgkmcnt(14)
    ds_read_b128 v[164:167], v14
    s_waitcnt lgkmcnt(14)
    ds_read_b128 v[168:171], v15
    s_waitcnt vmcnt(20) lgkmcnt(14)
    ds_read_b64_tr_b16 v[172:173], v16 offset:8192
    s_waitcnt vmcnt(16) lgkmcnt(14)
    ds_read_b64_tr_b16 v[174:175], v16 offset:12288
    s_waitcnt lgkmcnt(14)
    ds_read_b64_tr_b16 v[176:177], v17 offset:8192
    s_waitcnt lgkmcnt(14)
    ds_read_b64_tr_b16 v[178:179], v17 offset:12288
    s_waitcnt lgkmcnt(14)
    ds_read_b64_tr_b16 v[180:181], v18 offset:8192
    s_waitcnt lgkmcnt(14)
    ds_read_b64_tr_b16 v[182:183], v18 offset:12288
    s_waitcnt lgkmcnt(14)
    ds_read_b64_tr_b16 v[184:185], v19 offset:8192
    s_waitcnt lgkmcnt(14)
    ds_read_b64_tr_b16 v[186:187], v19 offset:12288
    s_add_u32 s35, s32, 16384
    s_add_u32 m0, s29, 0
    s_add_u32 s36, s32, 20480
    s_waitcnt lgkmcnt(8)
    buffer_load_dwordx4 v8, s[16:19], s35 offen lds
    v_mfma_f32_16x16x32_bf16 v[76:79], v[156:159], a[160:163], 0
    buffer_load_dwordx4 v9, s[16:19], s35 offen offset:1024 lds
    v_mfma_f32_16x16x32_bf16 v[84:87], v[156:159], a[176:179], 0
    buffer_load_dwordx4 v10, s[16:19], s35 offen offset:2048 lds
    v_mfma_f32_16x16x32_bf16 v[92:95], v[156:159], a[192:195], 0
    buffer_load_dwordx4 v11, s[16:19], s35 offen offset:3072 lds
    v_mfma_f32_16x16x32_bf16 v[100:103], v[156:159], a[208:211], 0
    s_add_u32 m0, s29, 4096
    s_add_u32 s39, s32, 24576
    v_mfma_f32_16x16x32_bf16 v[108:111], v[156:159], a[224:227], 0
    ds_read_b128 v[156:159], v12 offset:4096
    v_mfma_f32_16x16x32_bf16 v[76:79], v[160:163], a[164:167], v[76:79]
    v_mfma_f32_16x16x32_bf16 v[84:87], v[160:163], a[180:183], v[84:87]
    v_mfma_f32_16x16x32_bf16 v[92:95], v[160:163], a[196:199], v[92:95]
    v_mfma_f32_16x16x32_bf16 v[100:103], v[160:163], a[212:215], v[100:103]
    v_mfma_f32_16x16x32_bf16 v[108:111], v[160:163], a[228:231], v[108:111]
    ds_read_b128 v[160:163], v13 offset:4096
    v_mfma_f32_16x16x32_bf16 v[76:79], v[164:167], a[168:171], v[76:79]
    v_mfma_f32_16x16x32_bf16 v[84:87], v[164:167], a[184:187], v[84:87]
    v_mfma_f32_16x16x32_bf16 v[92:95], v[164:167], a[200:203], v[92:95]
    v_mfma_f32_16x16x32_bf16 v[100:103], v[164:167], a[216:219], v[100:103]
    v_mfma_f32_16x16x32_bf16 v[108:111], v[164:167], a[232:235], v[108:111]
    ds_read_b128 v[164:167], v14 offset:4096
    v_mfma_f32_16x16x32_bf16 v[76:79], v[168:171], a[172:175], v[76:79]
    v_mfma_f32_16x16x32_bf16 v[84:87], v[168:171], a[188:191], v[84:87]
    v_mfma_f32_16x16x32_bf16 v[92:95], v[168:171], a[204:207], v[92:95]
    v_mfma_f32_16x16x32_bf16 v[100:103], v[168:171], a[220:223], v[100:103]
    v_mfma_f32_16x16x32_bf16 v[108:111], v[168:171], a[236:239], v[108:111]
    ds_read_b128 v[168:171], v15 offset:4096
    s_waitcnt lgkmcnt(3)
    v_mfma_f32_16x16x32_bf16 v[80:83], v[156:159], a[160:163], 0
    s_waitcnt lgkmcnt(0)
    buffer_load_dwordx4 v8, s[16:19], s36 offen lds
    v_mfma_f32_16x16x32_bf16 v[88:91], v[156:159], a[176:179], 0
    buffer_load_dwordx4 v9, s[16:19], s36 offen offset:1024 lds
    v_mfma_f32_16x16x32_bf16 v[96:99], v[156:159], a[192:195], 0
    buffer_load_dwordx4 v10, s[16:19], s36 offen offset:2048 lds
    v_mfma_f32_16x16x32_bf16 v[104:107], v[156:159], a[208:211], 0
    buffer_load_dwordx4 v11, s[16:19], s36 offen offset:3072 lds
    v_mfma_f32_16x16x32_bf16 v[112:115], v[156:159], a[224:227], 0
    s_waitcnt vmcnt(20)
    ds_read_b128 v[156:159], v12 offset:16384
    v_mfma_f32_16x16x32_bf16 v[80:83], v[160:163], a[164:167], v[80:83]
    v_max3_f32 v63, v76, v77, v78
    v_max3_f32 v64, v84, v85, v86
    v_mfma_f32_16x16x32_bf16 v[88:91], v[160:163], a[180:183], v[88:91]
    v_max3_f32 v65, v92, v93, v94
    v_max3_f32 v66, v100, v101, v102
    v_mfma_f32_16x16x32_bf16 v[96:99], v[160:163], a[196:199], v[96:99]
    v_max3_f32 v67, v108, v109, v110
    s_add_u32 m0, s29, 16384
    s_add_u32 s40, s32, 28672
    v_mfma_f32_16x16x32_bf16 v[104:107], v[160:163], a[212:215], v[104:107]
    v_mfma_f32_16x16x32_bf16 v[112:115], v[160:163], a[228:231], v[112:115]
    ds_read_b128 v[160:163], v13 offset:16384
    v_mfma_f32_16x16x32_bf16 v[80:83], v[164:167], a[168:171], v[80:83]
    v_mfma_f32_16x16x32_bf16 v[88:91], v[164:167], a[184:187], v[88:91]
    v_mfma_f32_16x16x32_bf16 v[96:99], v[164:167], a[200:203], v[96:99]
    v_mfma_f32_16x16x32_bf16 v[104:107], v[164:167], a[216:219], v[104:107]
    v_mfma_f32_16x16x32_bf16 v[112:115], v[164:167], a[232:235], v[112:115]
    ds_read_b128 v[164:167], v14 offset:16384
    v_mfma_f32_16x16x32_bf16 v[80:83], v[168:171], a[172:175], v[80:83]
    v_mfma_f32_16x16x32_bf16 v[88:91], v[168:171], a[188:191], v[88:91]
    v_mfma_f32_16x16x32_bf16 v[96:99], v[168:171], a[204:207], v[96:99]
    v_mfma_f32_16x16x32_bf16 v[104:107], v[168:171], a[220:223], v[104:107]
    v_mfma_f32_16x16x32_bf16 v[112:115], v[168:171], a[236:239], v[112:115]
    ds_read_b128 v[168:171], v15 offset:16384
    s_waitcnt lgkmcnt(3)
    v_mfma_f32_16x16x32_bf16 v[116:119], v[156:159], a[160:163], 0
    s_waitcnt lgkmcnt(0)
    buffer_load_dwordx4 v8, s[16:19], s39 offen lds
    v_mfma_f32_16x16x32_bf16 v[124:127], v[156:159], a[176:179], 0
    buffer_load_dwordx4 v9, s[16:19], s39 offen offset:1024 lds
    v_mfma_f32_16x16x32_bf16 v[132:135], v[156:159], a[192:195], 0
    buffer_load_dwordx4 v10, s[16:19], s39 offen offset:2048 lds
    v_mfma_f32_16x16x32_bf16 v[140:143], v[156:159], a[208:211], 0
    buffer_load_dwordx4 v11, s[16:19], s39 offen offset:3072 lds
    v_mfma_f32_16x16x32_bf16 v[148:151], v[156:159], a[224:227], 0
    s_waitcnt vmcnt(20)
    ds_read_b128 v[156:159], v12 offset:20480
    v_mfma_f32_16x16x32_bf16 v[116:119], v[160:163], a[164:167], v[116:119]
    v_max3_f32 v63, v63, v79, v80
    v_max3_f32 v63, v63, v81, v82
    v_mfma_f32_16x16x32_bf16 v[124:127], v[160:163], a[180:183], v[124:127]
    v_max_f32 v63, v63, v83
    v_max3_f32 v64, v64, v87, v88
    v_mfma_f32_16x16x32_bf16 v[132:135], v[160:163], a[196:199], v[132:135]
    v_max3_f32 v64, v64, v89, v90
    v_max_f32 v64, v64, v91
    v_mfma_f32_16x16x32_bf16 v[140:143], v[160:163], a[212:215], v[140:143]
    v_max3_f32 v65, v65, v95, v96
    v_max3_f32 v65, v65, v97, v98
    v_mfma_f32_16x16x32_bf16 v[148:151], v[160:163], a[228:231], v[148:151]
    ds_read_b128 v[160:163], v13 offset:20480
    v_mfma_f32_16x16x32_bf16 v[116:119], v[164:167], a[168:171], v[116:119]
    v_max_f32 v65, v65, v99
    v_max3_f32 v66, v66, v103, v104
    v_mfma_f32_16x16x32_bf16 v[124:127], v[164:167], a[184:187], v[124:127]
    v_max3_f32 v66, v66, v105, v106
    v_max_f32 v66, v66, v107
    v_mfma_f32_16x16x32_bf16 v[132:135], v[164:167], a[200:203], v[132:135]
    v_max3_f32 v67, v67, v111, v112
    v_max3_f32 v67, v67, v113, v114
    v_mfma_f32_16x16x32_bf16 v[140:143], v[164:167], a[216:219], v[140:143]
    v_max_f32 v67, v67, v115
    v_mov_b32 v68, v63
    v_mfma_f32_16x16x32_bf16 v[148:151], v[164:167], a[232:235], v[148:151]
    ds_read_b128 v[164:167], v14 offset:20480
    v_mfma_f32_16x16x32_bf16 v[116:119], v[168:171], a[172:175], v[116:119]
    v_mov_b32 v69, v63
    s_add_u32 m0, s29, 20480
    s_add_u32 s37, s32, 16384
    v_mfma_f32_16x16x32_bf16 v[124:127], v[168:171], a[188:191], v[124:127]
    v_permlane32_swap_b32 v68, v69
    v_mfma_f32_16x16x32_bf16 v[132:135], v[168:171], a[204:207], v[132:135]
    v_max_f32 v68, v68, v69
    v_mov_b32 v69, v68
    v_mfma_f32_16x16x32_bf16 v[140:143], v[168:171], a[220:223], v[140:143]
    v_max3_f32 v63, v116, v117, v118
    v_permlane16_swap_b32 v68, v69
    v_mfma_f32_16x16x32_bf16 v[148:151], v[168:171], a[236:239], v[148:151]
    ds_read_b128 v[168:171], v15 offset:20480
    s_waitcnt lgkmcnt(3)
    v_mfma_f32_16x16x32_bf16 v[120:123], v[156:159], a[160:163], 0
    s_waitcnt lgkmcnt(0)
    buffer_load_dwordx4 v8, s[16:19], s40 offen lds
    v_mfma_f32_16x16x32_bf16 v[128:131], v[156:159], a[176:179], 0
    buffer_load_dwordx4 v9, s[16:19], s40 offen offset:1024 lds
    v_mfma_f32_16x16x32_bf16 v[136:139], v[156:159], a[192:195], 0
    buffer_load_dwordx4 v10, s[16:19], s40 offen offset:2048 lds
    v_mfma_f32_16x16x32_bf16 v[144:147], v[156:159], a[208:211], 0
    buffer_load_dwordx4 v11, s[16:19], s40 offen offset:3072 lds
    v_mfma_f32_16x16x32_bf16 v[152:155], v[156:159], a[224:227], 0
    s_waitcnt vmcnt(12)
    ds_read_b128 v[156:159], v12
    v_mfma_f32_16x16x32_bf16 v[120:123], v[160:163], a[164:167], v[120:123]
    v_max_f32 v48, v68, v69
    v_mul_f32 v53, s30, v48
    v_mfma_f32_16x16x32_bf16 v[128:131], v[160:163], a[180:183], v[128:131]
    v_sub_f32 v53, 0, v53
    v_add_f32 v58, s31, v48
    v_mfma_f32_16x16x32_bf16 v[136:139], v[160:163], a[196:199], v[136:139]
    v_mov_b32 v68, v64
    v_mov_b32 v69, v64
    v_mfma_f32_16x16x32_bf16 v[144:147], v[160:163], a[212:215], v[144:147]
    v_fma_f32 v76, v76, s30, v53
    v_permlane32_swap_b32 v68, v69
    v_mfma_f32_16x16x32_bf16 v[152:155], v[160:163], a[228:231], v[152:155]
    ds_read_b128 v[160:163], v13
    v_mfma_f32_16x16x32_bf16 v[120:123], v[164:167], a[168:171], v[120:123]
    v_max_f32 v68, v68, v69
    v_mov_b32 v69, v68
    v_mfma_f32_16x16x32_bf16 v[128:131], v[164:167], a[184:187], v[128:131]
    v_exp_f32 v76, v76
    v_mfma_f32_16x16x32_bf16 v[136:139], v[164:167], a[200:203], v[136:139]
    v_permlane16_swap_b32 v68, v69
    v_mfma_f32_16x16x32_bf16 v[144:147], v[164:167], a[216:219], v[144:147]
    v_max_f32 v49, v68, v69
    v_mul_f32 v54, s30, v49
    v_mfma_f32_16x16x32_bf16 v[152:155], v[164:167], a[232:235], v[152:155]
    ds_read_b128 v[164:167], v14
    v_mfma_f32_16x16x32_bf16 v[120:123], v[168:171], a[172:175], v[120:123]
    v_sub_f32 v54, 0, v54
    v_add_f32 v59, s31, v49
    v_mfma_f32_16x16x32_bf16 v[128:131], v[168:171], a[188:191], v[128:131]
    v_mov_b32 v68, v65
    v_mov_b32 v69, v65
    v_mfma_f32_16x16x32_bf16 v[136:139], v[168:171], a[204:207], v[136:139]
    v_fma_f32 v77, v77, s30, v53
    v_permlane32_swap_b32 v68, v69
    v_mfma_f32_16x16x32_bf16 v[144:147], v[168:171], a[220:223], v[144:147]
    v_max_f32 v68, v68, v69
    v_mov_b32 v69, v68
    v_mfma_f32_16x16x32_bf16 v[152:155], v[168:171], a[236:239], v[152:155]
    ds_read_b128 v[168:171], v15
    v_permlane16_swap_b32 v68, v69
    v_max_f32 v50, v68, v69
    v_mul_f32 v55, s30, v50
    v_sub_f32 v55, 0, v55
    v_add_f32 v60, s31, v50
    v_mov_b32 v68, v66
    v_mov_b32 v69, v66
    v_exp_f32 v77, v77
    v_fma_f32 v78, v78, s30, v53
    v_permlane32_swap_b32 v68, v69
    v_max_f32 v68, v68, v69
    v_mov_b32 v69, v68
    v_exp_f32 v78, v78
    v_fma_f32 v79, v79, s30, v53
    v_permlane16_swap_b32 v68, v69
    v_max_f32 v51, v68, v69
    v_mul_f32 v56, s30, v51
    v_sub_f32 v56, 0, v56
    v_add_f32 v61, s31, v51
    v_mov_b32 v68, v67
    v_mov_b32 v69, v67
    v_exp_f32 v79, v79
    v_fma_f32 v80, v80, s30, v53
    v_permlane32_swap_b32 v68, v69
    v_max_f32 v68, v68, v69
    v_mov_b32 v69, v68
    v_exp_f32 v80, v80
    v_fma_f32 v81, v81, s30, v53
    v_permlane16_swap_b32 v68, v69
    v_max_f32 v52, v68, v69
    v_mul_f32 v57, s30, v52
    v_sub_f32 v57, 0, v57
    v_add_f32 v62, s31, v52
    v_exp_f32 v81, v81
    v_fma_f32 v82, v82, s30, v53
    v_exp_f32 v82, v82
    v_fma_f32 v83, v83, s30, v53
    v_exp_f32 v83, v83
    v_cvt_pk_bf16_f32 v76, v76, v77
    v_cvt_pk_bf16_f32 v77, v78, v79
    v_cvt_pk_bf16_f32 v78, v80, v81
    v_cvt_pk_bf16_f32 v79, v82, v83
    v_fma_f32 v84, v84, s30, v54
    v_exp_f32 v84, v84
    v_mfma_f32_16x16x32_bf16 a[0:3], v[172:175], v[76:79], 0
    v_fma_f32 v85, v85, s30, v54
    v_exp_f32 v85, v85
    v_mfma_f32_16x16x32_bf16 a[4:7], v[176:179], v[76:79], 0
    v_fma_f32 v86, v86, s30, v54
    v_exp_f32 v86, v86
    v_mfma_f32_16x16x32_bf16 a[8:11], v[180:183], v[76:79], 0
    v_fma_f32 v87, v87, s30, v54
    v_exp_f32 v87, v87
    v_mfma_f32_16x16x32_bf16 a[12:15], v[184:187], v[76:79], 0
    v_fma_f32 v88, v88, s30, v54
    v_exp_f32 v88, v88
    v_mfma_f32_16x16x32_bf16 v[28:31], v[24:27], v[76:79], 0
    v_fma_f32 v89, v89, s30, v54
    v_exp_f32 v89, v89
    v_fma_f32 v90, v90, s30, v54
    v_exp_f32 v90, v90
    v_fma_f32 v91, v91, s30, v54
    v_exp_f32 v91, v91
    v_cvt_pk_bf16_f32 v84, v84, v85
    v_cvt_pk_bf16_f32 v85, v86, v87
    v_cvt_pk_bf16_f32 v86, v88, v89
    v_cvt_pk_bf16_f32 v87, v90, v91
    v_fma_f32 v92, v92, s30, v55
    v_exp_f32 v92, v92
    v_mfma_f32_16x16x32_bf16 a[32:35], v[172:175], v[84:87], 0
    v_fma_f32 v93, v93, s30, v55
    v_exp_f32 v93, v93
    v_mfma_f32_16x16x32_bf16 a[36:39], v[176:179], v[84:87], 0
    v_fma_f32 v94, v94, s30, v55
    v_exp_f32 v94, v94
    v_mfma_f32_16x16x32_bf16 a[40:43], v[180:183], v[84:87], 0
    v_fma_f32 v95, v95, s30, v55
    v_exp_f32 v95, v95
    v_mfma_f32_16x16x32_bf16 a[44:47], v[184:187], v[84:87], 0
    v_fma_f32 v96, v96, s30, v55
    v_exp_f32 v96, v96
    v_mfma_f32_16x16x32_bf16 v[32:35], v[24:27], v[84:87], 0
    v_fma_f32 v97, v97, s30, v55
    v_exp_f32 v97, v97
    v_fma_f32 v98, v98, s30, v55
    v_exp_f32 v98, v98
    v_fma_f32 v99, v99, s30, v55
    v_exp_f32 v99, v99
    v_cvt_pk_bf16_f32 v92, v92, v93
    v_cvt_pk_bf16_f32 v93, v94, v95
    v_cvt_pk_bf16_f32 v94, v96, v97
    v_cvt_pk_bf16_f32 v95, v98, v99
    v_fma_f32 v100, v100, s30, v56
    v_exp_f32 v100, v100
    v_mfma_f32_16x16x32_bf16 a[64:67], v[172:175], v[92:95], 0
    v_fma_f32 v101, v101, s30, v56
    v_exp_f32 v101, v101
    v_mfma_f32_16x16x32_bf16 a[68:71], v[176:179], v[92:95], 0
    v_fma_f32 v102, v102, s30, v56
    v_exp_f32 v102, v102
    v_mfma_f32_16x16x32_bf16 a[72:75], v[180:183], v[92:95], 0
    v_fma_f32 v103, v103, s30, v56
    v_exp_f32 v103, v103
    v_mfma_f32_16x16x32_bf16 a[76:79], v[184:187], v[92:95], 0
    v_fma_f32 v104, v104, s30, v56
    v_exp_f32 v104, v104
    v_mfma_f32_16x16x32_bf16 v[36:39], v[24:27], v[92:95], 0
    v_fma_f32 v105, v105, s30, v56
    v_exp_f32 v105, v105
    v_fma_f32 v106, v106, s30, v56
    v_exp_f32 v106, v106
    v_fma_f32 v107, v107, s30, v56
    v_exp_f32 v107, v107
    v_cvt_pk_bf16_f32 v100, v100, v101
    v_cvt_pk_bf16_f32 v101, v102, v103
    v_cvt_pk_bf16_f32 v102, v104, v105
    v_cvt_pk_bf16_f32 v103, v106, v107
    v_fma_f32 v108, v108, s30, v57
    v_exp_f32 v108, v108
    v_mfma_f32_16x16x32_bf16 a[96:99], v[172:175], v[100:103], 0
    v_fma_f32 v109, v109, s30, v57
    v_exp_f32 v109, v109
    v_mfma_f32_16x16x32_bf16 a[100:103], v[176:179], v[100:103], 0
    v_fma_f32 v110, v110, s30, v57
    v_exp_f32 v110, v110
    v_mfma_f32_16x16x32_bf16 a[104:107], v[180:183], v[100:103], 0
    v_fma_f32 v111, v111, s30, v57
    v_exp_f32 v111, v111
    v_mfma_f32_16x16x32_bf16 a[108:111], v[184:187], v[100:103], 0
    v_fma_f32 v112, v112, s30, v57
    v_exp_f32 v112, v112
    v_mfma_f32_16x16x32_bf16 v[40:43], v[24:27], v[100:103], 0
    v_fma_f32 v113, v113, s30, v57
    v_exp_f32 v113, v113
    v_fma_f32 v114, v114, s30, v57
    v_exp_f32 v114, v114
    v_fma_f32 v115, v115, s30, v57
    v_exp_f32 v115, v115
    v_cvt_pk_bf16_f32 v108, v108, v109
    v_cvt_pk_bf16_f32 v109, v110, v111
    v_cvt_pk_bf16_f32 v110, v112, v113
    v_cvt_pk_bf16_f32 v111, v114, v115
    s_add_u32 m0, s29, 8192
    s_add_u32 s38, s32, 20480
    v_mfma_f32_16x16x32_bf16 a[128:131], v[172:175], v[108:111], 0
    ds_read_b64_tr_b16 v[172:173], v20 offset:8192
    v_mfma_f32_16x16x32_bf16 a[132:135], v[176:179], v[108:111], 0
    ds_read_b64_tr_b16 v[174:175], v20 offset:12288
    v_mfma_f32_16x16x32_bf16 a[136:139], v[180:183], v[108:111], 0
    ds_read_b64_tr_b16 v[176:177], v21 offset:8192
    v_mfma_f32_16x16x32_bf16 a[140:143], v[184:187], v[108:111], 0
    ds_read_b64_tr_b16 v[178:179], v21 offset:12288
    v_mfma_f32_16x16x32_bf16 v[44:47], v[24:27], v[108:111], 0
    ds_read_b64_tr_b16 v[180:181], v22 offset:8192
    ds_read_b64_tr_b16 v[182:183], v22 offset:12288
    ds_read_b64_tr_b16 v[184:185], v23 offset:8192
    ds_read_b64_tr_b16 v[186:187], v23 offset:12288
    s_waitcnt lgkmcnt(1)
    buffer_load_dwordx4 v8, s[20:23], s37 offen lds
    buffer_load_dwordx4 v9, s[20:23], s37 offen offset:1024 lds
    buffer_load_dwordx4 v10, s[20:23], s37 offen offset:2048 lds
    buffer_load_dwordx4 v11, s[20:23], s37 offen offset:3072 lds
    v_mfma_f32_16x16x32_bf16 a[16:19], v[172:175], v[76:79], 0
    s_add_u32 m0, s29, 12288
    v_max3_f32 v63, v63, v119, v120
    s_waitcnt lgkmcnt(0)
    buffer_load_dwordx4 v8, s[20:23], s38 offen lds
    v_mfma_f32_16x16x32_bf16 a[48:51], v[172:175], v[84:87], 0
    buffer_load_dwordx4 v9, s[20:23], s38 offen offset:1024 lds
    v_mfma_f32_16x16x32_bf16 a[80:83], v[172:175], v[92:95], 0
    buffer_load_dwordx4 v10, s[20:23], s38 offen offset:2048 lds
    v_mfma_f32_16x16x32_bf16 a[112:115], v[172:175], v[100:103], 0
    buffer_load_dwordx4 v11, s[20:23], s38 offen offset:3072 lds
    v_mfma_f32_16x16x32_bf16 a[144:147], v[172:175], v[108:111], 0
    ds_read_b64_tr_b16 v[172:173], v16 offset:24576
    v_mfma_f32_16x16x32_bf16 a[20:23], v[176:179], v[76:79], 0
    ds_read_b64_tr_b16 v[174:175], v16 offset:28672
    v_mfma_f32_16x16x32_bf16 a[52:55], v[176:179], v[84:87], 0
    v_max3_f32 v63, v63, v121, v122
    v_max_f32 v63, v63, v123
    v_mfma_f32_16x16x32_bf16 a[84:87], v[176:179], v[92:95], 0
    v_max3_f32 v64, v124, v125, v126
    v_max3_f32 v64, v64, v127, v128
    v_mfma_f32_16x16x32_bf16 a[116:119], v[176:179], v[100:103], 0
    v_max3_f32 v64, v64, v129, v130
    v_max_f32 v64, v64, v131
    v_mfma_f32_16x16x32_bf16 a[148:151], v[176:179], v[108:111], 0
    ds_read_b64_tr_b16 v[176:177], v17 offset:24576
    v_mfma_f32_16x16x32_bf16 a[24:27], v[180:183], v[76:79], 0
    ds_read_b64_tr_b16 v[178:179], v17 offset:28672
    v_mfma_f32_16x16x32_bf16 a[56:59], v[180:183], v[84:87], 0
    v_max3_f32 v65, v132, v133, v134
    v_max3_f32 v65, v65, v135, v136
    v_mfma_f32_16x16x32_bf16 a[88:91], v[180:183], v[92:95], 0
    v_max3_f32 v65, v65, v137, v138
    v_max_f32 v65, v65, v139
    v_mfma_f32_16x16x32_bf16 a[120:123], v[180:183], v[100:103], 0
    v_max3_f32 v66, v140, v141, v142
    v_max3_f32 v66, v66, v143, v144
    v_mfma_f32_16x16x32_bf16 a[152:155], v[180:183], v[108:111], 0
    ds_read_b64_tr_b16 v[180:181], v18 offset:24576
    v_mfma_f32_16x16x32_bf16 a[28:31], v[184:187], v[76:79], 0
    ds_read_b64_tr_b16 v[182:183], v18 offset:28672
    v_mfma_f32_16x16x32_bf16 a[60:63], v[184:187], v[84:87], 0
    v_max3_f32 v66, v66, v145, v146
    v_max_f32 v66, v66, v147
    v_mfma_f32_16x16x32_bf16 a[92:95], v[184:187], v[92:95], 0
    v_max3_f32 v67, v148, v149, v150
    v_max3_f32 v67, v67, v151, v152
    v_mfma_f32_16x16x32_bf16 a[124:127], v[184:187], v[100:103], 0
    v_max3_f32 v67, v67, v153, v154
    v_max_f32 v67, v67, v155
    v_mfma_f32_16x16x32_bf16 a[156:159], v[184:187], v[108:111], 0
    ds_read_b64_tr_b16 v[184:185], v19 offset:24576
    v_mfma_f32_16x16x32_bf16 v[76:79], v[156:159], a[160:163], 0
    ds_read_b64_tr_b16 v[186:187], v19 offset:28672
    v_mfma_f32_16x16x32_bf16 v[84:87], v[156:159], a[176:179], 0
    v_cmp_gt_f32 s[44:45], v63, v58
    v_cmp_gt_f32 s[46:47], v64, v59
    v_mfma_f32_16x16x32_bf16 v[92:95], v[156:159], a[192:195], 0
    v_cmp_gt_f32 s[48:49], v65, v60
    v_cmp_gt_f32 s[50:51], v66, v61
    v_mfma_f32_16x16x32_bf16 v[100:103], v[156:159], a[208:211], 0
    v_cmp_gt_f32 s[52:53], v67, v62
    s_or_b64 s[44:45], s[44:45], s[46:47]
    s_or_b64 s[44:45], s[44:45], s[48:49]
    v_mfma_f32_16x16x32_bf16 v[108:111], v[156:159], a[224:227], 0
    s_waitcnt vmcnt(16)
    ds_read_b128 v[156:159], v12 offset:4096
    v_mfma_f32_16x16x32_bf16 v[76:79], v[160:163], a[164:167], v[76:79]
    s_or_b64 s[44:45], s[44:45], s[50:51]
    s_or_b64 s[44:45], s[44:45], s[52:53]
    s_cbranch_scc1 L_slow1
L_ret1:
    v_mfma_f32_16x16x32_bf16 v[84:87], v[160:163], a[180:183], v[84:87]
    v_fma_f32 v116, v116, s30, v53
    v_exp_f32 v116, v116
    v_mfma_f32_16x16x32_bf16 v[92:95], v[160:163], a[196:199], v[92:95]
    v_fma_f32 v117, v117, s30, v53
    v_exp_f32 v117, v117
    v_mfma_f32_16x16x32_bf16 v[100:103], v[160:163], a[212:215], v[100:103]
    v_fma_f32 v118, v118, s30, v53
    v_exp_f32 v118, v118
    v_mfma_f32_16x16x32_bf16 v[108:111], v[160:163], a[228:231], v[108:111]
    ds_read_b128 v[160:163], v13 offset:4096
    v_mfma_f32_16x16x32_bf16 v[76:79], v[164:167], a[168:171], v[76:79]
    v_fma_f32 v119, v119, s30, v53
    v_exp_f32 v119, v119
    v_mfma_f32_16x16x32_bf16 v[84:87], v[164:167], a[184:187], v[84:87]
    v_fma_f32 v120, v120, s30, v53
    v_exp_f32 v120, v120
    v_mfma_f32_16x16x32_bf16 v[92:95], v[164:167], a[200:203], v[92:95]
    v_fma_f32 v121, v121, s30, v53
    v_exp_f32 v121, v121
    v_mfma_f32_16x16x32_bf16 v[100:103], v[164:167], a[216:219], v[100:103]
    v_fma_f32 v122, v122, s30, v53
    v_exp_f32 v122, v122
    v_mfma_f32_16x16x32_bf16 v[108:111], v[164:167], a[232:235], v[108:111]
    ds_read_b128 v[164:167], v14 offset:4096
    v_mfma_f32_16x16x32_bf16 v[76:79], v[168:171], a[172:175], v[76:79]
    v_fma_f32 v123, v123, s30, v53
    v_exp_f32 v123, v123
    v_mfma_f32_16x16x32_bf16 v[84:87], v[168:171], a[188:191], v[84:87]
    v_cvt_pk_bf16_f32 v116, v116, v117
    v_cvt_pk_bf16_f32 v117, v118, v119
    v_mfma_f32_16x16x32_bf16 v[92:95], v[168:171], a[204:207], v[92:95]
    v_cvt_pk_bf16_f32 v118, v120, v121
    v_cvt_pk_bf16_f32 v119, v122, v123
    v_mfma_f32_16x16x32_bf16 v[100:103], v[168:171], a[220:223], v[100:103]
    v_fma_f32 v124, v124, s30, v54
    v_exp_f32 v124, v124
    v_mfma_f32_16x16x32_bf16 v[108:111], v[168:171], a[236:239], v[108:111]
    ds_read_b128 v[168:171], v15 offset:4096
    s_waitcnt lgkmcnt(3)
    v_mfma_f32_16x16x32_bf16 v[80:83], v[156:159], a[160:163], 0
    v_fma_f32 v125, v125, s30, v54
    v_exp_f32 v125, v125
    v_mfma_f32_16x16x32_bf16 v[88:91], v[156:159], a[176:179], 0
    v_fma_f32 v126, v126, s30, v54
    v_exp_f32 v126, v126
    v_mfma_f32_16x16x32_bf16 v[96:99], v[156:159], a[192:195], 0
    v_fma_f32 v127, v127, s30, v54
    v_exp_f32 v127, v127
    v_mfma_f32_16x16x32_bf16 v[104:107], v[156:159], a[208:211], 0
    v_fma_f32 v128, v128, s30, v54
    v_exp_f32 v128, v128
    v_mfma_f32_16x16x32_bf16 v[112:115], v[156:159], a[224:227], 0
    s_waitcnt vmcnt(12)
    ds_read_b128 v[156:159], v12 offset:16384
    s_waitcnt lgkmcnt(3)
    v_mfma_f32_16x16x32_bf16 v[80:83], v[160:163], a[164:167], v[80:83]
    v_fma_f32 v129, v129, s30, v54
    v_exp_f32 v129, v129
    v_mfma_f32_16x16x32_bf16 v[88:91], v[160:163], a[180:183], v[88:91]
    v_fma_f32 v130, v130, s30, v54
    v_exp_f32 v130, v130
    v_mfma_f32_16x16x32_bf16 v[96:99], v[160:163], a[196:199], v[96:99]
    v_fma_f32 v131, v131, s30, v54
    v_exp_f32 v131, v131
    v_mfma_f32_16x16x32_bf16 v[104:107], v[160:163], a[212:215], v[104:107]
    v_cvt_pk_bf16_f32 v124, v124, v125
    v_cvt_pk_bf16_f32 v125, v126, v127
    v_mfma_f32_16x16x32_bf16 v[112:115], v[160:163], a[228:231], v[112:115]
    ds_read_b128 v[160:163], v13 offset:16384
    s_waitcnt lgkmcnt(3)
    v_mfma_f32_16x16x32_bf16 v[80:83], v[164:167], a[168:171], v[80:83]
    v_cvt_pk_bf16_f32 v126, v128, v129
    v_cvt_pk_bf16_f32 v127, v130, v131
    v_mfma_f32_16x16x32_bf16 v[88:91], v[164:167], a[184:187], v[88:91]
    v_fma_f32 v132, v132, s30, v55
    v_exp_f32 v132, v132
    v_mfma_f32_16x16x32_bf16 v[96:99], v[164:167], a[200:203], v[96:99]
    v_fma_f32 v133, v133, s30, v55
    v_exp_f32 v133, v133
    v_mfma_f32_16x16x32_bf16 v[104:107], v[164:167], a[216:219], v[104:107]
    v_fma_f32 v134, v134, s30, v55
    v_exp_f32 v134, v134
    v_mfma_f32_16x16x32_bf16 v[112:115], v[164:167], a[232:235], v[112:115]
    ds_read_b128 v[164:167], v14 offset:16384
    s_waitcnt lgkmcnt(3)
    v_mfma_f32_16x16x32_bf16 v[80:83], v[168:171], a[172:175], v[80:83]
    v_fma_f32 v135, v135, s30, v55
    v_exp_f32 v135, v135
    v_mfma_f32_16x16x32_bf16 v[88:91], v[168:171], a[188:191], v[88:91]
    v_fma_f32 v136, v136, s30, v55
    v_exp_f32 v136, v136
    v_mfma_f32_16x16x32_bf16 v[96:99], v[168:171], a[204:207], v[96:99]
    v_fma_f32 v137, v137, s30, v55
    v_exp_f32 v137, v137
    v_mfma_f32_16x16x32_bf16 v[104:107], v[168:171], a[220:223], v[104:107]
    v_fma_f32 v138, v138, s30, v55
    v_exp_f32 v138, v138
    v_mfma_f32_16x16x32_bf16 v[112:115], v[168:171], a[236:239], v[112:115]
    ds_read_b128 v[168:171], v15 offset:16384
    v_mfma_f32_16x16x32_bf16 a[0:3], v[172:175], v[116:119], a[0:3]
    v_fma_f32 v139, v139, s30, v55
    v_exp_f32 v139, v139
    v_mfma_f32_16x16x32_bf16 a[32:35], v[172:175], v[124:127], a[32:35]
    v_cvt_pk_bf16_f32 v132, v132, v133
    v_cvt_pk_bf16_f32 v133, v134, v135
    v_mfma_f32_16x16x32_bf16 a[4:7], v[176:179], v[116:119], a[4:7]
    v_cvt_pk_bf16_f32 v134, v136, v137
    v_cvt_pk_bf16_f32 v135, v138, v139
    v_mfma_f32_16x16x32_bf16 a[36:39], v[176:179], v[124:127], a[36:39]
    v_fma_f32 v140, v140, s30, v56
    v_exp_f32 v140, v140
    v_mfma_f32_16x16x32_bf16 a[64:67], v[172:175], v[132:135], a[64:67]
    v_fma_f32 v141, v141, s30, v56
    v_exp_f32 v141, v141
    v_mfma_f32_16x16x32_bf16 a[68:71], v[176:179], v[132:135], a[68:71]
    v_fma_f32 v142, v142, s30, v56
    v_exp_f32 v142, v142
    v_mfma_f32_16x16x32_bf16 a[8:11], v[180:183], v[116:119], a[8:11]
    v_fma_f32 v143, v143, s30, v56
    v_exp_f32 v143, v143
    v_mfma_f32_16x16x32_bf16 a[40:43], v[180:183], v[124:127], a[40:43]
    v_fma_f32 v144, v144, s30, v56
    v_exp_f32 v144, v144
    v_mfma_f32_16x16x32_bf16 a[72:75], v[180:183], v[132:135], a[72:75]
    v_fma_f32 v145, v145, s30, v56
    v_exp_f32 v145, v145
    v_mfma_f32_16x16x32_bf16 a[12:15], v[184:187], v[116:119], a[12:15]
    v_fma_f32 v146, v146, s30, v56
    v_exp_f32 v146, v146
    v_mfma_f32_16x16x32_bf16 a[44:47], v[184:187], v[124:127], a[44:47]
    v_fma_f32 v147, v147, s30, v56
    v_exp_f32 v147, v147
    v_mfma_f32_16x16x32_bf16 a[76:79], v[184:187], v[132:135], a[76:79]
    v_cvt_pk_bf16_f32 v140, v140, v141
    v_cvt_pk_bf16_f32 v141, v142, v143
    v_mfma_f32_16x16x32_bf16 v[28:31], v[24:27], v[116:119], v[28:31]
    v_cvt_pk_bf16_f32 v142, v144, v145
    v_cvt_pk_bf16_f32 v143, v146, v147
    v_mfma_f32_16x16x32_bf16 v[32:35], v[24:27], v[124:127], v[32:35]
    v_fma_f32 v148, v148, s30, v57
    v_exp_f32 v148, v148
    v_mfma_f32_16x16x32_bf16 a[96:99], v[172:175], v[140:143], a[96:99]
    v_fma_f32 v149, v149, s30, v57
    v_exp_f32 v149, v149
    v_mfma_f32_16x16x32_bf16 a[100:103], v[176:179], v[140:143], a[100:103]
    v_fma_f32 v150, v150, s30, v57
    v_exp_f32 v150, v150
    v_mfma_f32_16x16x32_bf16 a[104:107], v[180:183], v[140:143], a[104:107]
    v_fma_f32 v151, v151, s30, v57
    v_exp_f32 v151, v151
    v_mfma_f32_16x16x32_bf16 a[108:111], v[184:187], v[140:143], a[108:111]
    v_fma_f32 v152, v152, s30, v57
    v_exp_f32 v152, v152
    v_mfma_f32_16x16x32_bf16 v[36:39], v[24:27], v[132:135], v[36:39]
    v_fma_f32 v153, v153, s30, v57
    v_exp_f32 v153, v153
    v_mfma_f32_16x16x32_bf16 v[40:43], v[24:27], v[140:143], v[40:43]
    v_fma_f32 v154, v154, s30, v57
    v_exp_f32 v154, v154
    v_fma_f32 v155, v155, s30, v57
    v_exp_f32 v155, v155
    v_cvt_pk_bf16_f32 v148, v148, v149
    v_cvt_pk_bf16_f32 v149, v150, v151
    v_cvt_pk_bf16_f32 v150, v152, v153
    v_cvt_pk_bf16_f32 v151, v154, v155
    s_add_u32 s35, s32, 32768
    s_add_u32 m0, s29, 0
    v_mfma_f32_16x16x32_bf16 a[128:131], v[172:175], v[148:151], a[128:131]
    ds_read_b64_tr_b16 v[172:173], v20 offset:24576
    v_mfma_f32_16x16x32_bf16 a[132:135], v[176:179], v[148:151], a[132:135]
    ds_read_b64_tr_b16 v[174:175], v20 offset:28672
    v_mfma_f32_16x16x32_bf16 a[136:139], v[180:183], v[148:151], a[136:139]
    ds_read_b64_tr_b16 v[176:177], v21 offset:24576
    v_mfma_f32_16x16x32_bf16 a[140:143], v[184:187], v[148:151], a[140:143]
    ds_read_b64_tr_b16 v[178:179], v21 offset:28672
    v_mfma_f32_16x16x32_bf16 v[44:47], v[24:27], v[148:151], v[44:47]
    ds_read_b64_tr_b16 v[180:181], v22 offset:24576
    ds_read_b64_tr_b16 v[182:183], v22 offset:28672
    ds_read_b64_tr_b16 v[184:185], v23 offset:24576
    ds_read_b64_tr_b16 v[186:187], v23 offset:28672
    buffer_load_dwordx4 v8, s[16:19], s35 offen lds
    buffer_load_dwordx4 v9, s[16:19], s35 offen offset:1024 lds
    buffer_load_dwordx4 v10, s[16:19], s35 offen offset:2048 lds
    buffer_load_dwordx4 v11, s[16:19], s35 offen offset:3072 lds
    s_waitcnt lgkmcnt(6)
    v_mfma_f32_16x16x32_bf16 a[16:19], v[172:175], v[116:119], a[16:19]
    s_add_u32 s36, s32, 36864
    s_add_u32 m0, s29, 4096
    s_add_u32 s35, s32, 24576
    v_mfma_f32_16x16x32_bf16 a[48:51], v[172:175], v[124:127], a[48:51]
    buffer_load_dwordx4 v8, s[16:19], s36 offen lds
    v_mfma_f32_16x16x32_bf16 a[80:83], v[172:175], v[132:135], a[80:83]
    buffer_load_dwordx4 v9, s[16:19], s36 offen offset:1024 lds
    v_mfma_f32_16x16x32_bf16 a[112:115], v[172:175], v[140:143], a[112:115]
    buffer_load_dwordx4 v10, s[16:19], s36 offen offset:2048 lds
    v_mfma_f32_16x16x32_bf16 a[144:147], v[172:175], v[148:151], a[144:147]
    buffer_load_dwordx4 v11, s[16:19], s36 offen offset:3072 lds
    s_waitcnt lgkmcnt(4)
    v_mfma_f32_16x16x32_bf16 a[20:23], v[176:179], v[116:119], a[20:23]
    s_waitcnt vmcnt(12)
    ds_read_b64_tr_b16 v[172:173], v16 offset:8192
    v_mfma_f32_16x16x32_bf16 a[52:55], v[176:179], v[124:127], a[52:55]
    s_waitcnt vmcnt(8)
    ds_read_b64_tr_b16 v[174:175], v16 offset:12288
    v_mfma_f32_16x16x32_bf16 a[84:87], v[176:179], v[132:135], a[84:87]
    s_add_u32 m0, s29, 24576
    s_add_u32 s36, s32, 28672
    s_waitcnt lgkmcnt(3)
    buffer_load_dwordx4 v8, s[20:23], s35 offen lds
    v_mfma_f32_16x16x32_bf16 a[116:119], v[176:179], v[140:143], a[116:119]
    buffer_load_dwordx4 v9, s[20:23], s35 offen offset:1024 lds
    v_mfma_f32_16x16x32_bf16 a[148:151], v[176:179], v[148:151], a[148:151]
    buffer_load_dwordx4 v10, s[20:23], s35 offen offset:2048 lds
    v_mfma_f32_16x16x32_bf16 a[24:27], v[180:183], v[116:119], a[24:27]
    buffer_load_dwordx4 v11, s[20:23], s35 offen offset:3072 lds
    v_mfma_f32_16x16x32_bf16 a[56:59], v[180:183], v[124:127], a[56:59]
    ds_read_b64_tr_b16 v[176:177], v17 offset:8192
    v_mfma_f32_16x16x32_bf16 a[88:91], v[180:183], v[132:135], a[88:91]
    ds_read_b64_tr_b16 v[178:179], v17 offset:12288
    v_mfma_f32_16x16x32_bf16 a[120:123], v[180:183], v[140:143], a[120:123]
    s_add_u32 m0, s29, 28672
    v_max3_f32 v63, v76, v77, v78
    s_waitcnt lgkmcnt(4)
    buffer_load_dwordx4 v8, s[20:23], s36 offen lds
    v_mfma_f32_16x16x32_bf16 a[152:155], v[180:183], v[148:151], a[152:155]
    buffer_load_dwordx4 v9, s[20:23], s36 offen offset:1024 lds
    v_mfma_f32_16x16x32_bf16 a[28:31], v[184:187], v[116:119], a[28:31]
    buffer_load_dwordx4 v10, s[20:23], s36 offen offset:2048 lds
    v_mfma_f32_16x16x32_bf16 a[60:63], v[184:187], v[124:127], a[60:63]
    buffer_load_dwordx4 v11, s[20:23], s36 offen offset:3072 lds
    v_mfma_f32_16x16x32_bf16 a[92:95], v[184:187], v[132:135], a[92:95]
    ds_read_b64_tr_b16 v[180:181], v18 offset:8192
    v_mfma_f32_16x16x32_bf16 a[124:127], v[184:187], v[140:143], a[124:127]
    ds_read_b64_tr_b16 v[182:183], v18 offset:12288
    v_mfma_f32_16x16x32_bf16 a[156:159], v[184:187], v[148:151], a[156:159]
    ds_read_b64_tr_b16 v[184:185], v19 offset:8192
    v_mfma_f32_16x16x32_bf16 v[116:119], v[156:159], a[160:163], 0
    ds_read_b64_tr_b16 v[186:187], v19 offset:12288
    v_mfma_f32_16x16x32_bf16 v[124:127], v[156:159], a[176:179], 0
    v_max3_f32 v63, v63, v79, v80
    v_max3_f32 v63, v63, v81, v82
    v_mfma_f32_16x16x32_bf16 v[132:135], v[156:159], a[192:195], 0
    v_max_f32 v63, v63, v83
    v_max3_f32 v64, v84, v85, v86
    v_mfma_f32_16x16x32_bf16 v[140:143], v[156:159], a[208:211], 0
    v_max3_f32 v64, v64, v87, v88
    v_max3_f32 v64, v64, v89, v90
    v_mfma_f32_16x16x32_bf16 v[148:151], v[156:159], a[224:227], 0
    ds_read_b128 v[156:159], v12 offset:20480
    v_mfma_f32_16x16x32_bf16 v[116:119], v[160:163], a[164:167], v[116:119]
    v_max_f32 v64, v64, v91
    v_max3_f32 v65, v92, v93, v94
    v_mfma_f32_16x16x32_bf16 v[124:127], v[160:163], a[180:183], v[124:127]
    v_max3_f32 v65, v65, v95, v96
    v_max3_f32 v65, v65, v97, v98
    v_mfma_f32_16x16x32_bf16 v[132:135], v[160:163], a[196:199], v[132:135]
    v_max_f32 v65, v65, v99
    v_max3_f32 v66, v100, v101, v102
    v_mfma_f32_16x16x32_bf16 v[140:143], v[160:163], a[212:215], v[140:143]
    v_max3_f32 v66, v66, v103, v104
    v_max3_f32 v66, v66, v105, v106
    v_mfma_f32_16x16x32_bf16 v[148:151], v[160:163], a[228:231], v[148:151]
    ds_read_b128 v[160:163], v13 offset:20480
    v_mfma_f32_16x16x32_bf16 v[116:119], v[164:167], a[168:171], v[116:119]
    v_max_f32 v66, v66, v107
    v_max3_f32 v67, v108, v109, v110
    v_mfma_f32_16x16x32_bf16 v[124:127], v[164:167], a[184:187], v[124:127]
    v_max3_f32 v67, v67, v111, v112
    v_max3_f32 v67, v67, v113, v114
    v_mfma_f32_16x16x32_bf16 v[132:135], v[164:167], a[200:203], v[132:135]
    v_max_f32 v67, v67, v115
    v_cmp_gt_f32 s[44:45], v63, v58
    v_mfma_f32_16x16x32_bf16 v[140:143], v[164:167], a[216:219], v[140:143]
    v_cmp_gt_f32 s[46:47], v64, v59
    v_cmp_gt_f32 s[48:49], v65, v60
    v_mfma_f32_16x16x32_bf16 v[148:151], v[164:167], a[232:235], v[148:151]
    ds_read_b128 v[164:167], v14 offset:20480
    v_mfma_f32_16x16x32_bf16 v[116:119], v[168:171], a[172:175], v[116:119]
    v_cmp_gt_f32 s[50:51], v66, v61
    v_cmp_gt_f32 s[52:53], v67, v62
    v_mfma_f32_16x16x32_bf16 v[124:127], v[168:171], a[188:191], v[124:127]
    s_or_b64 s[44:45], s[44:45], s[46:47]
    s_or_b64 s[44:45], s[44:45], s[48:49]
    s_or_b64 s[44:45], s[44:45], s[50:51]
    v_mfma_f32_16x16x32_bf16 v[132:135], v[168:171], a[204:207], v[132:135]
    s_or_b64 s[44:45], s[44:45], s[52:53]
    s_cbranch_scc1 L_slow2
L_ret2:
    v_fma_f32 v76, v76, s30, v53
    v_mfma_f32_16x16x32_bf16 v[140:143], v[168:171], a[220:223], v[140:143]
    v_exp_f32 v76, v76
    v_mfma_f32_16x16x32_bf16 v[148:151], v[168:171], a[236:239], v[148:151]
    ds_read_b128 v[168:171], v15 offset:20480
    s_waitcnt lgkmcnt(3)
    v_mfma_f32_16x16x32_bf16 v[120:123], v[156:159], a[160:163], 0
    v_fma_f32 v77, v77, s30, v53
    v_exp_f32 v77, v77
    v_mfma_f32_16x16x32_bf16 v[128:131], v[156:159], a[176:179], 0
    v_fma_f32 v78, v78, s30, v53
    v_exp_f32 v78, v78
    v_mfma_f32_16x16x32_bf16 v[136:139], v[156:159], a[192:195], 0
    v_fma_f32 v79, v79, s30, v53
    v_exp_f32 v79, v79
    v_mfma_f32_16x16x32_bf16 v[144:147], v[156:159], a[208:211], 0
    v_fma_f32 v80, v80, s30, v53
    v_exp_f32 v80, v80
    v_mfma_f32_16x16x32_bf16 v[152:155], v[156:159], a[224:227], 0
    s_waitcnt vmcnt(12)
    ds_read_b128 v[156:159], v12
    s_waitcnt lgkmcnt(3)
    v_mfma_f32_16x16x32_bf16 v[120:123], v[160:163], a[164:167], v[120:123]
    v_fma_f32 v81, v81, s30, v53
    v_exp_f32 v81, v81
    v_mfma_f32_16x16x32_bf16 v[128:131], v[160:163], a[180:183], v[128:131]
    v_fma_f32 v82, v82, s30, v53
    v_exp_f32 v82, v82
    v_mfma_f32_16x16x32_bf16 v[136:139], v[160:163], a[196:199], v[136:139]
    v_fma_f32 v83, v83, s30, v53
    v_exp_f32 v83, v83
    v_mfma_f32_16x16x32_bf16 v[144:147], v[160:163], a[212:215], v[144:147]
    v_cvt_pk_bf16_f32 v76, v76, v77
    v_cvt_pk_bf16_f32 v77, v78, v79
    v_mfma_f32_16x16x32_bf16 v[152:155], v[160:163], a[228:231], v[152:155]
    ds_read_b128 v[160:163], v13
    s_waitcnt lgkmcnt(3)
    v_mfma_f32_16x16x32_bf16 v[120:123], v[164:167], a[168:171], v[120:123]
    v_cvt_pk_bf16_f32 v78, v80, v81
    v_cvt_pk_bf16_f32 v79, v82, v83
    v_mfma_f32_16x16x32_bf16 v[128:131], v[164:167], a[184:187], v[128:131]
    v_fma_f32 v84, v84, s30, v54
    v_exp_f32 v84, v84
    v_mfma_f32_16x16x32_bf16 v[136:139], v[164:167], a[200:203], v[136:139]
    v_fma_f32 v85, v85, s30, v54
    v_exp_f32 v85, v85
    v_mfma_f32_16x16x32_bf16 v[144:147], v[164:167], a[216:219], v[144:147]
    v_fma_f32 v86, v86, s30, v54
    v_exp_f32 v86, v86
    v_mfma_f32_16x16x32_bf16 v[152:155], v[164:167], a[232:235], v[152:155]
    ds_read_b128 v[164:167], v14
    s_waitcnt lgkmcnt(3)
    v_mfma_f32_16x16x32_bf16 v[120:123], v[168:171], a[172:175], v[120:123]
    v_fma_f32 v87, v87, s30, v54
    v_exp_f32 v87, v87
    v_mfma_f32_16x16x32_bf16 v[128:131], v[168:171], a[188:191], v[128:131]
    v_fma_f32 v88, v88, s30, v54
    v_exp_f32 v88, v88
    v_mfma_f32_16x16x32_bf16 v[136:139], v[168:171], a[204:207], v[136:139]
    v_fma_f32 v89, v89, s30, v54
    v_exp_f32 v89, v89
    v_mfma_f32_16x16x32_bf16 v[144:147], v[168:171], a[220:223], v[144:147]
    v_fma_f32 v90, v90, s30, v54
    v_exp_f32 v90, v90
    v_mfma_f32_16x16x32_bf16 v[152:155], v[168:171], a[236:239], v[152:155]
    ds_read_b128 v[168:171], v15
    v_mfma_f32_16x16x32_bf16 a[0:3], v[172:175], v[76:79], a[0:3]
    v_fma_f32 v91, v91, s30, v54
    v_exp_f32 v91, v91
    v_mfma_f32_16x16x32_bf16 a[4:7], v[176:179], v[76:79], a[4:7]
    v_cvt_pk_bf16_f32 v84, v84, v85
    v_cvt_pk_bf16_f32 v85, v86, v87
    v_mfma_f32_16x16x32_bf16 a[8:11], v[180:183], v[76:79], a[8:11]
    v_cvt_pk_bf16_f32 v86, v88, v89
    v_cvt_pk_bf16_f32 v87, v90, v91
    v_mfma_f32_16x16x32_bf16 a[12:15], v[184:187], v[76:79], a[12:15]
    v_fma_f32 v92, v92, s30, v55
    v_exp_f32 v92, v92
    v_mfma_f32_16x16x32_bf16 a[32:35], v[172:175], v[84:87], a[32:35]
    v_fma_f32 v93, v93, s30, v55
    v_exp_f32 v93, v93
    v_mfma_f32_16x16x32_bf16 a[36:39], v[176:179], v[84:87], a[36:39]
    v_fma_f32 v94, v94, s30, v55
    v_exp_f32 v94, v94
    v_mfma_f32_16x16x32_bf16 a[40:43], v[180:183], v[84:87], a[40:43]
    v_fma_f32 v95, v95, s30, v55
    v_exp_f32 v95, v95
    v_mfma_f32_16x16x32_bf16 a[44:47], v[184:187], v[84:87], a[44:47]
    v_fma_f32 v96, v96, s30, v55
    v_exp_f32 v96, v96
    v_mfma_f32_16x16x32_bf16 v[28:31], v[24:27], v[76:79], v[28:31]
    v_fma_f32 v97, v97, s30, v55
    v_exp_f32 v97, v97
    v_mfma_f32_16x16x32_bf16 v[32:35], v[24:27], v[84:87], v[32:35]
    v_fma_f32 v98, v98, s30, v55
    v_exp_f32 v98, v98
    v_fma_f32 v99, v99, s30, v55
    v_exp_f32 v99, v99
    v_cvt_pk_bf16_f32 v92, v92, v93
    v_cvt_pk_bf16_f32 v93, v94, v95
    v_cvt_pk_bf16_f32 v94, v96, v97
    v_cvt_pk_bf16_f32 v95, v98, v99
    v_fma_f32 v100, v100, s30, v56
    v_exp_f32 v100, v100
    v_mfma_f32_16x16x32_bf16 a[64:67], v[172:175], v[92:95], a[64:67]
    v_fma_f32 v101, v101, s30, v56
    v_exp_f32 v101, v101
    v_mfma_f32_16x16x32_bf16 a[68:71], v[176:179], v[92:95], a[68:71]
    v_fma_f32 v102, v102, s30, v56
    v_exp_f32 v102, v102
    v_mfma_f32_16x16x32_bf16 a[72:75], v[180:183], v[92:95], a[72:75]
    v_fma_f32 v103, v103, s30, v56
    v_exp_f32 v103, v103
    v_mfma_f32_16x16x32_bf16 a[76:79], v[184:187], v[92:95], a[76:79]
    v_fma_f32 v104, v104, s30, v56
    v_exp_f32 v104, v104
    v_mfma_f32_16x16x32_bf16 v[36:39], v[24:27], v[92:95], v[36:39]
    v_fma_f32 v105, v105, s30, v56
    v_exp_f32 v105, v105
    v_fma_f32 v106, v106, s30, v56
    v_exp_f32 v106, v106
    v_fma_f32 v107, v107, s30, v56
    v_exp_f32 v107, v107
    v_cvt_pk_bf16_f32 v100, v100, v101
    v_cvt_pk_bf16_f32 v101, v102, v103
    v_cvt_pk_bf16_f32 v102, v104, v105
    v_cvt_pk_bf16_f32 v103, v106, v107
    v_fma_f32 v108, v108, s30, v57
    v_exp_f32 v108, v108
    v_mfma_f32_16x16x32_bf16 a[96:99], v[172:175], v[100:103], a[96:99]
    v_fma_f32 v109, v109, s30, v57
    v_exp_f32 v109, v109
    v_mfma_f32_16x16x32_bf16 a[100:103], v[176:179], v[100:103], a[100:103]
    v_fma_f32 v110, v110, s30, v57
    v_exp_f32 v110, v110
    v_mfma_f32_16x16x32_bf16 a[104:107], v[180:183], v[100:103], a[104:107]
    v_fma_f32 v111, v111, s30, v57
    v_exp_f32 v111, v111
    v_mfma_f32_16x16x32_bf16 a[108:111], v[184:187], v[100:103], a[108:111]
    v_fma_f32 v112, v112, s30, v57
    v_exp_f32 v112, v112
    v_mfma_f32_16x16x32_bf16 v[40:43], v[24:27], v[100:103], v[40:43]
    v_fma_f32 v113, v113, s30, v57
    v_exp_f32 v113, v113
    v_fma_f32 v114, v114, s30, v57
    v_exp_f32 v114, v114
    v_fma_f32 v115, v115, s30, v57
    v_exp_f32 v115, v115
    v_cvt_pk_bf16_f32 v108, v108, v109
    v_cvt_pk_bf16_f32 v109, v110, v111
    v_cvt_pk_bf16_f32 v110, v112, v113
    v_cvt_pk_bf16_f32 v111, v114, v115
    s_add_u32 s39, s32, 40960
    s_add_u32 m0, s29, 16384
    v_mfma_f32_16x16x32_bf16 a[128:131], v[172:175], v[108:111], a[128:131]
    ds_read_b64_tr_b16 v[172:173], v20 offset:8192
    v_mfma_f32_16x16x32_bf16 a[132:135], v[176:179], v[108:111], a[132:135]
    ds_read_b64_tr_b16 v[174:175], v20 offset:12288
    v_mfma_f32_16x16x32_bf16 a[136:139], v[180:183], v[108:111], a[136:139]
    ds_read_b64_tr_b16 v[176:177], v21 offset:8192
    v_mfma_f32_16x16x32_bf16 a[140:143], v[184:187], v[108:111], a[140:143]
    ds_read_b64_tr_b16 v[178:179], v21 offset:12288
    v_mfma_f32_16x16x32_bf16 v[44:47], v[24:27], v[108:111], v[44:47]
    ds_read_b64_tr_b16 v[180:181], v22 offset:8192
    ds_read_b64_tr_b16 v[182:183], v22 offset:12288
    ds_read_b64_tr_b16 v[184:185], v23 offset:8192
    ds_read_b64_tr_b16 v[186:187], v23 offset:12288
    buffer_load_dwordx4 v8, s[16:19], s39 offen lds
    buffer_load_dwordx4 v9, s[16:19], s39 offen offset:1024 lds
    buffer_load_dwordx4 v10, s[16:19], s39 offen offset:2048 lds
    buffer_load_dwordx4 v11, s[16:19], s39 offen offset:3072 lds
    s_waitcnt lgkmcnt(6)
    v_mfma_f32_16x16x32_bf16 a[16:19], v[172:175], v[76:79], a[16:19]
    s_add_u32 s40, s32, 45056
    s_add_u32 m0, s29, 20480
    s_add_u32 s37, s32, 32768
    v_mfma_f32_16x16x32_bf16 a[48:51], v[172:175], v[84:87], a[48:51]
    buffer_load_dwordx4 v8, s[16:19], s40 offen lds
    v_mfma_f32_16x16x32_bf16 a[80:83], v[172:175], v[92:95], a[80:83]
    buffer_load_dwordx4 v9, s[16:19], s40 offen offset:1024 lds
    v_mfma_f32_16x16x32_bf16 a[112:115], v[172:175], v[100:103], a[112:115]
    buffer_load_dwordx4 v10, s[16:19], s40 offen offset:2048 lds
    v_mfma_f32_16x16x32_bf16 a[144:147], v[172:175], v[108:111], a[144:147]
    buffer_load_dwordx4 v11, s[16:19], s40 offen offset:3072 lds
    s_waitcnt lgkmcnt(4)
    v_mfma_f32_16x16x32_bf16 a[20:23], v[176:179], v[76:79], a[20:23]
    s_waitcnt vmcnt(12)
    ds_read_b64_tr_b16 v[172:173], v16 offset:24576
    v_mfma_f32_16x16x32_bf16 a[52:55], v[176:179], v[84:87], a[52:55]
    s_waitcnt vmcnt(8)
    ds_read_b64_tr_b16 v[174:175], v16 offset:28672
    v_mfma_f32_16x16x32_bf16 a[84:87], v[176:179], v[92:95], a[84:87]
    s_add_u32 m0, s29, 8192
    s_add_u32 s38, s32, 36864
    s_waitcnt lgkmcnt(3)
    buffer_load_dwordx4 v8, s[20:23], s37 offen lds
    v_mfma_f32_16x16x32_bf16 a[116:119], v[176:179], v[100:103], a[116:119]
    buffer_load_dwordx4 v9, s[20:23], s37 offen offset:1024 lds
    v_mfma_f32_16x16x32_bf16 a[148:151], v[176:179], v[108:111], a[148:151]
    buffer_load_dwordx4 v10, s[20:23], s37 offen offset:2048 lds
    v_mfma_f32_16x16x32_bf16 a[24:27], v[180:183], v[76:79], a[24:27]
    buffer_load_dwordx4 v11, s[20:23], s37 offen offset:3072 lds
    v_mfma_f32_16x16x32_bf16 a[56:59], v[180:183], v[84:87], a[56:59]
    ds_read_b64_tr_b16 v[176:177], v17 offset:24576
    v_mfma_f32_16x16x32_bf16 a[88:91], v[180:183], v[92:95], a[88:91]
    ds_read_b64_tr_b16 v[178:179], v17 offset:28672
    v_mfma_f32_16x16x32_bf16 a[120:123], v[180:183], v[100:103], a[120:123]
    s_add_u32 m0, s29, 12288
    v_max3_f32 v63, v116, v117, v118
    s_waitcnt lgkmcnt(4)
    buffer_load_dwordx4 v8, s[20:23], s38 offen lds
    v_mfma_f32_16x16x32_bf16 a[152:155], v[180:183], v[108:111], a[152:155]
    buffer_load_dwordx4 v9, s[20:23], s38 offen offset:1024 lds
    v_mfma_f32_16x16x32_bf16 a[28:31], v[184:187], v[76:79], a[28:31]
    buffer_load_dwordx4 v10, s[20:23], s38 offen offset:2048 lds
    v_mfma_f32_16x16x32_bf16 a[60:63], v[184:187], v[84:87], a[60:63]
    buffer_load_dwordx4 v11, s[20:23], s38 offen offset:3072 lds
    v_mfma_f32_16x16x32_bf16 a[92:95], v[184:187], v[92:95], a[92:95]
    ds_read_b64_tr_b16 v[180:181], v18 offset:24576
    v_mfma_f32_16x16x32_bf16 a[124:127], v[184:187], v[100:103], a[124:127]
    ds_read_b64_tr_b16 v[182:183], v18 offset:28672
    v_mfma_f32_16x16x32_bf16 a[156:159], v[184:187], v[108:111], a[156:159]
    ds_read_b64_tr_b16 v[184:185], v19 offset:24576
    v_mfma_f32_16x16x32_bf16 v[76:79], v[156:159], a[160:163], 0
    ds_read_b64_tr_b16 v[186:187], v19 offset:28672
    v_mfma_f32_16x16x32_bf16 v[84:87], v[156:159], a[176:179], 0
    v_max3_f32 v63, v63, v119, v120
    v_max3_f32 v63, v63, v121, v122
    v_mfma_f32_16x16x32_bf16 v[92:95], v[156:159], a[192:195], 0
    v_max_f32 v63, v63, v123
    v_max3_f32 v64, v124, v125, v126
    v_mfma_f32_16x16x32_bf16 v[100:103], v[156:159], a[208:211], 0
    v_max3_f32 v64, v64, v127, v128
    v_max3_f32 v64, v64, v129, v130
    v_mfma_f32_16x16x32_bf16 v[108:111], v[156:159], a[224:227], 0
    ds_read_b128 v[156:159], v12 offset:4096
    v_mfma_f32_16x16x32_bf16 v[76:79], v[160:163], a[164:167], v[76:79]
    v_max_f32 v64, v64, v131
    v_max3_f32 v65, v132, v133, v134
    v_mfma_f32_16x16x32_bf16 v[84:87], v[160:163], a[180:183], v[84:87]
    v_max3_f32 v65, v65, v135, v136
    v_max3_f32 v65, v65, v137, v138
    v_mfma_f32_16x16x32_bf16 v[92:95], v[160:163], a[196:199], v[92:95]
    v_max_f32 v65, v65, v139
    v_max3_f32 v66, v140, v141, v142
    v_mfma_f32_16x16x32_bf16 v[100:103], v[160:163], a[212:215], v[100:103]
    v_max3_f32 v66, v66, v143, v144
    v_max3_f32 v66, v66, v145, v146
    v_mfma_f32_16x16x32_bf16 v[108:111], v[160:163], a[228:231], v[108:111]
    ds_read_b128 v[160:163], v13 offset:4096
    v_mfma_f32_16x16x32_bf16 v[76:79], v[164:167], a[168:171], v[76:79]
    v_max_f32 v66, v66, v147
    v_max3_f32 v67, v148, v149, v150
    v_mfma_f32_16x16x32_bf16 v[84:87], v[164:167], a[184:187], v[84:87]
    v_max3_f32 v67, v67, v151, v152
    v_max3_f32 v67, v67, v153, v154
    v_mfma_f32_16x16x32_bf16 v[92:95], v[164:167], a[200:203], v[92:95]
    v_max_f32 v67, v67, v155
    v_cmp_gt_f32 s[44:45], v63, v58
    v_mfma_f32_16x16x32_bf16 v[100:103], v[164:167], a[216:219], v[100:103]
    v_cmp_gt_f32 s[46:47], v64, v59
    v_cmp_gt_f32 s[48:49], v65, v60
    v_mfma_f32_16x16x32_bf16 v[108:111], v[164:167], a[232:235], v[108:111]
    ds_read_b128 v[164:167], v14 offset:4096
    v_mfma_f32_16x16x32_bf16 v[76:79], v[168:171], a[172:175], v[76:79]
    v_cmp_gt_f32 s[50:51], v66, v61
    v_cmp_gt_f32 s[52:53], v67, v62
    v_mfma_f32_16x16x32_bf16 v[84:87], v[168:171], a[188:191], v[84:87]
    s_or_b64 s[44:45], s[44:45], s[46:47]
    s_or_b64 s[44:45], s[44:45], s[48:49]
    s_or_b64 s[44:45], s[44:45], s[50:51]
    v_mfma_f32_16x16x32_bf16 v[92:95], v[168:171], a[204:207], v[92:95]
    s_or_b64 s[44:45], s[44:45], s[52:53]
    s_cbranch_scc1 L_slow3
L_ret3:
    v_fma_f32 v116, v116, s30, v53
    v_mfma_f32_16x16x32_bf16 v[100:103], v[168:171], a[220:223], v[100:103]
    v_exp_f32 v116, v116
    v_mfma_f32_16x16x32_bf16 v[108:111], v[168:171], a[236:239], v[108:111]
    ds_read_b128 v[168:171], v15 offset:4096
    s_waitcnt lgkmcnt(3)
    v_mfma_f32_16x16x32_bf16 v[80:83], v[156:159], a[160:163], 0
    v_fma_f32 v117, v117, s30, v53
    v_exp_f32 v117, v117
    v_mfma_f32_16x16x32_bf16 v[88:91], v[156:159], a[176:179], 0
    v_fma_f32 v118, v118, s30, v53
    v_exp_f32 v118, v118
    v_mfma_f32_16x16x32_bf16 v[96:99], v[156:159], a[192:195], 0
    v_fma_f32 v119, v119, s30, v53
    v_exp_f32 v119, v119
    v_mfma_f32_16x16x32_bf16 v[104:107], v[156:159], a[208:211], 0
    v_fma_f32 v120, v120, s30, v53
    v_exp_f32 v120, v120
    v_mfma_f32_16x16x32_bf16 v[112:115], v[156:159], a[224:227], 0
    s_waitcnt vmcnt(12)
    ds_read_b128 v[156:159], v12 offset:16384
    s_waitcnt lgkmcnt(3)
    v_mfma_f32_16x16x32_bf16 v[80:83], v[160:163], a[164:167], v[80:83]
    v_fma_f32 v121, v121, s30, v53
    v_exp_f32 v121, v121
    v_mfma_f32_16x16x32_bf16 v[88:91], v[160:163], a[180:183], v[88:91]
    v_fma_f32 v122, v122, s30, v53
    v_exp_f32 v122, v122
    v_mfma_f32_16x16x32_bf16 v[96:99], v[160:163], a[196:199], v[96:99]
    v_fma_f32 v123, v123, s30, v53
    v_exp_f32 v123, v123
    v_mfma_f32_16x16x32_bf16 v[104:107], v[160:163], a[212:215], v[104:107]
    v_cvt_pk_bf16_f32 v116, v116, v117
    v_cvt_pk_bf16_f32 v117, v118, v119
    v_mfma_f32_16x16x32_bf16 v[112:115], v[160:163], a[228:231], v[112:115]
    ds_read_b128 v[160:163], v13 offset:16384
    s_waitcnt lgkmcnt(3)
    v_mfma_f32_16x16x32_bf16 v[80:83], v[164:167], a[168:171], v[80:83]
    v_cvt_pk_bf16_f32 v118, v120, v121
    v_cvt_pk_bf16_f32 v119, v122, v123
    v_mfma_f32_16x16x32_bf16 v[88:91], v[164:167], a[184:187], v[88:91]
    v_fma_f32 v124, v124, s30, v54
    v_exp_f32 v124, v124
    v_mfma_f32_16x16x32_bf16 v[96:99], v[164:167], a[200:203], v[96:99]
    v_fma_f32 v125, v125, s30, v54
    v_exp_f32 v125, v125
    v_mfma_f32_16x16x32_bf16 v[104:107], v[164:167], a[216:219], v[104:107]
    v_fma_f32 v126, v126, s30, v54
    v_exp_f32 v126, v126
    v_mfma_f32_16x16x32_bf16 v[112:115], v[164:167], a[232:235], v[112:115]
    ds_read_b128 v[164:167], v14 offset:16384
    s_waitcnt lgkmcnt(3)
    v_mfma_f32_16x16x32_bf16 v[80:83], v[168:171], a[172:175], v[80:83]
    v_fma_f32 v127, v127, s30, v54
    v_exp_f32 v127, v127
    v_mfma_f32_16x16x32_bf16 v[88:91], v[168:171], a[188:191], v[88:91]
    v_fma_f32 v128, v128, s30, v54
    v_exp_f32 v128, v128
    v_mfma_f32_16x16x32_bf16 v[96:99], v[168:171], a[204:207], v[96:99]
    v_fma_f32 v129, v129, s30, v54
    v_exp_f32 v129, v129
    v_mfma_f32_16x16x32_bf16 v[104:107], v[168:171], a[220:223], v[104:107]
    v_fma_f32 v130, v130, s30, v54
    v_exp_f32 v130, v130
    v_mfma_f32_16x16x32_bf16 v[112:115], v[168:171], a[236:239], v[112:115]
    ds_read_b128 v[168:171], v15 offset:16384
    v_mfma_f32_16x16x32_bf16 a[0:3], v[172:175], v[116:119], a[0:3]
    v_fma_f32 v131, v131, s30, v54
    v_exp_f32 v131, v131
    v_mfma_f32_16x16x32_bf16 a[4:7], v[176:179], v[116:119], a[4:7]
    v_cvt_pk_bf16_f32 v124, v124, v125
    v_cvt_pk_bf16_f32 v125, v126, v127
    v_mfma_f32_16x16x32_bf16 a[8:11], v[180:183], v[116:119], a[8:11]
    v_cvt_pk_bf16_f32 v126, v128, v129
    v_cvt_pk_bf16_f32 v127, v130, v131
    v_mfma_f32_16x16x32_bf16 a[12:15], v[184:187], v[116:119], a[12:15]
    v_fma_f32 v132, v132, s30, v55
    v_exp_f32 v132, v132
    v_mfma_f32_16x16x32_bf16 a[32:35], v[172:175], v[124:127], a[32:35]
    v_fma_f32 v133, v133, s30, v55
    v_exp_f32 v133, v133
    v_mfma_f32_16x16x32_bf16 a[36:39], v[176:179], v[124:127], a[36:39]
    v_fma_f32 v134, v134, s30, v55
    v_exp_f32 v134, v134
    v_mfma_f32_16x16x32_bf16 a[40:43], v[180:183], v[124:127], a[40:43]
    v_fma_f32 v135, v135, s30, v55
    v_exp_f32 v135, v135
    v_mfma_f32_16x16x32_bf16 a[44:47], v[184:187], v[124:127], a[44:47]
    v_fma_f32 v136, v136, s30, v55
    v_exp_f32 v136, v136
    v_mfma_f32_16x16x32_bf16 v[28:31], v[24:27], v[116:119], v[28:31]
    v_fma_f32 v137, v137, s30, v55
    v_exp_f32 v137, v137
    v_mfma_f32_16x16x32_bf16 v[32:35], v[24:27], v[124:127], v[32:35]
    v_fma_f32 v138, v138, s30, v55
    v_exp_f32 v138, v138
    v_fma_f32 v139, v139, s30, v55
    v_exp_f32 v139, v139
    v_cvt_pk_bf16_f32 v132, v132, v133
    v_cvt_pk_bf16_f32 v133, v134, v135
    v_cvt_pk_bf16_f32 v134, v136, v137
    v_cvt_pk_bf16_f32 v135, v138, v139
    v_fma_f32 v140, v140, s30, v56
    v_exp_f32 v140, v140
    v_mfma_f32_16x16x32_bf16 a[64:67], v[172:175], v[132:135], a[64:67]
    v_fma_f32 v141, v141, s30, v56
    v_exp_f32 v141, v141
    v_mfma_f32_16x16x32_bf16 a[68:71], v[176:179], v[132:135], a[68:71]
    v_fma_f32 v142, v142, s30, v56
    v_exp_f32 v142, v142
    v_mfma_f32_16x16x32_bf16 a[72:75], v[180:183], v[132:135], a[72:75]
    v_fma_f32 v143, v143, s30, v56
    v_exp_f32 v143, v143
    v_mfma_f32_16x16x32_bf16 a[76:79], v[184:187], v[132:135], a[76:79]
    v_fma_f32 v144, v144, s30, v56
    v_exp_f32 v144, v144
    v_mfma_f32_16x16x32_bf16 v[36:39], v[24:27], v[132:135], v[36:39]
    v_fma_f32 v145, v145, s30, v56
    v_exp_f32 v145, v145
    v_fma_f32 v146, v146, s30, v56
    v_exp_f32 v146, v146
    v_fma_f32 v147, v147, s30, v56
    v_exp_f32 v147, v147
    v_cvt_pk_bf16_f32 v140, v140, v141
    v_cvt_pk_bf16_f32 v141, v142, v143
    v_cvt_pk_bf16_f32 v142, v144, v145
    v_cvt_pk_bf16_f32 v143, v146, v147
    v_fma_f32 v148, v148, s30, v57
    v_exp_f32 v148, v148
    v_mfma_f32_16x16x32_bf16 a[96:99], v[172:175], v[140:143], a[96:99]
    v_fma_f32 v149, v149, s30, v57
    v_exp_f32 v149, v149
    v_mfma_f32_16x16x32_bf16 a[100:103], v[176:179], v[140:143], a[100:103]
    v_fma_f32 v150, v150, s30, v57
    v_exp_f32 v150, v150
    v_mfma_f32_16x16x32_bf16 a[104:107], v[180:183], v[140:143], a[104:107]
    v_fma_f32 v151, v151, s30, v57
    v_exp_f32 v151, v151
    v_mfma_f32_16x16x32_bf16 a[108:111], v[184:187], v[140:143], a[108:111]
    v_fma_f32 v152, v152, s30, v57
    v_exp_f32 v152, v152
    v_mfma_f32_16x16x32_bf16 v[40:43], v[24:27], v[140:143], v[40:43]
    v_fma_f32 v153, v153, s30, v57
    v_exp_f32 v153, v153
    v_fma_f32 v154, v154, s30, v57
    v_exp_f32 v154, v154
    v_fma_f32 v155, v155, s30, v57
    v_exp_f32 v155, v155
    v_cvt_pk_bf16_f32 v148, v148, v149
    v_cvt_pk_bf16_f32 v149, v150, v151
    v_cvt_pk_bf16_f32 v150, v152, v153
    v_cvt_pk_bf16_f32 v151, v154, v155
    s_add_u32 s35, s32, 49152
    s_add_u32 m0, s29, 0
    v_mfma_f32_16x16x32_bf16 a[128:131], v[172:175], v[148:151], a[128:131]
    ds_read_b64_tr_b16 v[172:173], v20 offset:24576
    v_mfma_f32_16x16x32_bf16 a[132:135], v[176:179], v[148:151], a[132:135]
    ds_read_b64_tr_b16 v[174:175], v20 offset:28672
    v_mfma_f32_16x16x32_bf16 a[136:139], v[180:183], v[148:151], a[136:139]
    ds_read_b64_tr_b16 v[176:177], v21 offset:24576
    v_mfma_f32_16x16x32_bf16 a[140:143], v[184:187], v[148:151], a[140:143]
    ds_read_b64_tr_b16 v[178:179], v21 offset:28672
    v_mfma_f32_16x16x32_bf16 v[44:47], v[24:27], v[148:151], v[44:47]
    ds_read_b64_tr_b16 v[180:181], v22 offset:24576
    ds_read_b64_tr_b16 v[182:183], v22 offset:28672
    ds_read_b64_tr_b16 v[184:185], v23 offset:24576
    ds_read_b64_tr_b16 v[186:187], v23 offset:28672
    buffer_load_dwordx4 v8, s[16:19], s35 offen lds
    buffer_load_dwordx4 v9, s[16:19], s35 offen offset:1024 lds
    buffer_load_dwordx4 v10, s[16:19], s35 offen offset:2048 lds
    buffer_load_dwordx4 v11, s[16:19], s35 offen offset:3072 lds
    s_waitcnt lgkmcnt(6)
    v_mfma_f32_16x16x32_bf16 a[16:19], v[172:175], v[116:119], a[16:19]
    s_add_u32 s36, s32, 53248
    s_add_u32 m0, s29, 4096
    s_add_u32 s35, s32, 40960
    v_mfma_f32_16x16x32_bf16 a[48:51], v[172:175], v[124:127], a[48:51]
    buffer_load_dwordx4 v8, s[16:19], s36 offen lds
    v_mfma_f32_16x16x32_bf16 a[80:83], v[172:175], v[132:135], a[80:83]
    buffer_load_dwordx4 v9, s[16:19], s36 offen offset:1024 lds
    v_mfma_f32_16x16x32_bf16 a[112:115], v[172:175], v[140:143], a[112:115]
    buffer_load_dwordx4 v10, s[16:19], s36 offen offset:2048 lds
    v_mfma_f32_16x16x32_bf16 a[144:147], v[172:175], v[148:151], a[144:147]
    buffer_load_dwordx4 v11, s[16:19], s36 offen offset:3072 lds
    s_waitcnt lgkmcnt(4)
    v_mfma_f32_16x16x32_bf16 a[20:23], v[176:179], v[116:119], a[20:23]
    s_waitcnt vmcnt(12)
    ds_read_b64_tr_b16 v[172:173], v16 offset:8192
    v_mfma_f32_16x16x32_bf16 a[52:55], v[176:179], v[124:127], a[52:55]
    s_waitcnt vmcnt(8)
    ds_read_b64_tr_b16 v[174:175], v16 offset:12288
    v_mfma_f32_16x16x32_bf16 a[84:87], v[176:179], v[132:135], a[84:87]
    s_add_u32 m0, s29, 24576
    s_add_u32 s36, s32, 45056
    s_waitcnt lgkmcnt(3)
    buffer_load_dwordx4 v8, s[20:23], s35 offen lds
    v_mfma_f32_16x16x32_bf16 a[116:119], v[176:179], v[140:143], a[116:119]
    buffer_load_dwordx4 v9, s[20:23], s35 offen offset:1024 lds
    v_mfma_f32_16x16x32_bf16 a[148:151], v[176:179], v[148:151], a[148:151]
    buffer_load_dwordx4 v10, s[20:23], s35 offen offset:2048 lds
    v_mfma_f32_16x16x32_bf16 a[24:27], v[180:183], v[116:119], a[24:27]
    buffer_load_dwordx4 v11, s[20:23], s35 offen offset:3072 lds
    v_mfma_f32_16x16x32_bf16 a[56:59], v[180:183], v[124:127], a[56:59]
    ds_read_b64_tr_b16 v[176:177], v17 offset:8192
    v_mfma_f32_16x16x32_bf16 a[88:91], v[180:183], v[132:135], a[88:91]
    ds_read_b64_tr_b16 v[178:179], v17 offset:12288
    v_mfma_f32_16x16x32_bf16 a[120:123], v[180:183], v[140:143], a[120:123]
    s_add_u32 m0, s29, 28672
    v_max3_f32 v63, v76, v77, v78
    s_waitcnt lgkmcnt(4)
    buffer_load_dwordx4 v8, s[20:23], s36 offen lds
    v_mfma_f32_16x16x32_bf16 a[152:155], v[180:183], v[148:151], a[152:155]
    buffer_load_dwordx4 v9, s[20:23], s36 offen offset:1024 lds
    v_mfma_f32_16x16x32_bf16 a[28:31], v[184:187], v[116:119], a[28:31]
    buffer_load_dwordx4 v10, s[20:23], s36 offen offset:2048 lds
    v_mfma_f32_16x16x32_bf16 a[60:63], v[184:187], v[124:127], a[60:63]
    buffer_load_dwordx4 v11, s[20:23], s36 offen offset:3072 lds
    v_mfma_f32_16x16x32_bf16 a[92:95], v[184:187], v[132:135], a[92:95]
    ds_read_b64_tr_b16 v[180:181], v18 offset:8192
    v_mfma_f32_16x16x32_bf16 a[124:127], v[184:187], v[140:143], a[124:127]
    ds_read_b64_tr_b16 v[182:183], v18 offset:12288
    v_mfma_f32_16x16x32_bf16 a[156:159], v[184:187], v[148:151], a[156:159]
    ds_read_b64_tr_b16 v[184:185], v19 offset:8192
    v_mfma_f32_16x16x32_bf16 v[116:119], v[156:159], a[160:163], 0
    ds_read_b64_tr_b16 v[186:187], v19 offset:12288
    v_mfma_f32_16x16x32_bf16 v[124:127], v[156:159], a[176:179], 0
    v_max3_f32 v63, v63, v79, v80
    v_max3_f32 v63, v63, v81, v82
    v_mfma_f32_16x16x32_bf16 v[132:135], v[156:159], a[192:195], 0
    v_max_f32 v63, v63, v83
    v_max3_f32 v64, v84, v85, v86
    v_mfma_f32_16x16x32_bf16 v[140:143], v[156:159], a[208:211], 0
    v_max3_f32 v64, v64, v87, v88
    v_max3_f32 v64, v64, v89, v90
    v_mfma_f32_16x16x32_bf16 v[148:151], v[156:159], a[224:227], 0
    ds_read_b128 v[156:159], v12 offset:20480
    v_mfma_f32_16x16x32_bf16 v[116:119], v[160:163], a[164:167], v[116:119]
    v_max_f32 v64, v64, v91
    v_max3_f32 v65, v92, v93, v94
    v_mfma_f32_16x16x32_bf16 v[124:127], v[160:163], a[180:183], v[124:127]
    v_max3_f32 v65, v65, v95, v96
    v_max3_f32 v65, v65, v97, v98
    v_mfma_f32_16x16x32_bf16 v[132:135], v[160:163], a[196:199], v[132:135]
    v_max_f32 v65, v65, v99
    v_max3_f32 v66, v100, v101, v102
    v_mfma_f32_16x16x32_bf16 v[140:143], v[160:163], a[212:215], v[140:143]
    v_max3_f32 v66, v66, v103, v104
    v_max3_f32 v66, v66, v105, v106
    v_mfma_f32_16x16x32_bf16 v[148:151], v[160:163], a[228:231], v[148:151]
    ds_read_b128 v[160:163], v13 offset:20480
    v_mfma_f32_16x16x32_bf16 v[116:119], v[164:167], a[168:171], v[116:119]
    v_max_f32 v66, v66, v107
    v_max3_f32 v67, v108, v109, v110
    v_mfma_f32_16x16x32_bf16 v[124:127], v[164:167], a[184:187], v[124:127]
    v_max3_f32 v67, v67, v111, v112
    v_max3_f32 v67, v67, v113, v114
    v_mfma_f32_16x16x32_bf16 v[132:135], v[164:167], a[200:203], v[132:135]
    v_max_f32 v67, v67, v115
    v_cmp_gt_f32 s[44:45], v63, v58
    v_mfma_f32_16x16x32_bf16 v[140:143], v[164:167], a[216:219], v[140:143]
    v_cmp_gt_f32 s[46:47], v64, v59
    v_cmp_gt_f32 s[48:49], v65, v60
    v_mfma_f32_16x16x32_bf16 v[148:151], v[164:167], a[232:235], v[148:151]
    ds_read_b128 v[164:167], v14 offset:20480
    v_mfma_f32_16x16x32_bf16 v[116:119], v[168:171], a[172:175], v[116:119]
    v_cmp_gt_f32 s[50:51], v66, v61
    v_cmp_gt_f32 s[52:53], v67, v62
    v_mfma_f32_16x16x32_bf16 v[124:127], v[168:171], a[188:191], v[124:127]
    s_or_b64 s[44:45], s[44:45], s[46:47]
    s_or_b64 s[44:45], s[44:45], s[48:49]
    s_or_b64 s[44:45], s[44:45], s[50:51]
    v_mfma_f32_16x16x32_bf16 v[132:135], v[168:171], a[204:207], v[132:135]
    s_or_b64 s[44:45], s[44:45], s[52:53]
    s_cbranch_scc1 L_slow4
L_ret4:
    v_fma_f32 v76, v76, s30, v53
    v_mfma_f32_16x16x32_bf16 v[140:143], v[168:171], a[220:223], v[140:143]
    v_exp_f32 v76, v76
    v_mfma_f32_16x16x32_bf16 v[148:151], v[168:171], a[236:239], v[148:151]
    ds_read_b128 v[168:171], v15 offset:20480
    s_waitcnt lgkmcnt(3)
    v_mfma_f32_16x16x32_bf16 v[120:123], v[156:159], a[160:163], 0
    v_fma_f32 v77, v77, s30, v53
    v_exp_f32 v77, v77
    v_mfma_f32_16x16x32_bf16 v[128:131], v[156:159], a[176:179], 0
    v_fma_f32 v78, v78, s30, v53
    v_exp_f32 v78, v78
    v_mfma_f32_16x16x32_bf16 v[136:139], v[156:159], a[192:195], 0
    v_fma_f32 v79, v79, s30, v53
    v_exp_f32 v79, v79
    v_mfma_f32_16x16x32_bf16 v[144:147], v[156:159], a[208:211], 0
    v_fma_f32 v80, v80, s30, v53
    v_exp_f32 v80, v80
    v_mfma_f32_16x16x32_bf16 v[152:155], v[156:159], a[224:227], 0
    s_waitcnt vmcnt(12)
    ds_read_b128 v[156:159], v12
    s_waitcnt lgkmcnt(3)
    v_mfma_f32_16x16x32_bf16 v[120:123], v[160:163], a[164:167], v[120:123]
    v_fma_f32 v81, v81, s30, v53
    v_exp_f32 v81, v81
    v_mfma_f32_16x16x32_bf16 v[128:131], v[160:163], a[180:183], v[128:131]
    v_fma_f32 v82, v82, s30, v53
    v_exp_f32 v82, v82
    v_mfma_f32_16x16x32_bf16 v[136:139], v[160:163], a[196:199], v[136:139]
    v_fma_f32 v83, v83, s30, v53
    v_exp_f32 v83, v83
    v_mfma_f32_16x16x32_bf16 v[144:147], v[160:163], a[212:215], v[144:147]
    v_cvt_pk_bf16_f32 v76, v76, v77
    v_cvt_pk_bf16_f32 v77, v78, v79
    v_mfma_f32_16x16x32_bf16 v[152:155], v[160:163], a[228:231], v[152:155]
    ds_read_b128 v[160:163], v13
    s_waitcnt lgkmcnt(3)
    v_mfma_f32_16x16x32_bf16 v[120:123], v[164:167], a[168:171], v[120:123]
    v_cvt_pk_bf16_f32 v78, v80, v81
    v_cvt_pk_bf16_f32 v79, v82, v83
    v_mfma_f32_16x16x32_bf16 v[128:131], v[164:167], a[184:187], v[128:131]
    v_fma_f32 v84, v84, s30, v54
    v_exp_f32 v84, v84
    v_mfma_f32_16x16x32_bf16 v[136:139], v[164:167], a[200:203], v[136:139]
    v_fma_f32 v85, v85, s30, v54
    v_exp_f32 v85, v85
    v_mfma_f32_16x16x32_bf16 v[144:147], v[164:167], a[216:219], v[144:147]
    v_fma_f32 v86, v86, s30, v54
    v_exp_f32 v86, v86
    v_mfma_f32_16x16x32_bf16 v[152:155], v[164:167], a[232:235], v[152:155]
    ds_read_b128 v[164:167], v14
    s_waitcnt lgkmcnt(3)
    v_mfma_f32_16x16x32_bf16 v[120:123], v[168:171], a[172:175], v[120:123]
    v_fma_f32 v87, v87, s30, v54
    v_exp_f32 v87, v87
    v_mfma_f32_16x16x32_bf16 v[128:131], v[168:171], a[188:191], v[128:131]
    v_fma_f32 v88, v88, s30, v54
    v_exp_f32 v88, v88
    v_mfma_f32_16x16x32_bf16 v[136:139], v[168:171], a[204:207], v[136:139]
    v_fma_f32 v89, v89, s30, v54
    v_exp_f32 v89, v89
    v_mfma_f32_16x16x32_bf16 v[144:147], v[168:171], a[220:223], v[144:147]
    v_fma_f32 v90, v90, s30, v54
    v_exp_f32 v90, v90
    v_mfma_f32_16x16x32_bf16 v[152:155], v[168:171], a[236:239], v[152:155]
    ds_read_b128 v[168:171], v15
    v_mfma_f32_16x16x32_bf16 a[0:3], v[172:175], v[76:79], a[0:3]
    v_fma_f32 v91, v91, s30, v54
    v_exp_f32 v91, v91
    v_mfma_f32_16x16x32_bf16 a[4:7], v[176:179], v[76:79], a[4:7]
    v_cvt_pk_bf16_f32 v84, v84, v85
    v_cvt_pk_bf16_f32 v85, v86, v87
    v_mfma_f32_16x16x32_bf16 a[8:11], v[180:183], v[76:79], a[8:11]
    v_cvt_pk_bf16_f32 v86, v88, v89
    v_cvt_pk_bf16_f32 v87, v90, v91
    v_mfma_f32_16x16x32_bf16 a[12:15], v[184:187], v[76:79], a[12:15]
    v_fma_f32 v92, v92, s30, v55
    v_exp_f32 v92, v92
    v_mfma_f32_16x16x32_bf16 a[32:35], v[172:175], v[84:87], a[32:35]
    v_fma_f32 v93, v93, s30, v55
    v_exp_f32 v93, v93
    v_mfma_f32_16x16x32_bf16 a[36:39], v[176:179], v[84:87], a[36:39]
    v_fma_f32 v94, v94, s30, v55
    v_exp_f32 v94, v94
    v_mfma_f32_16x16x32_bf16 a[40:43], v[180:183], v[84:87], a[40:43]
    v_fma_f32 v95, v95, s30, v55
    v_exp_f32 v95, v95
    v_mfma_f32_16x16x32_bf16 a[44:47], v[184:187], v[84:87], a[44:47]
    v_fma_f32 v96, v96, s30, v55
    v_exp_f32 v96, v96
    v_mfma_f32_16x16x32_bf16 v[28:31], v[24:27], v[76:79], v[28:31]
    v_fma_f32 v97, v97, s30, v55
    v_exp_f32 v97, v97
    v_mfma_f32_16x16x32_bf16 v[32:35], v[24:27], v[84:87], v[32:35]
    v_fma_f32 v98, v98, s30, v55
    v_exp_f32 v98, v98
    v_fma_f32 v99, v99, s30, v55
    v_exp_f32 v99, v99
    v_cvt_pk_bf16_f32 v92, v92, v93
    v_cvt_pk_bf16_f32 v93, v94, v95
    v_cvt_pk_bf16_f32 v94, v96, v97
    v_cvt_pk_bf16_f32 v95, v98, v99
    v_fma_f32 v100, v100, s30, v56
    v_exp_f32 v100, v100
    v_mfma_f32_16x16x32_bf16 a[64:67], v[172:175], v[92:95], a[64:67]
    v_fma_f32 v101, v101, s30, v56
    v_exp_f32 v101, v101
    v_mfma_f32_16x16x32_bf16 a[68:71], v[176:179], v[92:95], a[68:71]
    v_fma_f32 v102, v102, s30, v56
    v_exp_f32 v102, v102
    v_mfma_f32_16x16x32_bf16 a[72:75], v[180:183], v[92:95], a[72:75]
    v_fma_f32 v103, v103, s30, v56
    v_exp_f32 v103, v103
    v_mfma_f32_16x16x32_bf16 a[76:79], v[184:187], v[92:95], a[76:79]
    v_fma_f32 v104, v104, s30, v56
    v_exp_f32 v104, v104
    v_mfma_f32_16x16x32_bf16 v[36:39], v[24:27], v[92:95], v[36:39]
    v_fma_f32 v105, v105, s30, v56
    v_exp_f32 v105, v105
    v_fma_f32 v106, v106, s30, v56
    v_exp_f32 v106, v106
    v_fma_f32 v107, v107, s30, v56
    v_exp_f32 v107, v107
    v_cvt_pk_bf16_f32 v100, v100, v101
    v_cvt_pk_bf16_f32 v101, v102, v103
    v_cvt_pk_bf16_f32 v102, v104, v105
    v_cvt_pk_bf16_f32 v103, v106, v107
    v_fma_f32 v108, v108, s30, v57
    v_exp_f32 v108, v108
    v_mfma_f32_16x16x32_bf16 a[96:99], v[172:175], v[100:103], a[96:99]
    v_fma_f32 v109, v109, s30, v57
    v_exp_f32 v109, v109
    v_mfma_f32_16x16x32_bf16 a[100:103], v[176:179], v[100:103], a[100:103]
    v_fma_f32 v110, v110, s30, v57
    v_exp_f32 v110, v110
    v_mfma_f32_16x16x32_bf16 a[104:107], v[180:183], v[100:103], a[104:107]
    v_fma_f32 v111, v111, s30, v57
    v_exp_f32 v111, v111
    v_mfma_f32_16x16x32_bf16 a[108:111], v[184:187], v[100:103], a[108:111]
    v_fma_f32 v112, v112, s30, v57
    v_exp_f32 v112, v112
    v_mfma_f32_16x16x32_bf16 v[40:43], v[24:27], v[100:103], v[40:43]
    v_fma_f32 v113, v113, s30, v57
    v_exp_f32 v113, v113
    v_fma_f32 v114, v114, s30, v57
    v_exp_f32 v114, v114
    v_fma_f32 v115, v115, s30, v57
    v_exp_f32 v115, v115
    v_cvt_pk_bf16_f32 v108, v108, v109
    v_cvt_pk_bf16_f32 v109, v110, v111
    v_cvt_pk_bf16_f32 v110, v112, v113
    v_cvt_pk_bf16_f32 v111, v114, v115
    s_add_u32 s39, s32, 57344
    s_add_u32 m0, s29, 16384
    v_mfma_f32_16x16x32_bf16 a[128:131], v[172:175], v[108:111], a[128:131]
    ds_read_b64_tr_b16 v[172:173], v20 offset:8192
    v_mfma_f32_16x16x32_bf16 a[132:135], v[176:179], v[108:111], a[132:135]
    ds_read_b64_tr_b16 v[174:175], v20 offset:12288
    v_mfma_f32_16x16x32_bf16 a[136:139], v[180:183], v[108:111], a[136:139]
    ds_read_b64_tr_b16 v[176:177], v21 offset:8192
    v_mfma_f32_16x16x32_bf16 a[140:143], v[184:187], v[108:111], a[140:143]
    ds_read_b64_tr_b16 v[178:179], v21 offset:12288
    v_mfma_f32_16x16x32_bf16 v[44:47], v[24:27], v[108:111], v[44:47]
    ds_read_b64_tr_b16 v[180:181], v22 offset:8192
    ds_read_b64_tr_b16 v[182:183], v22 offset:12288
    ds_read_b64_tr_b16 v[184:185], v23 offset:8192
    ds_read_b64_tr_b16 v[186:187], v23 offset:12288
    buffer_load_dwordx4 v8, s[16:19], s39 offen lds
    buffer_load_dwordx4 v9, s[16:19], s39 offen offset:1024 lds
    buffer_load_dwordx4 v10, s[16:19], s39 offen offset:2048 lds
    buffer_load_dwordx4 v11, s[16:19], s39 offen offset:3072 lds
    s_waitcnt lgkmcnt(6)
    v_mfma_f32_16x16x32_bf16 a[16:19], v[172:175], v[76:79], a[16:19]
    s_add_u32 s40, s32, 61440
    s_add_u32 m0, s29, 20480
    s_add_u32 s37, s32, 49152
    v_mfma_f32_16x16x32_bf16 a[48:51], v[172:175], v[84:87], a[48:51]
    buffer_load_dwordx4 v8, s[16:19], s40 offen lds
    v_mfma_f32_16x16x32_bf16 a[80:83], v[172:175], v[92:95], a[80:83]
    buffer_load_dwordx4 v9, s[16:19], s40 offen offset:1024 lds
    v_mfma_f32_16x16x32_bf16 a[112:115], v[172:175], v[100:103], a[112:115]
    buffer_load_dwordx4 v10, s[16:19], s40 offen offset:2048 lds
    v_mfma_f32_16x16x32_bf16 a[144:147], v[172:175], v[108:111], a[144:147]
    buffer_load_dwordx4 v11, s[16:19], s40 offen offset:3072 lds
    s_waitcnt lgkmcnt(4)
    v_mfma_f32_16x16x32_bf16 a[20:23], v[176:179], v[76:79], a[20:23]
    s_waitcnt vmcnt(12)
    ds_read_b64_tr_b16 v[172:173], v16 offset:24576
    v_mfma_f32_16x16x32_bf16 a[52:55], v[176:179], v[84:87], a[52:55]
    s_waitcnt vmcnt(8)
    ds_read_b64_tr_b16 v[174:175], v16 offset:28672
    v_mfma_f32_16x16x32_bf16 a[84:87], v[176:179], v[92:95], a[84:87]
    s_add_u32 m0, s29, 8192
    s_add_u32 s38, s32, 53248
    s_waitcnt lgkmcnt(3)
    buffer_load_dwordx4 v8, s[20:23], s37 offen lds
    v_mfma_f32_16x16x32_bf16 a[116:119], v[176:179], v[100:103], a[116:119]
    buffer_load_dwordx4 v9, s[20:23], s37 offen offset:1024 lds
    v_mfma_f32_16x16x32_bf16 a[148:151], v[176:179], v[108:111], a[148:151]
    buffer_load_dwordx4 v10, s[20:23], s37 offen offset:2048 lds
    v_mfma_f32_16x16x32_bf16 a[24:27], v[180:183], v[76:79], a[24:27]
    buffer_load_dwordx4 v11, s[20:23], s37 offen offset:3072 lds
    v_mfma_f32_16x16x32_bf16 a[56:59], v[180:183], v[84:87], a[56:59]
    ds_read_b64_tr_b16 v[176:177], v17 offset:24576
    v_mfma_f32_16x16x32_bf16 a[88:91], v[180:183], v[92:95], a[88:91]
    ds_read_b64_tr_b16 v[178:179], v17 offset:28672
    v_mfma_f32_16x16x32_bf16 a[120:123], v[180:183], v[100:103], a[120:123]
    s_add_u32 m0, s29, 12288
    v_max3_f32 v63, v116, v117, v118
    s_waitcnt lgkmcnt(4)
    buffer_load_dwordx4 v8, s[20:23], s38 offen lds
    v_mfma_f32_16x16x32_bf16 a[152:155], v[180:183], v[108:111], a[152:155]
    buffer_load_dwordx4 v9, s[20:23], s38 offen offset:1024 lds
    v_mfma_f32_16x16x32_bf16 a[28:31], v[184:187], v[76:79], a[28:31]
    buffer_load_dwordx4 v10, s[20:23], s38 offen offset:2048 lds
    v_mfma_f32_16x16x32_bf16 a[60:63], v[184:187], v[84:87], a[60:63]
    buffer_load_dwordx4 v11, s[20:23], s38 offen offset:3072 lds
    v_mfma_f32_16x16x32_bf16 a[92:95], v[184:187], v[92:95], a[92:95]
    ds_read_b64_tr_b16 v[180:181], v18 offset:24576
    v_mfma_f32_16x16x32_bf16 a[124:127], v[184:187], v[100:103], a[124:127]
    ds_read_b64_tr_b16 v[182:183], v18 offset:28672
    v_mfma_f32_16x16x32_bf16 a[156:159], v[184:187], v[108:111], a[156:159]
    ds_read_b64_tr_b16 v[184:185], v19 offset:24576
    v_mfma_f32_16x16x32_bf16 v[76:79], v[156:159], a[160:163], 0
    ds_read_b64_tr_b16 v[186:187], v19 offset:28672
    v_mfma_f32_16x16x32_bf16 v[84:87], v[156:159], a[176:179], 0
    v_max3_f32 v63, v63, v119, v120
    v_max3_f32 v63, v63, v121, v122
    v_mfma_f32_16x16x32_bf16 v[92:95], v[156:159], a[192:195], 0
    v_max_f32 v63, v63, v123
    v_max3_f32 v64, v124, v125, v126
    v_mfma_f32_16x16x32_bf16 v[100:103], v[156:159], a[208:211], 0
    v_max3_f32 v64, v64, v127, v128
    v_max3_f32 v64, v64, v129, v130
    v_mfma_f32_16x16x32_bf16 v[108:111], v[156:159], a[224:227], 0
    ds_read_b128 v[156:159], v12 offset:4096
    v_mfma_f32_16x16x32_bf16 v[76:79], v[160:163], a[164:167], v[76:79]
    v_max_f32 v64, v64, v131
    v_max3_f32 v65, v132, v133, v134
    v_mfma_f32_16x16x32_bf16 v[84:87], v[160:163], a[180:183], v[84:87]
    v_max3_f32 v65, v65, v135, v136
    v_max3_f32 v65, v65, v137, v138
    v_mfma_f32_16x16x32_bf16 v[92:95], v[160:163], a[196:199], v[92:95]
    v_max_f32 v65, v65, v139
    v_max3_f32 v66, v140, v141, v142
    v_mfma_f32_16x16x32_bf16 v[100:103], v[160:163], a[212:215], v[100:103]
    v_max3_f32 v66, v66, v143, v144
    v_max3_f32 v66, v66, v145, v146
    v_mfma_f32_16x16x32_bf16 v[108:111], v[160:163], a[228:231], v[108:111]
    ds_read_b128 v[160:163], v13 offset:4096
    v_mfma_f32_16x16x32_bf16 v[76:79], v[164:167], a[168:171], v[76:79]
    v_max_f32 v66, v66, v147
    v_max3_f32 v67, v148, v149, v150
    v_mfma_f32_16x16x32_bf16 v[84:87], v[164:167], a[184:187], v[84:87]
    v_max3_f32 v67, v67, v151, v152
    v_max3_f32 v67, v67, v153, v154
    v_mfma_f32_16x16x32_bf16 v[92:95], v[164:167], a[200:203], v[92:95]
    v_max_f32 v67, v67, v155
    v_cmp_gt_f32 s[44:45], v63, v58
    v_mfma_f32_16x16x32_bf16 v[100:103], v[164:167], a[216:219], v[100:103]
    v_cmp_gt_f32 s[46:47], v64, v59
    v_cmp_gt_f32 s[48:49], v65, v60
    v_mfma_f32_16x16x32_bf16 v[108:111], v[164:167], a[232:235], v[108:111]
    ds_read_b128 v[164:167], v14 offset:4096
    v_mfma_f32_16x16x32_bf16 v[76:79], v[168:171], a[172:175], v[76:79]
    v_cmp_gt_f32 s[50:51], v66, v61
    v_cmp_gt_f32 s[52:53], v67, v62
    v_mfma_f32_16x16x32_bf16 v[84:87], v[168:171], a[188:191], v[84:87]
    s_or_b64 s[44:45], s[44:45], s[46:47]
    s_or_b64 s[44:45], s[44:45], s[48:49]
    s_or_b64 s[44:45], s[44:45], s[50:51]
    v_mfma_f32_16x16x32_bf16 v[92:95], v[168:171], a[204:207], v[92:95]
    s_or_b64 s[44:45], s[44:45], s[52:53]
    s_cbranch_scc1 L_slow5
L_ret5:
    v_fma_f32 v116, v116, s30, v53
    v_mfma_f32_16x16x32_bf16 v[100:103], v[168:171], a[220:223], v[100:103]
    v_exp_f32 v116, v116
    v_mfma_f32_16x16x32_bf16 v[108:111], v[168:171], a[236:239], v[108:111]
    ds_read_b128 v[168:171], v15 offset:4096
    s_waitcnt lgkmcnt(3)
    v_mfma_f32_16x16x32_bf16 v[80:83], v[156:159], a[160:163], 0
    v_fma_f32 v117, v117, s30, v53
    v_exp_f32 v117, v117
    v_mfma_f32_16x16x32_bf16 v[88:91], v[156:159], a[176:179], 0
    v_fma_f32 v118, v118, s30, v53
    v_exp_f32 v118, v118
    v_mfma_f32_16x16x32_bf16 v[96:99], v[156:159], a[192:195], 0
    v_fma_f32 v119, v119, s30, v53
    v_exp_f32 v119, v119
    v_mfma_f32_16x16x32_bf16 v[104:107], v[156:159], a[208:211], 0
    v_fma_f32 v120, v120, s30, v53
    v_exp_f32 v120, v120
    v_mfma_f32_16x16x32_bf16 v[112:115], v[156:159], a[224:227], 0
    s_waitcnt vmcnt(12)
    ds_read_b128 v[156:159], v12 offset:16384
    s_waitcnt lgkmcnt(3)
    v_mfma_f32_16x16x32_bf16 v[80:83], v[160:163], a[164:167], v[80:83]
    v_fma_f32 v121, v121, s30, v53
    v_exp_f32 v121, v121
    v_mfma_f32_16x16x32_bf16 v[88:91], v[160:163], a[180:183], v[88:91]
    v_fma_f32 v122, v122, s30, v53
    v_exp_f32 v122, v122
    v_mfma_f32_16x16x32_bf16 v[96:99], v[160:163], a[196:199], v[96:99]
    v_fma_f32 v123, v123, s30, v53
    v_exp_f32 v123, v123
    v_mfma_f32_16x16x32_bf16 v[104:107], v[160:163], a[212:215], v[104:107]
    v_cvt_pk_bf16_f32 v116, v116, v117
    v_cvt_pk_bf16_f32 v117, v118, v119
    v_mfma_f32_16x16x32_bf16 v[112:115], v[160:163], a[228:231], v[112:115]
    ds_read_b128 v[160:163], v13 offset:16384
    s_waitcnt lgkmcnt(3)
    v_mfma_f32_16x16x32_bf16 v[80:83], v[164:167], a[168:171], v[80:83]
    v_cvt_pk_bf16_f32 v118, v120, v121
    v_cvt_pk_bf16_f32 v119, v122, v123
    v_mfma_f32_16x16x32_bf16 v[88:91], v[164:167], a[184:187], v[88:91]
    v_fma_f32 v124, v124, s30, v54
    v_exp_f32 v124, v124
    v_mfma_f32_16x16x32_bf16 v[96:99], v[164:167], a[200:203], v[96:99]
    v_fma_f32 v125, v125, s30, v54
    v_exp_f32 v125, v125
    v_mfma_f32_16x16x32_bf16 v[104:107], v[164:167], a[216:219], v[104:107]
    v_fma_f32 v126, v126, s30, v54
    v_exp_f32 v126, v126
    v_mfma_f32_16x16x32_bf16 v[112:115], v[164:167], a[232:235], v[112:115]
    ds_read_b128 v[164:167], v14 offset:16384
    s_waitcnt lgkmcnt(3)
    v_mfma_f32_16x16x32_bf16 v[80:83], v[168:171], a[172:175], v[80:83]
    v_fma_f32 v127, v127, s30, v54
    v_exp_f32 v127, v127
    v_mfma_f32_16x16x32_bf16 v[88:91], v[168:171], a[188:191], v[88:91]
    v_fma_f32 v128, v128, s30, v54
    v_exp_f32 v128, v128
    v_mfma_f32_16x16x32_bf16 v[96:99], v[168:171], a[204:207], v[96:99]
    v_fma_f32 v129, v129, s30, v54
    v_exp_f32 v129, v129
    v_mfma_f32_16x16x32_bf16 v[104:107], v[168:171], a[220:223], v[104:107]
    v_fma_f32 v130, v130, s30, v54
    v_exp_f32 v130, v130
    v_mfma_f32_16x16x32_bf16 v[112:115], v[168:171], a[236:239], v[112:115]
    ds_read_b128 v[168:171], v15 offset:16384
    v_mfma_f32_16x16x32_bf16 a[0:3], v[172:175], v[116:119], a[0:3]
    v_fma_f32 v131, v131, s30, v54
    v_exp_f32 v131, v131
    v_mfma_f32_16x16x32_bf16 a[4:7], v[176:179], v[116:119], a[4:7]
    v_cvt_pk_bf16_f32 v124, v124, v125
    v_cvt_pk_bf16_f32 v125, v126, v127
    v_mfma_f32_16x16x32_bf16 a[8:11], v[180:183], v[116:119], a[8:11]
    v_cvt_pk_bf16_f32 v126, v128, v129
    v_cvt_pk_bf16_f32 v127, v130, v131
    v_mfma_f32_16x16x32_bf16 a[12:15], v[184:187], v[116:119], a[12:15]
    v_fma_f32 v132, v132, s30, v55
    v_exp_f32 v132, v132
    v_mfma_f32_16x16x32_bf16 a[32:35], v[172:175], v[124:127], a[32:35]
    v_fma_f32 v133, v133, s30, v55
    v_exp_f32 v133, v133
    v_mfma_f32_16x16x32_bf16 a[36:39], v[176:179], v[124:127], a[36:39]
    v_fma_f32 v134, v134, s30, v55
    v_exp_f32 v134, v134
    v_mfma_f32_16x16x32_bf16 a[40:43], v[180:183], v[124:127], a[40:43]
    v_fma_f32 v135, v135, s30, v55
    v_exp_f32 v135, v135
    v_mfma_f32_16x16x32_bf16 a[44:47], v[184:187], v[124:127], a[44:47]
    v_fma_f32 v136, v136, s30, v55
    v_exp_f32 v136, v136
    v_mfma_f32_16x16x32_bf16 v[28:31], v[24:27], v[116:119], v[28:31]
    v_fma_f32 v137, v137, s30, v55
    v_exp_f32 v137, v137
    v_mfma_f32_16x16x32_bf16 v[32:35], v[24:27], v[124:127], v[32:35]
    v_fma_f32 v138, v138, s30, v55
    v_exp_f32 v138, v138
    v_fma_f32 v139, v139, s30, v55
    v_exp_f32 v139, v139
    v_cvt_pk_bf16_f32 v132, v132, v133
    v_cvt_pk_bf16_f32 v133, v134, v135
    v_cvt_pk_bf16_f32 v134, v136, v137
    v_cvt_pk_bf16_f32 v135, v138, v139
    v_fma_f32 v140, v140, s30, v56
    v_exp_f32 v140, v140
    v_mfma_f32_16x16x32_bf16 a[64:67], v[172:175], v[132:135], a[64:67]
    v_fma_f32 v141, v141, s30, v56
    v_exp_f32 v141, v141
    v_mfma_f32_16x16x32_bf16 a[68:71], v[176:179], v[132:135], a[68:71]
    v_fma_f32 v142, v142, s30, v56
    v_exp_f32 v142, v142
    v_mfma_f32_16x16x32_bf16 a[72:75], v[180:183], v[132:135], a[72:75]
    v_fma_f32 v143, v143, s30, v56
    v_exp_f32 v143, v143
    v_mfma_f32_16x16x32_bf16 a[76:79], v[184:187], v[132:135], a[76:79]
    v_fma_f32 v144, v144, s30, v56
    v_exp_f32 v144, v144
    v_mfma_f32_16x16x32_bf16 v[36:39], v[24:27], v[132:135], v[36:39]
    v_fma_f32 v145, v145, s30, v56
    v_exp_f32 v145, v145
    v_fma_f32 v146, v146, s30, v56
    v_exp_f32 v146, v146
    v_fma_f32 v147, v147, s30, v56
    v_exp_f32 v147, v147
    v_cvt_pk_bf16_f32 v140, v140, v141
    v_cvt_pk_bf16_f32 v141, v142, v143
    v_cvt_pk_bf16_f32 v142, v144, v145
    v_cvt_pk_bf16_f32 v143, v146, v147
    v_fma_f32 v148, v148, s30, v57
    v_exp_f32 v148, v148
    v_mfma_f32_16x16x32_bf16 a[96:99], v[172:175], v[140:143], a[96:99]
    v_fma_f32 v149, v149, s30, v57
    v_exp_f32 v149, v149
    v_mfma_f32_16x16x32_bf16 a[100:103], v[176:179], v[140:143], a[100:103]
    v_fma_f32 v150, v150, s30, v57
    v_exp_f32 v150, v150
    v_mfma_f32_16x16x32_bf16 a[104:107], v[180:183], v[140:143], a[104:107]
    v_fma_f32 v151, v151, s30, v57
    v_exp_f32 v151, v151
    v_mfma_f32_16x16x32_bf16 a[108:111], v[184:187], v[140:143], a[108:111]
    v_fma_f32 v152, v152, s30, v57
    v_exp_f32 v152, v152
    v_mfma_f32_16x16x32_bf16 v[40:43], v[24:27], v[140:143], v[40:43]
    v_fma_f32 v153, v153, s30, v57
    v_exp_f32 v153, v153
    v_fma_f32 v154, v154, s30, v57
    v_exp_f32 v154, v154
    v_fma_f32 v155, v155, s30, v57
    v_exp_f32 v155, v155
    v_cvt_pk_bf16_f32 v148, v148, v149
    v_cvt_pk_bf16_f32 v149, v150, v151
    v_cvt_pk_bf16_f32 v150, v152, v153
    v_cvt_pk_bf16_f32 v151, v154, v155
    s_add_u32 s35, s32, 57344
    s_add_u32 m0, s29, 24576
    v_mfma_f32_16x16x32_bf16 a[128:131], v[172:175], v[148:151], a[128:131]
    ds_read_b64_tr_b16 v[172:173], v20 offset:24576
    v_mfma_f32_16x16x32_bf16 a[132:135], v[176:179], v[148:151], a[132:135]
    ds_read_b64_tr_b16 v[174:175], v20 offset:28672
    v_mfma_f32_16x16x32_bf16 a[136:139], v[180:183], v[148:151], a[136:139]
    ds_read_b64_tr_b16 v[176:177], v21 offset:24576
    v_mfma_f32_16x16x32_bf16 a[140:143], v[184:187], v[148:151], a[140:143]
    ds_read_b64_tr_b16 v[178:179], v21 offset:28672
    v_mfma_f32_16x16x32_bf16 v[44:47], v[24:27], v[148:151], v[44:47]
    ds_read_b64_tr_b16 v[180:181], v22 offset:24576
    ds_read_b64_tr_b16 v[182:183], v22 offset:28672
    ds_read_b64_tr_b16 v[184:185], v23 offset:24576
    ds_read_b64_tr_b16 v[186:187], v23 offset:28672
    s_waitcnt lgkmcnt(1)
    buffer_load_dwordx4 v8, s[20:23], s35 offen lds
    buffer_load_dwordx4 v9, s[20:23], s35 offen offset:1024 lds
    buffer_load_dwordx4 v10, s[20:23], s35 offen offset:2048 lds
    buffer_load_dwordx4 v11, s[20:23], s35 offen offset:3072 lds
    v_mfma_f32_16x16x32_bf16 a[16:19], v[172:175], v[116:119], a[16:19]
    s_add_u32 s36, s32, 61440
    s_add_u32 m0, s29, 28672
    v_max3_f32 v63, v76, v77, v78
    v_mfma_f32_16x16x32_bf16 a[48:51], v[172:175], v[124:127], a[48:51]
    s_waitcnt lgkmcnt(0)
    buffer_load_dwordx4 v8, s[20:23], s36 offen lds
    v_mfma_f32_16x16x32_bf16 a[80:83], v[172:175], v[132:135], a[80:83]
    buffer_load_dwordx4 v9, s[20:23], s36 offen offset:1024 lds
    v_mfma_f32_16x16x32_bf16 a[112:115], v[172:175], v[140:143], a[112:115]
    buffer_load_dwordx4 v10, s[20:23], s36 offen offset:2048 lds
    v_mfma_f32_16x16x32_bf16 a[144:147], v[172:175], v[148:151], a[144:147]
    buffer_load_dwordx4 v11, s[20:23], s36 offen offset:3072 lds
    v_mfma_f32_16x16x32_bf16 a[20:23], v[176:179], v[116:119], a[20:23]
    s_waitcnt vmcnt(12)
    ds_read_b64_tr_b16 v[172:173], v16 offset:8192
    v_mfma_f32_16x16x32_bf16 a[52:55], v[176:179], v[124:127], a[52:55]
    s_waitcnt vmcnt(8)
    ds_read_b64_tr_b16 v[174:175], v16 offset:12288
    v_mfma_f32_16x16x32_bf16 a[84:87], v[176:179], v[132:135], a[84:87]
    v_max3_f32 v63, v63, v79, v80
    v_max3_f32 v63, v63, v81, v82
    v_mfma_f32_16x16x32_bf16 a[116:119], v[176:179], v[140:143], a[116:119]
    v_max_f32 v63, v63, v83
    v_max3_f32 v64, v84, v85, v86
    v_mfma_f32_16x16x32_bf16 a[148:151], v[176:179], v[148:151], a[148:151]
    ds_read_b64_tr_b16 v[176:177], v17 offset:8192
    v_mfma_f32_16x16x32_bf16 a[24:27], v[180:183], v[116:119], a[24:27]
    ds_read_b64_tr_b16 v[178:179], v17 offset:12288
    v_mfma_f32_16x16x32_bf16 a[56:59], v[180:183], v[124:127], a[56:59]
    v_max3_f32 v64, v64, v87, v88
    v_max3_f32 v64, v64, v89, v90
    v_mfma_f32_16x16x32_bf16 a[88:91], v[180:183], v[132:135], a[88:91]
    v_max_f32 v64, v64, v91
    v_max3_f32 v65, v92, v93, v94
    v_mfma_f32_16x16x32_bf16 a[120:123], v[180:183], v[140:143], a[120:123]
    v_max3_f32 v65, v65, v95, v96
    v_max3_f32 v65, v65, v97, v98
    v_mfma_f32_16x16x32_bf16 a[152:155], v[180:183], v[148:151], a[152:155]
    ds_read_b64_tr_b16 v[180:181], v18 offset:8192
    v_mfma_f32_16x16x32_bf16 a[28:31], v[184:187], v[116:119], a[28:31]
    ds_read_b64_tr_b16 v[182:183], v18 offset:12288
    v_mfma_f32_16x16x32_bf16 a[60:63], v[184:187], v[124:127], a[60:63]
    v_max_f32 v65, v65, v99
    v_max3_f32 v66, v100, v101, v102
    v_mfma_f32_16x16x32_bf16 a[92:95], v[184:187], v[132:135], a[92:95]
    v_max3_f32 v66, v66, v103, v104
    v_max3_f32 v66, v66, v105, v106
    v_mfma_f32_16x16x32_bf16 a[124:127], v[184:187], v[140:143], a[124:127]
    v_max_f32 v66, v66, v107
    v_max3_f32 v67, v108, v109, v110
    v_mfma_f32_16x16x32_bf16 a[156:159], v[184:187], v[148:151], a[156:159]
    ds_read_b64_tr_b16 v[184:185], v19 offset:8192
    v_mfma_f32_16x16x32_bf16 v[116:119], v[156:159], a[160:163], 0
    ds_read_b64_tr_b16 v[186:187], v19 offset:12288
    v_mfma_f32_16x16x32_bf16 v[124:127], v[156:159], a[176:179], 0
    v_max3_f32 v67, v67, v111, v112
    v_max3_f32 v67, v67, v113, v114
    v_mfma_f32_16x16x32_bf16 v[132:135], v[156:159], a[192:195], 0
    v_max_f32 v67, v67, v115
    v_cmp_gt_f32 s[44:45], v63, v58
    v_mfma_f32_16x16x32_bf16 v[140:143], v[156:159], a[208:211], 0
    v_cmp_gt_f32 s[46:47], v64, v59
    v_cmp_gt_f32 s[48:49], v65, v60
    v_mfma_f32_16x16x32_bf16 v[148:151], v[156:159], a[224:227], 0
    ds_read_b128 v[156:159], v12 offset:20480
    v_mfma_f32_16x16x32_bf16 v[116:119], v[160:163], a[164:167], v[116:119]
    v_cmp_gt_f32 s[50:51], v66, v61
    v_cmp_gt_f32 s[52:53], v67, v62
    v_mfma_f32_16x16x32_bf16 v[124:127], v[160:163], a[180:183], v[124:127]
    s_or_b64 s[44:45], s[44:45], s[46:47]
    s_or_b64 s[44:45], s[44:45], s[48:49]
    s_or_b64 s[44:45], s[44:45], s[50:51]
    v_mfma_f32_16x16x32_bf16 v[132:135], v[160:163], a[196:199], v[132:135]
    s_or_b64 s[44:45], s[44:45], s[52:53]
    s_cbranch_scc1 L_slow6
L_ret6:
    v_fma_f32 v76, v76, s30, v53
    v_mfma_f32_16x16x32_bf16 v[140:143], v[160:163], a[212:215], v[140:143]
    v_exp_f32 v76, v76
    v_mfma_f32_16x16x32_bf16 v[148:151], v[160:163], a[228:231], v[148:151]
    ds_read_b128 v[160:163], v13 offset:20480
    v_mfma_f32_16x16x32_bf16 v[116:119], v[164:167], a[168:171], v[116:119]
    v_fma_f32 v77, v77, s30, v53
    v_exp_f32 v77, v77
    v_mfma_f32_16x16x32_bf16 v[124:127], v[164:167], a[184:187], v[124:127]
    v_fma_f32 v78, v78, s30, v53
    v_exp_f32 v78, v78
    v_mfma_f32_16x16x32_bf16 v[132:135], v[164:167], a[200:203], v[132:135]
    v_fma_f32 v79, v79, s30, v53
    v_exp_f32 v79, v79
    v_mfma_f32_16x16x32_bf16 v[140:143], v[164:167], a[216:219], v[140:143]
    v_fma_f32 v80, v80, s30, v53
    v_exp_f32 v80, v80
    v_mfma_f32_16x16x32_bf16 v[148:151], v[164:167], a[232:235], v[148:151]
    ds_read_b128 v[164:167], v14 offset:20480
    v_mfma_f32_16x16x32_bf16 v[116:119], v[168:171], a[172:175], v[116:119]
    v_fma_f32 v81, v81, s30, v53
    v_exp_f32 v81, v81
    v_mfma_f32_16x16x32_bf16 v[124:127], v[168:171], a[188:191], v[124:127]
    v_fma_f32 v82, v82, s30, v53
    v_exp_f32 v82, v82
    v_mfma_f32_16x16x32_bf16 v[132:135], v[168:171], a[204:207], v[132:135]
    v_fma_f32 v83, v83, s30, v53
    v_exp_f32 v83, v83
    v_mfma_f32_16x16x32_bf16 v[140:143], v[168:171], a[220:223], v[140:143]
    v_cvt_pk_bf16_f32 v76, v76, v77
    v_cvt_pk_bf16_f32 v77, v78, v79
    v_mfma_f32_16x16x32_bf16 v[148:151], v[168:171], a[236:239], v[148:151]
    ds_read_b128 v[168:171], v15 offset:20480
    s_waitcnt lgkmcnt(3)
    v_mfma_f32_16x16x32_bf16 v[120:123], v[156:159], a[160:163], 0
    v_cvt_pk_bf16_f32 v78, v80, v81
    v_cvt_pk_bf16_f32 v79, v82, v83
    v_mfma_f32_16x16x32_bf16 v[128:131], v[156:159], a[176:179], 0
    v_fma_f32 v84, v84, s30, v54
    v_exp_f32 v84, v84
    v_mfma_f32_16x16x32_bf16 v[136:139], v[156:159], a[192:195], 0
    v_fma_f32 v85, v85, s30, v54
    v_exp_f32 v85, v85
    v_mfma_f32_16x16x32_bf16 v[144:147], v[156:159], a[208:211], 0
    v_fma_f32 v86, v86, s30, v54
    v_exp_f32 v86, v86
    v_mfma_f32_16x16x32_bf16 v[152:155], v[156:159], a[224:227], 0
    v_fma_f32 v87, v87, s30, v54
    v_exp_f32 v87, v87
    s_waitcnt lgkmcnt(2)
    v_mfma_f32_16x16x32_bf16 v[120:123], v[160:163], a[164:167], v[120:123]
    v_fma_f32 v88, v88, s30, v54
    v_exp_f32 v88, v88
    v_mfma_f32_16x16x32_bf16 v[128:131], v[160:163], a[180:183], v[128:131]
    v_fma_f32 v89, v89, s30, v54
    v_exp_f32 v89, v89
    v_mfma_f32_16x16x32_bf16 v[136:139], v[160:163], a[196:199], v[136:139]
    v_fma_f32 v90, v90, s30, v54
    v_exp_f32 v90, v90
    v_mfma_f32_16x16x32_bf16 v[144:147], v[160:163], a[212:215], v[144:147]
    v_fma_f32 v91, v91, s30, v54
    v_exp_f32 v91, v91
    v_mfma_f32_16x16x32_bf16 v[152:155], v[160:163], a[228:231], v[152:155]
    v_cvt_pk_bf16_f32 v84, v84, v85
    v_cvt_pk_bf16_f32 v85, v86, v87
    s_waitcnt lgkmcnt(1)
    v_mfma_f32_16x16x32_bf16 v[120:123], v[164:167], a[168:171], v[120:123]
    v_cvt_pk_bf16_f32 v86, v88, v89
    v_cvt_pk_bf16_f32 v87, v90, v91
    v_mfma_f32_16x16x32_bf16 v[128:131], v[164:167], a[184:187], v[128:131]
    v_fma_f32 v92, v92, s30, v55
    v_exp_f32 v92, v92
    v_mfma_f32_16x16x32_bf16 v[136:139], v[164:167], a[200:203], v[136:139]
    v_fma_f32 v93, v93, s30, v55
    v_exp_f32 v93, v93
    v_mfma_f32_16x16x32_bf16 v[144:147], v[164:167], a[216:219], v[144:147]
    v_fma_f32 v94, v94, s30, v55
    v_exp_f32 v94, v94
    v_mfma_f32_16x16x32_bf16 v[152:155], v[164:167], a[232:235], v[152:155]
    v_fma_f32 v95, v95, s30, v55
    v_exp_f32 v95, v95
    s_waitcnt lgkmcnt(0)
    v_mfma_f32_16x16x32_bf16 v[120:123], v[168:171], a[172:175], v[120:123]
    v_fma_f32 v96, v96, s30, v55
    v_exp_f32 v96, v96
    v_mfma_f32_16x16x32_bf16 v[128:131], v[168:171], a[188:191], v[128:131]
    v_fma_f32 v97, v97, s30, v55
    v_exp_f32 v97, v97
    v_mfma_f32_16x16x32_bf16 v[136:139], v[168:171], a[204:207], v[136:139]
    v_fma_f32 v98, v98, s30, v55
    v_exp_f32 v98, v98
    v_mfma_f32_16x16x32_bf16 v[144:147], v[168:171], a[220:223], v[144:147]
    v_fma_f32 v99, v99, s30, v55
    v_exp_f32 v99, v99
    v_mfma_f32_16x16x32_bf16 v[152:155], v[168:171], a[236:239], v[152:155]
    v_cvt_pk_bf16_f32 v92, v92, v93
    v_cvt_pk_bf16_f32 v93, v94, v95
    v_mfma_f32_16x16x32_bf16 a[0:3], v[172:175], v[76:79], a[0:3]
    v_cvt_pk_bf16_f32 v94, v96, v97
    v_cvt_pk_bf16_f32 v95, v98, v99
    v_mfma_f32_16x16x32_bf16 a[32:35], v[172:175], v[84:87], a[32:35]
    v_fma_f32 v100, v100, s30, v56
    v_exp_f32 v100, v100
    v_mfma_f32_16x16x32_bf16 a[64:67], v[172:175], v[92:95], a[64:67]
    v_fma_f32 v101, v101, s30, v56
    v_exp_f32 v101, v101
    v_mfma_f32_16x16x32_bf16 a[4:7], v[176:179], v[76:79], a[4:7]
    v_fma_f32 v102, v102, s30, v56
    v_exp_f32 v102, v102
    v_mfma_f32_16x16x32_bf16 a[36:39], v[176:179], v[84:87], a[36:39]
    v_fma_f32 v103, v103, s30, v56
    v_exp_f32 v103, v103
    v_mfma_f32_16x16x32_bf16 a[68:71], v[176:179], v[92:95], a[68:71]
    v_fma_f32 v104, v104, s30, v56
    v_exp_f32 v104, v104
    v_mfma_f32_16x16x32_bf16 a[8:11], v[180:183], v[76:79], a[8:11]
    v_fma_f32 v105, v105, s30, v56
    v_exp_f32 v105, v105
    v_mfma_f32_16x16x32_bf16 a[40:43], v[180:183], v[84:87], a[40:43]
    v_fma_f32 v106, v106, s30, v56
    v_exp_f32 v106, v106
    v_mfma_f32_16x16x32_bf16 a[72:75], v[180:183], v[92:95], a[72:75]
    v_fma_f32 v107, v107, s30, v56
    v_exp_f32 v107, v107
    v_mfma_f32_16x16x32_bf16 a[12:15], v[184:187], v[76:79], a[12:15]
    v_cvt_pk_bf16_f32 v100, v100, v101
    v_cvt_pk_bf16_f32 v101, v102, v103
    v_mfma_f32_16x16x32_bf16 a[44:47], v[184:187], v[84:87], a[44:47]
    v_cvt_pk_bf16_f32 v102, v104, v105
    v_cvt_pk_bf16_f32 v103, v106, v107
    v_mfma_f32_16x16x32_bf16 a[76:79], v[184:187], v[92:95], a[76:79]
    v_fma_f32 v108, v108, s30, v57
    v_exp_f32 v108, v108
    v_mfma_f32_16x16x32_bf16 a[96:99], v[172:175], v[100:103], a[96:99]
    v_fma_f32 v109, v109, s30, v57
    v_exp_f32 v109, v109
    v_mfma_f32_16x16x32_bf16 a[100:103], v[176:179], v[100:103], a[100:103]
    v_fma_f32 v110, v110, s30, v57
    v_exp_f32 v110, v110
    v_mfma_f32_16x16x32_bf16 a[104:107], v[180:183], v[100:103], a[104:107]
    v_fma_f32 v111, v111, s30, v57
    v_exp_f32 v111, v111
    v_mfma_f32_16x16x32_bf16 a[108:111], v[184:187], v[100:103], a[108:111]
    v_fma_f32 v112, v112, s30, v57
    v_exp_f32 v112, v112
    v_mfma_f32_16x16x32_bf16 v[28:31], v[24:27], v[76:79], v[28:31]
    v_fma_f32 v113, v113, s30, v57
    v_exp_f32 v113, v113
    v_mfma_f32_16x16x32_bf16 v[32:35], v[24:27], v[84:87], v[32:35]
    v_fma_f32 v114, v114, s30, v57
    v_exp_f32 v114, v114
    v_mfma_f32_16x16x32_bf16 v[36:39], v[24:27], v[92:95], v[36:39]
    v_fma_f32 v115, v115, s30, v57
    v_exp_f32 v115, v115
    v_mfma_f32_16x16x32_bf16 v[40:43], v[24:27], v[100:103], v[40:43]
    v_cvt_pk_bf16_f32 v108, v108, v109
    v_cvt_pk_bf16_f32 v109, v110, v111
    v_cvt_pk_bf16_f32 v110, v112, v113
    v_cvt_pk_bf16_f32 v111, v114, v115
    v_max3_f32 v63, v116, v117, v118
    v_max3_f32 v63, v63, v119, v120
    v_mfma_f32_16x16x32_bf16 a[128:131], v[172:175], v[108:111], a[128:131]
    ds_read_b64_tr_b16 v[172:173], v20 offset:8192
    v_mfma_f32_16x16x32_bf16 a[132:135], v[176:179], v[108:111], a[132:135]
    ds_read_b64_tr_b16 v[174:175], v20 offset:12288
    v_mfma_f32_16x16x32_bf16 a[136:139], v[180:183], v[108:111], a[136:139]
    ds_read_b64_tr_b16 v[176:177], v21 offset:8192
    v_mfma_f32_16x16x32_bf16 a[140:143], v[184:187], v[108:111], a[140:143]
    ds_read_b64_tr_b16 v[178:179], v21 offset:12288
    v_mfma_f32_16x16x32_bf16 v[44:47], v[24:27], v[108:111], v[44:47]
    ds_read_b64_tr_b16 v[180:181], v22 offset:8192
    ds_read_b64_tr_b16 v[182:183], v22 offset:12288
    ds_read_b64_tr_b16 v[184:185], v23 offset:8192
    ds_read_b64_tr_b16 v[186:187], v23 offset:12288
    v_max3_f32 v63, v63, v121, v122
    v_max_f32 v63, v63, v123
    v_max3_f32 v64, v124, v125, v126
    v_max3_f32 v64, v64, v127, v128
    v_max3_f32 v64, v64, v129, v130
    v_max_f32 v64, v64, v131
    v_max3_f32 v65, v132, v133, v134
    v_max3_f32 v65, v65, v135, v136
    s_waitcnt lgkmcnt(6)
    v_mfma_f32_16x16x32_bf16 a[16:19], v[172:175], v[76:79], a[16:19]
    v_max3_f32 v65, v65, v137, v138
    v_max_f32 v65, v65, v139
    v_mfma_f32_16x16x32_bf16 a[48:51], v[172:175], v[84:87], a[48:51]
    v_max3_f32 v66, v140, v141, v142
    v_max3_f32 v66, v66, v143, v144
    v_mfma_f32_16x16x32_bf16 a[80:83], v[172:175], v[92:95], a[80:83]
    v_max3_f32 v66, v66, v145, v146
    v_max_f32 v66, v66, v147
    v_mfma_f32_16x16x32_bf16 a[112:115], v[172:175], v[100:103], a[112:115]
    v_max3_f32 v67, v148, v149, v150
    v_max3_f32 v67, v67, v151, v152
    v_mfma_f32_16x16x32_bf16 a[144:147], v[172:175], v[108:111], a[144:147]
    s_waitcnt vmcnt(4)
    ds_read_b64_tr_b16 v[172:173], v16 offset:24576
    s_waitcnt lgkmcnt(5)
    v_mfma_f32_16x16x32_bf16 a[20:23], v[176:179], v[76:79], a[20:23]
    s_waitcnt vmcnt(0)
    ds_read_b64_tr_b16 v[174:175], v16 offset:28672
    v_mfma_f32_16x16x32_bf16 a[52:55], v[176:179], v[84:87], a[52:55]
    v_max3_f32 v67, v67, v153, v154
    v_max_f32 v67, v67, v155
    v_mfma_f32_16x16x32_bf16 a[84:87], v[176:179], v[92:95], a[84:87]
    v_cmp_gt_f32 s[44:45], v63, v58
    v_cmp_gt_f32 s[46:47], v64, v59
    v_mfma_f32_16x16x32_bf16 a[116:119], v[176:179], v[100:103], a[116:119]
    v_cmp_gt_f32 s[48:49], v65, v60
    v_cmp_gt_f32 s[50:51], v66, v61
    v_mfma_f32_16x16x32_bf16 a[148:151], v[176:179], v[108:111], a[148:151]
    ds_read_b64_tr_b16 v[176:177], v17 offset:24576
    s_waitcnt lgkmcnt(5)
    v_mfma_f32_16x16x32_bf16 a[24:27], v[180:183], v[76:79], a[24:27]
    ds_read_b64_tr_b16 v[178:179], v17 offset:28672
    v_mfma_f32_16x16x32_bf16 a[56:59], v[180:183], v[84:87], a[56:59]
    v_cmp_gt_f32 s[52:53], v67, v62
    s_or_b64 s[44:45], s[44:45], s[46:47]
    s_or_b64 s[44:45], s[44:45], s[48:49]
    v_mfma_f32_16x16x32_bf16 a[88:91], v[180:183], v[92:95], a[88:91]
    s_or_b64 s[44:45], s[44:45], s[50:51]
    s_or_b64 s[44:45], s[44:45], s[52:53]
    v_mfma_f32_16x16x32_bf16 a[120:123], v[180:183], v[100:103], a[120:123]
    v_mfma_f32_16x16x32_bf16 a[152:155], v[180:183], v[108:111], a[152:155]
    ds_read_b64_tr_b16 v[180:181], v18 offset:24576
    s_waitcnt lgkmcnt(5)
    v_mfma_f32_16x16x32_bf16 a[28:31], v[184:187], v[76:79], a[28:31]
    ds_read_b64_tr_b16 v[182:183], v18 offset:28672
    v_mfma_f32_16x16x32_bf16 a[60:63], v[184:187], v[84:87], a[60:63]
    v_mfma_f32_16x16x32_bf16 a[92:95], v[184:187], v[92:95], a[92:95]
    v_mfma_f32_16x16x32_bf16 a[124:127], v[184:187], v[100:103], a[124:127]
    v_mfma_f32_16x16x32_bf16 a[156:159], v[184:187], v[108:111], a[156:159]
    ds_read_b64_tr_b16 v[184:185], v19 offset:24576
    ds_read_b64_tr_b16 v[186:187], v19 offset:28672
    s_cbranch_scc1 L_slow7
L_ret7:
    v_fma_f32 v116, v116, s30, v53
    v_exp_f32 v116, v116
    v_fma_f32 v117, v117, s30, v53
    v_exp_f32 v117, v117
    v_fma_f32 v118, v118, s30, v53
    v_exp_f32 v118, v118
    v_fma_f32 v119, v119, s30, v53
    v_exp_f32 v119, v119
    v_fma_f32 v120, v120, s30, v53
    v_exp_f32 v120, v120
    v_fma_f32 v121, v121, s30, v53
    v_exp_f32 v121, v121
    v_fma_f32 v122, v122, s30, v53
    v_exp_f32 v122, v122
    v_fma_f32 v123, v123, s30, v53
    v_exp_f32 v123, v123
    v_cvt_pk_bf16_f32 v116, v116, v117
    v_cvt_pk_bf16_f32 v117, v118, v119
    v_cvt_pk_bf16_f32 v118, v120, v121
    v_cvt_pk_bf16_f32 v119, v122, v123
    v_fma_f32 v124, v124, s30, v54
    v_exp_f32 v124, v124
    s_waitcnt lgkmcnt(6)
    v_mfma_f32_16x16x32_bf16 a[0:3], v[172:175], v[116:119], a[0:3]
    v_fma_f32 v125, v125, s30, v54
    v_exp_f32 v125, v125
    s_waitcnt lgkmcnt(4)
    v_mfma_f32_16x16x32_bf16 a[4:7], v[176:179], v[116:119], a[4:7]
    v_fma_f32 v126, v126, s30, v54
    v_exp_f32 v126, v126
    s_waitcnt lgkmcnt(2)
    v_mfma_f32_16x16x32_bf16 a[8:11], v[180:183], v[116:119], a[8:11]
    v_fma_f32 v127, v127, s30, v54
    v_exp_f32 v127, v127
    s_waitcnt lgkmcnt(0)
    v_mfma_f32_16x16x32_bf16 a[12:15], v[184:187], v[116:119], a[12:15]
    v_fma_f32 v128, v128, s30, v54
    v_exp_f32 v128, v128
    v_mfma_f32_16x16x32_bf16 v[28:31], v[24:27], v[116:119], v[28:31]
    v_fma_f32 v129, v129, s30, v54
    v_exp_f32 v129, v129
    v_fma_f32 v130, v130, s30, v54
    v_exp_f32 v130, v130
    v_fma_f32 v131, v131, s30, v54
    v_exp_f32 v131, v131
    v_cvt_pk_bf16_f32 v124, v124, v125
    v_cvt_pk_bf16_f32 v125, v126, v127
    v_cvt_pk_bf16_f32 v126, v128, v129
    v_cvt_pk_bf16_f32 v127, v130, v131
    v_fma_f32 v132, v132, s30, v55
    v_exp_f32 v132, v132
    v_mfma_f32_16x16x32_bf16 a[32:35], v[172:175], v[124:127], a[32:35]
    v_fma_f32 v133, v133, s30, v55
    v_exp_f32 v133, v133
    v_mfma_f32_16x16x32_bf16 a[36:39], v[176:179], v[124:127], a[36:39]
    v_fma_f32 v134, v134, s30, v55
    v_exp_f32 v134, v134
    v_mfma_f32_16x16x32_bf16 a[40:43], v[180:183], v[124:127], a[40:43]
    v_fma_f32 v135, v135, s30, v55
    v_exp_f32 v135, v135
    v_mfma_f32_16x16x32_bf16 a[44:47], v[184:187], v[124:127], a[44:47]
    v_fma_f32 v136, v136, s30, v55
    v_exp_f32 v136, v136
    v_mfma_f32_16x16x32_bf16 v[32:35], v[24:27], v[124:127], v[32:35]
    v_fma_f32 v137, v137, s30, v55
    v_exp_f32 v137, v137
    v_fma_f32 v138, v138, s30, v55
    v_exp_f32 v138, v138
    v_fma_f32 v139, v139, s30, v55
    v_exp_f32 v139, v139
    v_cvt_pk_bf16_f32 v132, v132, v133
    v_cvt_pk_bf16_f32 v133, v134, v135
    v_cvt_pk_bf16_f32 v134, v136, v137
    v_cvt_pk_bf16_f32 v135, v138, v139
    v_fma_f32 v140, v140, s30, v56
    v_exp_f32 v140, v140
    v_mfma_f32_16x16x32_bf16 a[64:67], v[172:175], v[132:135], a[64:67]
    v_fma_f32 v141, v141, s30, v56
    v_exp_f32 v141, v141
    v_mfma_f32_16x16x32_bf16 a[68:71], v[176:179], v[132:135], a[68:71]
    v_fma_f32 v142, v142, s30, v56
    v_exp_f32 v142, v142
    v_mfma_f32_16x16x32_bf16 a[72:75], v[180:183], v[132:135], a[72:75]
    v_fma_f32 v143, v143, s30, v56
    v_exp_f32 v143, v143
    v_mfma_f32_16x16x32_bf16 a[76:79], v[184:187], v[132:135], a[76:79]
    v_fma_f32 v144, v144, s30, v56
    v_exp_f32 v144, v144
    v_mfma_f32_16x16x32_bf16 v[36:39], v[24:27], v[132:135], v[36:39]
    v_fma_f32 v145, v145, s30, v56
    v_exp_f32 v145, v145
    v_fma_f32 v146, v146, s30, v56
    v_exp_f32 v146, v146
    v_fma_f32 v147, v147, s30, v56
    v_exp_f32 v147, v147
    v_cvt_pk_bf16_f32 v140, v140, v141
    v_cvt_pk_bf16_f32 v141, v142, v143
    v_cvt_pk_bf16_f32 v142, v144, v145
    v_cvt_pk_bf16_f32 v143, v146, v147
    v_fma_f32 v148, v148, s30, v57
    v_exp_f32 v148, v148
    v_mfma_f32_16x16x32_bf16 a[96:99], v[172:175], v[140:143], a[96:99]
    v_fma_f32 v149, v149, s30, v57
    v_exp_f32 v149, v149
    v_mfma_f32_16x16x32_bf16 a[100:103], v[176:179], v[140:143], a[100:103]
    v_fma_f32 v150, v150, s30, v57
    v_exp_f32 v150, v150
    v_mfma_f32_16x16x32_bf16 a[104:107], v[180:183], v[140:143], a[104:107]
    v_fma_f32 v151, v151, s30, v57
    v_exp_f32 v151, v151
    v_mfma_f32_16x16x32_bf16 a[108:111], v[184:187], v[140:143], a[108:111]
    v_fma_f32 v152, v152, s30, v57
    v_exp_f32 v152, v152
    v_mfma_f32_16x16x32_bf16 v[40:43], v[24:27], v[140:143], v[40:43]
    v_fma_f32 v153, v153, s30, v57
    v_exp_f32 v153, v153
    v_fma_f32 v154, v154, s30, v57
    v_exp_f32 v154, v154
    v_fma_f32 v155, v155, s30, v57
    v_exp_f32 v155, v155
    v_cvt_pk_bf16_f32 v148, v148, v149
    v_cvt_pk_bf16_f32 v149, v150, v151
    v_cvt_pk_bf16_f32 v150, v152, v153
    v_cvt_pk_bf16_f32 v151, v154, v155
    s_nop 0
    s_nop 0
    v_mfma_f32_16x16x32_bf16 a[128:131], v[172:175], v[148:151], a[128:131]
    ds_read_b64_tr_b16 v[172:173], v20 offset:24576
    v_mfma_f32_16x16x32_bf16 a[132:135], v[176:179], v[148:151], a[132:135]
    ds_read_b64_tr_b16 v[174:175], v20 offset:28672
    v_mfma_f32_16x16x32_bf16 a[136:139], v[180:183], v[148:151], a[136:139]
    ds_read_b64_tr_b16 v[176:177], v21 offset:24576
    v_mfma_f32_16x16x32_bf16 a[140:143], v[184:187], v[148:151], a[140:143]
    ds_read_b64_tr_b16 v[178:179], v21 offset:28672
    v_mfma_f32_16x16x32_bf16 v[44:47], v[24:27], v[148:151], v[44:47]
    ds_read_b64_tr_b16 v[180:181], v22 offset:24576
    ds_read_b64_tr_b16 v[182:183], v22 offset:28672
    ds_read_b64_tr_b16 v[184:185], v23 offset:24576
    ds_read_b64_tr_b16 v[186:187], v23 offset:28672
    s_waitcnt lgkmcnt(6)
    v_mfma_f32_16x16x32_bf16 a[16:19], v[172:175], v[116:119], a[16:19]
    v_mfma_f32_16x16x32_bf16 a[48:51], v[172:175], v[124:127], a[48:51]
    v_mfma_f32_16x16x32_bf16 a[80:83], v[172:175], v[132:135], a[80:83]
    v_mfma_f32_16x16x32_bf16 a[112:115], v[172:175], v[140:143], a[112:115]
    v_mfma_f32_16x16x32_bf16 a[144:147], v[172:175], v[148:151], a[144:147]
    s_waitcnt lgkmcnt(4)
    v_mfma_f32_16x16x32_bf16 a[20:23], v[176:179], v[116:119], a[20:23]
    v_mfma_f32_16x16x32_bf16 a[52:55], v[176:179], v[124:127], a[52:55]
    v_mfma_f32_16x16x32_bf16 a[84:87], v[176:179], v[132:135], a[84:87]
    v_mfma_f32_16x16x32_bf16 a[116:119], v[176:179], v[140:143], a[116:119]
    v_mfma_f32_16x16x32_bf16 a[148:151], v[176:179], v[148:151], a[148:151]
    s_waitcnt lgkmcnt(2)
    v_mfma_f32_16x16x32_bf16 a[24:27], v[180:183], v[116:119], a[24:27]
    v_mfma_f32_16x16x32_bf16 a[56:59], v[180:183], v[124:127], a[56:59]
    v_mfma_f32_16x16x32_bf16 a[88:91], v[180:183], v[132:135], a[88:91]
    v_mfma_f32_16x16x32_bf16 a[120:123], v[180:183], v[140:143], a[120:123]
    v_mfma_f32_16x16x32_bf16 a[152:155], v[180:183], v[148:151], a[152:155]
    s_waitcnt lgkmcnt(0)
    v_mfma_f32_16x16x32_bf16 a[28:31], v[184:187], v[116:119], a[28:31]
    v_mfma_f32_16x16x32_bf16 a[60:63], v[184:187], v[124:127], a[60:63]
    v_mfma_f32_16x16x32_bf16 a[92:95], v[184:187], v[132:135], a[92:95]
    v_mfma_f32_16x16x32_bf16 a[124:127], v[184:187], v[140:143], a[124:127]
    v_mfma_f32_16x16x32_bf16 a[156:159], v[184:187], v[148:151], a[156:159]
    s_waitcnt vmcnt(0) lgkmcnt(0)
    s_nop 7
    s_nop 7
    v_lshlrev_b32 v76, 4, v1
    v_lshlrev_b32 v77, 3, v3
    v_add_u32 v77, s29, v77
    v_mov_b32 v78, v48
    v_mov_b32 v79, v28
    ds_write_b64 v77, v[78:79] offset:35072
    v_mov_b32 v78, v49
    v_mov_b32 v79, v32
    ds_write_b64 v77, v[78:79] offset:35200
    v_mov_b32 v78, v50
    v_mov_b32 v79, v36
    ds_write_b64 v77, v[78:79] offset:35328
    v_mov_b32 v78, v51
    v_mov_b32 v79, v40
    ds_write_b64 v77, v[78:79] offset:35456
    v_mov_b32 v78, v52
    v_mov_b32 v79, v44
    ds_write_b64 v77, v[78:79] offset:35584
    s_cmp_eq_u32 s28, 1
    s_cbranch_scc1 L_epi1
    s_cmp_eq_u32 s28, 2
    s_cbranch_scc1 L_epi2
    s_cmp_eq_u32 s28, 3
    s_cbranch_scc1 L_epi3
L_epi0:
    v_add_u32 v80, 20480, v76
    ds_write_b128 v80, a[32:35]
    ds_write_b128 v80, a[36:39] offset:1024
    ds_write_b128 v80, a[40:43] offset:2048
    ds_write_b128 v80, a[44:47] offset:3072
    ds_write_b128 v80, a[48:51] offset:4096
    ds_write_b128 v80, a[52:55] offset:5120
    ds_write_b128 v80, a[56:59] offset:6144
    ds_write_b128 v80, a[60:63] offset:7168
    ds_write_b128 v80, a[64:67] offset:8192
    ds_write_b128 v80, a[68:71] offset:9216
    ds_write_b128 v80, a[72:75] offset:10240
    ds_write_b128 v80, a[76:79] offset:11264
    ds_write_b128 v80, a[80:83] offset:12288
    ds_write_b128 v80, a[84:87] offset:13312
    ds_write_b128 v80, a[88:91] offset:14336
    s_waitcnt lgkmcnt(14)
    ds_write_b128 v80, a[92:95] offset:15360
    s_waitcnt lgkmcnt(14)
    ds_write_b128 v80, a[96:99] offset:16384
    s_waitcnt lgkmcnt(14)
    ds_write_b128 v80, a[100:103] offset:17408
    s_waitcnt lgkmcnt(14)
    ds_write_b128 v80, a[104:107] offset:18432
    s_waitcnt lgkmcnt(14)
    ds_write_b128 v80, a[108:111] offset:19456
    s_waitcnt lgkmcnt(14)
    ds_write_b128 v80, a[112:115] offset:20480
    s_waitcnt lgkmcnt(14)
    ds_write_b128 v80, a[116:119] offset:21504
    s_waitcnt lgkmcnt(14)
    ds_write_b128 v80, a[120:123] offset:22528
    s_waitcnt lgkmcnt(14)
    ds_write_b128 v80, a[124:127] offset:23552
    s_waitcnt lgkmcnt(14)
    ds_write_b128 v80, a[136:139] offset:24576
    s_waitcnt lgkmcnt(14)
    ds_write_b128 v80, a[140:143] offset:25600
    s_waitcnt lgkmcnt(14)
    ds_write_b128 v80, a[144:147] offset:26624
    s_waitcnt lgkmcnt(14)
    ds_write_b128 v80, a[148:151] offset:27648
    s_waitcnt lgkmcnt(14)
    ds_write_b128 v80, a[152:155] offset:28672
    s_waitcnt lgkmcnt(14)
    ds_write_b128 v80, a[156:159] offset:29696
    s_waitcnt lgkmcnt(0)
    s_barrier
    v_lshlrev_b32 v81, 3, v3
    v_add_u32 v88, 20480, v81
    ds_read_b64 v[136:137], v88 offset:35072
    ds_read_b64 v[144:145], v88 offset:35200
    ds_read_b64 v[152:153], v88 offset:35328
    ds_read_b64 v[160:161], v88 offset:35456
    ds_read_b64 v[168:169], v88 offset:35584
    v_add_u32 v89, 56320, v81
    ds_read_b64 v[138:139], v89 offset:35072
    ds_read_b64 v[146:147], v89 offset:35200
    ds_read_b64 v[154:155], v89 offset:35328
    ds_read_b64 v[162:163], v89 offset:35456
    ds_read_b64 v[170:171], v89 offset:35584
    v_add_u32 v90, 92160, v81
    ds_read_b64 v[140:141], v90 offset:35072
    ds_read_b64 v[148:149], v90 offset:35200
    ds_read_b64 v[156:157], v90 offset:35328
    ds_read_b64 v[164:165], v90 offset:35456
    ds_read_b64 v[172:173], v90 offset:35584
    v_add_u32 v91, 128000, v81
    s_waitcnt lgkmcnt(14)
    ds_read_b64 v[142:143], v91 offset:35072
    s_waitcnt lgkmcnt(14)
    ds_read_b64 v[150:151], v91 offset:35200
    s_waitcnt lgkmcnt(14)
    ds_read_b64 v[158:159], v91 offset:35328
    s_waitcnt lgkmcnt(14)
    ds_read_b64 v[166:167], v91 offset:35456
    s_waitcnt lgkmcnt(14)
    ds_read_b64 v[174:175], v91 offset:35584
    v_add_u32 v133, 56320, v76
    s_waitcnt lgkmcnt(14)
    ds_read_b128 v[176:179], v133 offset:1024
    v_add_u32 v134, 92160, v76
    s_waitcnt lgkmcnt(14)
    ds_read_b128 v[180:183], v134 offset:1024
    v_add_u32 v135, 128000, v76
    s_waitcnt lgkmcnt(14)
    ds_read_b128 v[184:187], v135 offset:1024
    s_waitcnt lgkmcnt(14)
    ds_read_b128 v[188:191], v135 offset:2048
    v_max_f32 v82, v136, v138
    v_mul_u32_u24 v84, 272, v3
    v_lshl_add_u32 v84, v2, 6, v84
    v_add_u32 v84, 51200, v84
    v_and_b32 v86, 1, v2
    v_xor_b32 v192, 0, v86
    v_lshl_add_u32 v192, v192, 3, v84
    s_waitcnt lgkmcnt(8)
    v_max3_f32 v82, v82, v140, v142
    v_sub_f32 v92, v136, v82
    v_mul_f32 v92, s30, v92
    v_exp_f32 v92, v92
    v_sub_f32 v97, v138, v82
    v_mul_f32 v83, v92, v137
    v_mul_f32 v97, s30, v97
    v_exp_f32 v97, v97
    v_sub_f32 v102, v140, v82
    v_fma_f32 v83, v97, v139, v83
    v_mul_f32 v102, s30, v102
    v_exp_f32 v102, v102
    v_sub_f32 v107, v142, v82
    v_fma_f32 v83, v102, v141, v83
    v_mul_f32 v107, s30, v107
    v_exp_f32 v107, v107
    v_max_f32 v82, v144, v146
    v_fma_f32 v83, v107, v143, v83
    v_rcp_f32 v83, v83
    s_waitcnt lgkmcnt(7)
    v_max3_f32 v82, v82, v148, v150
    v_mul_f32 v92, v92, v83
    v_mul_f32 v97, v97, v83
    v_mul_f32 v102, v102, v83
    v_mul_f32 v107, v107, v83
    v_sub_f32 v93, v144, v82
    v_mul_f32 v93, s30, v93
    v_exp_f32 v93, v93
    v_sub_f32 v98, v146, v82
    v_mul_f32 v83, v93, v145
    v_mul_f32 v98, s30, v98
    v_exp_f32 v98, v98
    v_sub_f32 v103, v148, v82
    v_fma_f32 v83, v98, v147, v83
    v_mul_f32 v103, s30, v103
    v_exp_f32 v103, v103
    v_sub_f32 v108, v150, v82
    v_fma_f32 v83, v103, v149, v83
    v_mul_f32 v108, s30, v108
    v_exp_f32 v108, v108
    v_max_f32 v82, v152, v154
    v_fma_f32 v83, v108, v151, v83
    v_rcp_f32 v83, v83
    s_waitcnt lgkmcnt(6)
    v_max3_f32 v82, v82, v156, v158
    v_mul_f32 v93, v93, v83
    v_mul_f32 v98, v98, v83
    v_mul_f32 v103, v103, v83
    v_mul_f32 v108, v108, v83
    v_sub_f32 v94, v152, v82
    v_mul_f32 v94, s30, v94
    v_exp_f32 v94, v94
    v_sub_f32 v99, v154, v82
    v_mul_f32 v83, v94, v153
    v_mul_f32 v99, s30, v99
    v_exp_f32 v99, v99
    v_sub_f32 v104, v156, v82
    v_fma_f32 v83, v99, v155, v83
    v_mul_f32 v104, s30, v104
    v_exp_f32 v104, v104
    v_sub_f32 v109, v158, v82
    v_fma_f32 v83, v104, v157, v83
    v_mul_f32 v109, s30, v109
    v_exp_f32 v109, v109
    v_max_f32 v82, v160, v162
    v_fma_f32 v83, v109, v159, v83
    v_rcp_f32 v83, v83
    s_waitcnt lgkmcnt(5)
    v_max3_f32 v82, v82, v164, v166
    v_mul_f32 v94, v94, v83
    v_mul_f32 v99, v99, v83
    v_mul_f32 v104, v104, v83
    v_mul_f32 v109, v109, v83
    v_sub_f32 v95, v160, v82
    v_mul_f32 v95, s30, v95
    v_exp_f32 v95, v95
    v_sub_f32 v100, v162, v82
    v_mul_f32 v83, v95, v161
    v_mul_f32 v100, s30, v100
    v_exp_f32 v100, v100
    v_sub_f32 v105, v164, v82
    v_fma_f32 v83, v100, v163, v83
    ds_read_b128 v[160:163], v133
    v_mul_f32 v105, s30, v105
    v_exp_f32 v105, v105
    v_sub_f32 v110, v166, v82
    v_fma_f32 v83, v105, v165, v83
    v_mul_f32 v110, s30, v110
    v_exp_f32 v110, v110
    v_max_f32 v82, v168, v170
    v_fma_f32 v83, v110, v167, v83
    ds_read_b128 v[164:167], v134
    v_rcp_f32 v83, v83
    s_waitcnt lgkmcnt(6)
    v_max3_f32 v82, v82, v172, v174
    v_mul_f32 v95, v95, v83
    v_mul_f32 v100, v100, v83
    v_mul_f32 v105, v105, v83
    v_mul_f32 v110, v110, v83
    v_sub_f32 v96, v168, v82
    v_mul_f32 v96, s30, v96
    v_exp_f32 v96, v96
    v_sub_f32 v101, v170, v82
    v_mul_f32 v83, v96, v169
    v_mul_f32 v101, s30, v101
    v_exp_f32 v101, v101
    v_sub_f32 v106, v172, v82
    v_fma_f32 v83, v101, v171, v83
    ds_read_b128 v[168:171], v135
    v_mul_f32 v106, s30, v106
    v_exp_f32 v106, v106
    v_sub_f32 v111, v174, v82
    v_fma_f32 v83, v106, v173, v83
    v_mul_f32 v111, s30, v111
    v_exp_f32 v111, v111
    v_xor_b32 v193, 1, v86
    v_fma_f32 v83, v111, v175, v83
    v_rcp_f32 v83, v83
    v_lshl_add_u32 v193, v193, 3, v84
    v_mul_f32 v96, v96, v83
    v_mul_f32 v101, v101, v83
    v_mul_f32 v106, v106, v83
    v_mul_f32 v111, v111, v83
    v_xor_b32 v194, 2, v86
    v_lshl_add_u32 v194, v194, 3, v84
    v_xor_b32 v195, 3, v86
    v_lshl_add_u32 v195, v195, 3, v84
    v_xor_b32 v196, 4, v86
    v_lshl_add_u32 v196, v196, 3, v84
    v_xor_b32 v197, 5, v86
    v_lshl_add_u32 v197, v197, 3, v84
    v_xor_b32 v198, 6, v86
    v_lshl_add_u32 v198, v198, 3, v84
    v_xor_b32 v199, 7, v86
    v_lshl_add_u32 v199, v199, 3, v84
    v_lshlrev_b32 v85, 8, v3
    v_lshl_add_u32 v85, v2, 6, v85
    v_add_u32 v85, 16384, v85
    v_accvgpr_read_b32 v156, a0
    v_accvgpr_read_b32 v157, a1
    v_accvgpr_read_b32 v158, a2
    v_accvgpr_read_b32 v159, a3
    v_mul_f32 v116, v92, v156
    v_mul_f32 v117, v92, v157
    v_mul_f32 v118, v92, v158
    v_mul_f32 v119, v92, v159
    s_waitcnt lgkmcnt(2)
    v_fma_f32 v116, v97, v160, v116
    v_fma_f32 v117, v97, v161, v117
    v_fma_f32 v118, v97, v162, v118
    v_fma_f32 v119, v97, v163, v119
    ds_read_b128 v[160:163], v133 offset:3072
    s_waitcnt lgkmcnt(2)
    v_fma_f32 v116, v102, v164, v116
    v_fma_f32 v117, v102, v165, v117
    v_fma_f32 v118, v102, v166, v118
    v_fma_f32 v119, v102, v167, v119
    ds_read_b128 v[164:167], v134 offset:3072
    s_waitcnt lgkmcnt(2)
    v_fma_f32 v116, v107, v168, v116
    v_fma_f32 v117, v107, v169, v117
    v_fma_f32 v118, v107, v170, v118
    v_fma_f32 v119, v107, v171, v119
    ds_read_b128 v[168:171], v135 offset:3072
    v_cvt_pk_bf16_f32 v116, v116, v117
    v_cvt_pk_bf16_f32 v117, v118, v119
    ds_write_b64 v192, v[116:117]
    v_accvgpr_read_b32 v172, a4
    v_accvgpr_read_b32 v173, a5
    v_accvgpr_read_b32 v174, a6
    v_accvgpr_read_b32 v175, a7
    v_mul_f32 v120, v92, v172
    v_mul_f32 v121, v92, v173
    v_mul_f32 v122, v92, v174
    v_mul_f32 v123, v92, v175
    v_fma_f32 v120, v97, v176, v120
    v_fma_f32 v121, v97, v177, v121
    v_fma_f32 v122, v97, v178, v122
    v_fma_f32 v123, v97, v179, v123
    v_fma_f32 v120, v102, v180, v120
    v_fma_f32 v121, v102, v181, v121
    v_fma_f32 v122, v102, v182, v122
    v_fma_f32 v123, v102, v183, v123
    ds_read_b128 v[180:183], v133 offset:2048
    v_fma_f32 v120, v107, v184, v120
    v_fma_f32 v121, v107, v185, v121
    v_fma_f32 v122, v107, v186, v122
    v_fma_f32 v123, v107, v187, v123
    ds_read_b128 v[184:187], v134 offset:2048
    v_cvt_pk_bf16_f32 v120, v120, v121
    v_cvt_pk_bf16_f32 v121, v122, v123
    ds_write_b64 v193, v[120:121]
    v_accvgpr_read_b32 v176, a8
    v_accvgpr_read_b32 v177, a9
    v_accvgpr_read_b32 v178, a10
    v_accvgpr_read_b32 v179, a11
    v_mul_f32 v124, v92, v176
    v_mul_f32 v125, v92, v177
    v_mul_f32 v126, v92, v178
    v_mul_f32 v127, v92, v179
    ds_read_b128 v[176:179], v133 offset:4096
    v_accvgpr_read_b32 v156, a12
    v_accvgpr_read_b32 v157, a13
    v_accvgpr_read_b32 v158, a14
    v_accvgpr_read_b32 v159, a15
    v_mul_f32 v128, v92, v156
    v_mul_f32 v129, v92, v157
    v_mul_f32 v130, v92, v158
    s_waitcnt lgkmcnt(3)
    v_fma_f32 v124, v97, v180, v124
    v_fma_f32 v125, v97, v181, v125
    v_fma_f32 v126, v97, v182, v126
    v_fma_f32 v127, v97, v183, v127
    ds_read_b128 v[180:183], v134 offset:4096
    s_waitcnt lgkmcnt(3)
    v_fma_f32 v124, v102, v184, v124
    v_fma_f32 v125, v102, v185, v125
    v_fma_f32 v126, v102, v186, v126
    v_fma_f32 v127, v102, v187, v127
    ds_read_b128 v[184:187], v135 offset:4096
    v_fma_f32 v124, v107, v188, v124
    v_fma_f32 v125, v107, v189, v125
    v_fma_f32 v126, v107, v190, v126
    v_fma_f32 v127, v107, v191, v127
    ds_read_b128 v[188:191], v135 offset:5120
    v_cvt_pk_bf16_f32 v124, v124, v125
    v_cvt_pk_bf16_f32 v125, v126, v127
    ds_write_b64 v194, v[124:125]
    v_mul_f32 v131, v92, v159
    v_fma_f32 v128, v97, v160, v128
    v_fma_f32 v129, v97, v161, v129
    v_fma_f32 v130, v97, v162, v130
    v_fma_f32 v131, v97, v163, v131
    ds_read_b128 v[160:163], v133 offset:6144
    v_fma_f32 v128, v102, v164, v128
    v_fma_f32 v129, v102, v165, v129
    v_fma_f32 v130, v102, v166, v130
    v_fma_f32 v131, v102, v167, v131
    ds_read_b128 v[164:167], v134 offset:6144
    v_fma_f32 v128, v107, v168, v128
    v_fma_f32 v129, v107, v169, v129
    v_fma_f32 v130, v107, v170, v130
    v_fma_f32 v131, v107, v171, v131
    ds_read_b128 v[168:171], v135 offset:6144
    v_cvt_pk_bf16_f32 v128, v128, v129
    v_cvt_pk_bf16_f32 v129, v130, v131
    ds_write_b64 v195, v[128:129]
    v_accvgpr_read_b32 v172, a16
    v_accvgpr_read_b32 v173, a17
    v_accvgpr_read_b32 v174, a18
    v_accvgpr_read_b32 v175, a19
    v_mul_f32 v116, v92, v172
    v_mul_f32 v117, v92, v173
    v_mul_f32 v118, v92, v174
    v_mul_f32 v119, v92, v175
    s_waitcnt lgkmcnt(8)
    v_fma_f32 v116, v97, v176, v116
    v_fma_f32 v117, v97, v177, v117
    v_fma_f32 v118, v97, v178, v118
    v_fma_f32 v119, v97, v179, v119
    s_waitcnt lgkmcnt(7)
    v_fma_f32 v116, v102, v180, v116
    v_fma_f32 v117, v102, v181, v117
    v_fma_f32 v118, v102, v182, v118
    v_fma_f32 v119, v102, v183, v119
    ds_read_b128 v[180:183], v133 offset:5120
    s_waitcnt lgkmcnt(7)
    v_fma_f32 v116, v107, v184, v116
    v_fma_f32 v117, v107, v185, v117
    v_fma_f32 v118, v107, v186, v118
    v_fma_f32 v119, v107, v187, v119
    ds_read_b128 v[184:187], v134 offset:5120
    v_cvt_pk_bf16_f32 v116, v116, v117
    v_cvt_pk_bf16_f32 v117, v118, v119
    ds_write_b64 v196, v[116:117]
    v_accvgpr_read_b32 v176, a20
    v_accvgpr_read_b32 v177, a21
    v_accvgpr_read_b32 v178, a22
    v_accvgpr_read_b32 v179, a23
    v_mul_f32 v120, v92, v176
    v_mul_f32 v121, v92, v177
    v_mul_f32 v122, v92, v178
    v_mul_f32 v123, v92, v179
    ds_read_b128 v[176:179], v133 offset:7168
    v_accvgpr_read_b32 v156, a24
    v_accvgpr_read_b32 v157, a25
    v_accvgpr_read_b32 v158, a26
    v_accvgpr_read_b32 v159, a27
    v_mul_f32 v124, v92, v156
    v_mul_f32 v125, v92, v157
    v_mul_f32 v126, v92, v158
    s_waitcnt lgkmcnt(3)
    v_fma_f32 v120, v97, v180, v120
    v_fma_f32 v121, v97, v181, v121
    v_fma_f32 v122, v97, v182, v122
    v_fma_f32 v123, v97, v183, v123
    ds_read_b128 v[180:183], v134 offset:7168
    s_waitcnt lgkmcnt(3)
    v_fma_f32 v120, v102, v184, v120
    v_fma_f32 v121, v102, v185, v121
    v_fma_f32 v122, v102, v186, v122
    v_fma_f32 v123, v102, v187, v123
    ds_read_b128 v[184:187], v135 offset:7168
    v_fma_f32 v120, v107, v188, v120
    v_fma_f32 v121, v107, v189, v121
    v_fma_f32 v122, v107, v190, v122
    v_fma_f32 v123, v107, v191, v123
    ds_read_b128 v[188:191], v135 offset:24576
    v_cvt_pk_bf16_f32 v120, v120, v121
    v_cvt_pk_bf16_f32 v121, v122, v123
    ds_write_b64 v197, v[120:121]
    v_mul_f32 v127, v92, v159
    v_fma_f32 v124, v97, v160, v124
    v_fma_f32 v125, v97, v161, v125
    v_fma_f32 v126, v97, v162, v126
    v_fma_f32 v127, v97, v163, v127
    ds_read_b128 v[160:163], v133 offset:25600
    v_fma_f32 v124, v102, v164, v124
    v_fma_f32 v125, v102, v165, v125
    v_fma_f32 v126, v102, v166, v126
    v_fma_f32 v127, v102, v167, v127
    ds_read_b128 v[164:167], v134 offset:25600
    v_fma_f32 v124, v107, v168, v124
    v_fma_f32 v125, v107, v169, v125
    v_fma_f32 v126, v107, v170, v126
    v_fma_f32 v127, v107, v171, v127
    ds_read_b128 v[168:171], v135 offset:25600
    v_cvt_pk_bf16_f32 v124, v124, v125
    v_cvt_pk_bf16_f32 v125, v126, v127
    ds_write_b64 v198, v[124:125]
    v_accvgpr_read_b32 v172, a28
    v_accvgpr_read_b32 v173, a29
    v_accvgpr_read_b32 v174, a30
    v_accvgpr_read_b32 v175, a31
    v_mul_f32 v128, v92, v172
    v_mul_f32 v129, v92, v173
    v_mul_f32 v130, v92, v174
    v_mul_f32 v131, v92, v175
    s_waitcnt lgkmcnt(8)
    v_fma_f32 v128, v97, v176, v128
    v_fma_f32 v129, v97, v177, v129
    v_fma_f32 v130, v97, v178, v130
    v_fma_f32 v131, v97, v179, v131
    s_waitcnt lgkmcnt(7)
    v_fma_f32 v128, v102, v180, v128
    v_fma_f32 v129, v102, v181, v129
    v_fma_f32 v130, v102, v182, v130
    v_fma_f32 v131, v102, v183, v131
    ds_read_b128 v[180:183], v133 offset:24576
    s_waitcnt lgkmcnt(7)
    v_fma_f32 v128, v107, v184, v128
    v_fma_f32 v129, v107, v185, v129
    v_fma_f32 v130, v107, v186, v130
    v_fma_f32 v131, v107, v187, v131
    ds_read_b128 v[184:187], v134 offset:24576
    v_cvt_pk_bf16_f32 v128, v128, v129
    v_cvt_pk_bf16_f32 v129, v130, v131
    ds_write_b64 v199, v[128:129]
    v_accvgpr_read_b32 v176, a128
    v_accvgpr_read_b32 v177, a129
    v_accvgpr_read_b32 v178, a130
    v_accvgpr_read_b32 v179, a131
    v_mul_f32 v116, v96, v176
    v_mul_f32 v117, v96, v177
    v_mul_f32 v118, v96, v178
    v_mul_f32 v119, v96, v179
    v_accvgpr_read_b32 v156, a132
    v_accvgpr_read_b32 v157, a133
    v_accvgpr_read_b32 v158, a134
    v_accvgpr_read_b32 v159, a135
    v_mul_f32 v120, v96, v156
    v_mul_f32 v121, v96, v157
    v_mul_f32 v122, v96, v158
    v_mul_f32 v123, v96, v159
    s_waitcnt lgkmcnt(6)
    v_fma_f32 v120, v101, v160, v120
    s_waitcnt lgkmcnt(2)
    v_fma_f32 v116, v101, v180, v116
    v_fma_f32 v117, v101, v181, v117
    v_fma_f32 v118, v101, v182, v118
    v_fma_f32 v119, v101, v183, v119
    v_fma_f32 v121, v101, v161, v121
    v_fma_f32 v122, v101, v162, v122
    v_fma_f32 v123, v101, v163, v123
    s_waitcnt lgkmcnt(1)
    v_fma_f32 v116, v106, v184, v116
    v_fma_f32 v117, v106, v185, v117
    v_fma_f32 v118, v106, v186, v118
    v_fma_f32 v119, v106, v187, v119
    v_fma_f32 v116, v111, v188, v116
    v_fma_f32 v117, v111, v189, v117
    v_fma_f32 v118, v111, v190, v118
    v_fma_f32 v119, v111, v191, v119
    v_cvt_pk_bf16_f32 v200, v116, v117
    v_cvt_pk_bf16_f32 v201, v118, v119
    v_fma_f32 v120, v106, v164, v120
    v_fma_f32 v121, v106, v165, v121
    v_fma_f32 v122, v106, v166, v122
    v_fma_f32 v123, v106, v167, v123
    v_fma_f32 v120, v111, v168, v120
    v_fma_f32 v121, v111, v169, v121
    v_fma_f32 v122, v111, v170, v122
    v_fma_f32 v123, v111, v171, v123
    v_cvt_pk_bf16_f32 v202, v120, v121
    v_cvt_pk_bf16_f32 v203, v122, v123
    v_and_b32 v86, 1, v2
    v_cmp_eq_u32 vcc, 1, v86
    v_mul_u32_u24 v208, 272, v2
    v_lshl_add_u32 v208, v3, 4, v208
    v_cndmask_b32 v204, v200, v202, vcc
    v_cndmask_b32 v206, v202, v200, vcc
    v_cndmask_b32 v205, v201, v203, vcc
    v_cndmask_b32 v207, v203, v201, vcc
    buffer_store_dwordx4 v[204:207], v85, s[24:27], 0 offen
    v_add_u32 v208, 51200, v208
    s_waitcnt lgkmcnt(0)
    ds_read_b128 v[212:215], v208
    ds_read_b128 v[216:219], v208 offset:1088
    ds_read_b128 v[220:223], v208 offset:2176
    ds_read_b128 v[224:227], v208 offset:3264
    v_lshlrev_b32 v209, 4, v1
    s_mov_b32 s33, 0
    s_mov_b32 s34, 1024
    s_mov_b32 s35, 2048
    s_mov_b32 s36, 3072
    s_waitcnt lgkmcnt(3)
    buffer_store_dwordx4 v[212:215], v209, s[24:27], s33 offen
    s_waitcnt lgkmcnt(2)
    buffer_store_dwordx4 v[216:219], v209, s[24:27], s34 offen
    s_waitcnt lgkmcnt(1)
    buffer_store_dwordx4 v[220:223], v209, s[24:27], s35 offen
    s_waitcnt lgkmcnt(0)
    buffer_store_dwordx4 v[224:227], v209, s[24:27], s36 offen
    s_waitcnt vmcnt(0)
    s_branch L_end
L_epi1:
    v_add_u32 v80, 56320, v76
    ds_write_b128 v80, a[0:3]
    ds_write_b128 v80, a[4:7] offset:1024
    ds_write_b128 v80, a[8:11] offset:2048
    ds_write_b128 v80, a[12:15] offset:3072
    ds_write_b128 v80, a[16:19] offset:4096
    ds_write_b128 v80, a[20:23] offset:5120
    ds_write_b128 v80, a[24:27] offset:6144
    ds_write_b128 v80, a[28:31] offset:7168
    ds_write_b128 v80, a[64:67] offset:8192
    ds_write_b128 v80, a[68:71] offset:9216
    ds_write_b128 v80, a[72:75] offset:10240
    ds_write_b128 v80, a[76:79] offset:11264
    ds_write_b128 v80, a[80:83] offset:12288
    ds_write_b128 v80, a[84:87] offset:13312
    ds_write_b128 v80, a[88:91] offset:14336
    s_waitcnt lgkmcnt(14)
    ds_write_b128 v80, a[92:95] offset:15360
    s_waitcnt lgkmcnt(14)
    ds_write_b128 v80, a[96:99] offset:16384
    s_waitcnt lgkmcnt(14)
    ds_write_b128 v80, a[100:103] offset:17408
    s_waitcnt lgkmcnt(14)
    ds_write_b128 v80, a[104:107] offset:18432
    s_waitcnt lgkmcnt(14)
    ds_write_b128 v80, a[108:111] offset:19456
    s_waitcnt lgkmcnt(14)
    ds_write_b128 v80, a[112:115] offset:20480
    s_waitcnt lgkmcnt(14)
    ds_write_b128 v80, a[116:119] offset:21504
    s_waitcnt lgkmcnt(14)
    ds_write_b128 v80, a[120:123] offset:22528
    s_waitcnt lgkmcnt(14)
    ds_write_b128 v80, a[124:127] offset:23552
    s_waitcnt lgkmcnt(14)
    ds_write_b128 v80, a[128:131] offset:24576
    s_waitcnt lgkmcnt(14)
    ds_write_b128 v80, a[132:135] offset:25600
    s_waitcnt lgkmcnt(14)
    ds_write_b128 v80, a[144:147] offset:26624
    s_waitcnt lgkmcnt(14)
    ds_write_b128 v80, a[148:151] offset:27648
    s_waitcnt lgkmcnt(14)
    ds_write_b128 v80, a[152:155] offset:28672
    s_waitcnt lgkmcnt(14)
    ds_write_b128 v80, a[156:159] offset:29696
    s_waitcnt lgkmcnt(0)
    s_barrier
    v_lshlrev_b32 v81, 3, v3
    v_add_u32 v88, 20480, v81
    ds_read_b64 v[136:137], v88 offset:35072
    ds_read_b64 v[144:145], v88 offset:35200
    ds_read_b64 v[152:153], v88 offset:35328
    ds_read_b64 v[160:161], v88 offset:35456
    ds_read_b64 v[168:169], v88 offset:35584
    v_add_u32 v89, 56320, v81
    ds_read_b64 v[138:139], v89 offset:35072
    ds_read_b64 v[146:147], v89 offset:35200
    ds_read_b64 v[154:155], v89 offset:35328
    ds_read_b64 v[162:163], v89 offset:35456
    ds_read_b64 v[170:171], v89 offset:35584
    v_add_u32 v90, 92160, v81
    ds_read_b64 v[140:141], v90 offset:35072
    ds_read_b64 v[148:149], v90 offset:35200
    ds_read_b64 v[156:157], v90 offset:35328
    ds_read_b64 v[164:165], v90 offset:35456
    ds_read_b64 v[172:173], v90 offset:35584
    v_add_u32 v91, 128000, v81
    s_waitcnt lgkmcnt(14)
    ds_read_b64 v[142:143], v91 offset:35072
    s_waitcnt lgkmcnt(14)
    ds_read_b64 v[150:151], v91 offset:35200
    s_waitcnt lgkmcnt(14)
    ds_read_b64 v[158:159], v91 offset:35328
    s_waitcnt lgkmcnt(14)
    ds_read_b64 v[166:167], v91 offset:35456
    s_waitcnt lgkmcnt(14)
    ds_read_b64 v[174:175], v91 offset:35584
    v_add_u32 v132, 20480, v76
    v_add_u32 v134, 92160, v76
    s_waitcnt lgkmcnt(14)
    ds_read_b128 v[180:183], v134 offset:9216
    v_add_u32 v135, 128000, v76
    s_waitcnt lgkmcnt(14)
    ds_read_b128 v[184:187], v135 offset:9216
    s_waitcnt lgkmcnt(14)
    ds_read_b128 v[188:191], v135 offset:10240
    v_max_f32 v82, v136, v138
    v_mul_u32_u24 v84, 272, v3
    v_lshl_add_u32 v84, v2, 6, v84
    v_add_u32 v84, 87040, v84
    v_and_b32 v86, 1, v2
    v_xor_b32 v192, 0, v86
    v_lshl_add_u32 v192, v192, 3, v84
    v_xor_b32 v193, 1, v86
    v_lshl_add_u32 v193, v193, 3, v84
    s_waitcnt lgkmcnt(7)
    v_max3_f32 v82, v82, v140, v142
    v_sub_f32 v92, v136, v82
    v_mul_f32 v92, s30, v92
    v_exp_f32 v92, v92
    v_sub_f32 v97, v138, v82
    v_mul_f32 v83, v92, v137
    v_mul_f32 v97, s30, v97
    v_exp_f32 v97, v97
    v_sub_f32 v102, v140, v82
    v_fma_f32 v83, v97, v139, v83
    v_mul_f32 v102, s30, v102
    v_exp_f32 v102, v102
    v_sub_f32 v107, v142, v82
    v_fma_f32 v83, v102, v141, v83
    v_mul_f32 v107, s30, v107
    v_exp_f32 v107, v107
    v_max_f32 v82, v144, v146
    v_fma_f32 v83, v107, v143, v83
    v_rcp_f32 v83, v83
    s_waitcnt lgkmcnt(6)
    v_max3_f32 v82, v82, v148, v150
    v_mul_f32 v92, v92, v83
    v_mul_f32 v97, v97, v83
    v_mul_f32 v102, v102, v83
    v_mul_f32 v107, v107, v83
    v_sub_f32 v93, v144, v82
    v_mul_f32 v93, s30, v93
    v_exp_f32 v93, v93
    v_sub_f32 v98, v146, v82
    v_mul_f32 v83, v93, v145
    v_mul_f32 v98, s30, v98
    v_exp_f32 v98, v98
    v_sub_f32 v103, v148, v82
    v_fma_f32 v83, v98, v147, v83
    v_mul_f32 v103, s30, v103
    v_exp_f32 v103, v103
    v_sub_f32 v108, v150, v82
    v_fma_f32 v83, v103, v149, v83
    v_mul_f32 v108, s30, v108
    v_exp_f32 v108, v108
    v_max_f32 v82, v152, v154
    v_fma_f32 v83, v108, v151, v83
    v_rcp_f32 v83, v83
    s_waitcnt lgkmcnt(5)
    v_max3_f32 v82, v82, v156, v158
    v_mul_f32 v93, v93, v83
    v_mul_f32 v98, v98, v83
    v_mul_f32 v103, v103, v83
    v_mul_f32 v108, v108, v83
    v_sub_f32 v94, v152, v82
    v_mul_f32 v94, s30, v94
    v_exp_f32 v94, v94
    v_sub_f32 v99, v154, v82
    v_mul_f32 v83, v94, v153
    v_mul_f32 v99, s30, v99
    v_exp_f32 v99, v99
    v_sub_f32 v104, v156, v82
    v_fma_f32 v83, v99, v155, v83
    v_mul_f32 v104, s30, v104
    v_exp_f32 v104, v104
    v_sub_f32 v109, v158, v82
    v_fma_f32 v83, v104, v157, v83
    v_mul_f32 v109, s30, v109
    v_exp_f32 v109, v109
    v_max_f32 v82, v160, v162
    v_fma_f32 v83, v109, v159, v83
    ds_read_b128 v[156:159], v132
    v_rcp_f32 v83, v83
    s_waitcnt lgkmcnt(5)
    v_max3_f32 v82, v82, v164, v166
    v_mul_f32 v94, v94, v83
    v_mul_f32 v99, v99, v83
    v_mul_f32 v104, v104, v83
    v_mul_f32 v109, v109, v83
    v_sub_f32 v95, v160, v82
    v_mul_f32 v95, s30, v95
    v_exp_f32 v95, v95
    v_sub_f32 v100, v162, v82
    v_mul_f32 v83, v95, v161
    v_mul_f32 v100, s30, v100
    v_exp_f32 v100, v100
    v_sub_f32 v105, v164, v82
    v_fma_f32 v83, v100, v163, v83
    v_mul_f32 v105, s30, v105
    v_exp_f32 v105, v105
    v_sub_f32 v110, v166, v82
    v_fma_f32 v83, v105, v165, v83
    v_mul_f32 v110, s30, v110
    v_exp_f32 v110, v110
    v_max_f32 v82, v168, v170
    v_fma_f32 v83, v110, v167, v83
    ds_read_b128 v[164:167], v134 offset:8192
    v_rcp_f32 v83, v83
    s_waitcnt lgkmcnt(5)
    v_max3_f32 v82, v82, v172, v174
    v_mul_f32 v95, v95, v83
    v_mul_f32 v100, v100, v83
    v_mul_f32 v105, v105, v83
    v_mul_f32 v110, v110, v83
    v_sub_f32 v96, v168, v82
    v_mul_f32 v96, s30, v96
    v_exp_f32 v96, v96
    v_sub_f32 v101, v170, v82
    v_mul_f32 v83, v96, v169
    v_mul_f32 v101, s30, v101
    v_exp_f32 v101, v101
    v_sub_f32 v106, v172, v82
    v_fma_f32 v83, v101, v171, v83
    ds_read_b128 v[168:171], v135 offset:8192
    v_mul_f32 v106, s30, v106
    v_exp_f32 v106, v106
    v_sub_f32 v111, v174, v82
    v_fma_f32 v83, v106, v173, v83
    v_mul_f32 v111, s30, v111
    v_exp_f32 v111, v111
    v_xor_b32 v194, 2, v86
    v_fma_f32 v83, v111, v175, v83
    ds_read_b128 v[172:175], v132 offset:1024
    v_rcp_f32 v83, v83
    v_lshl_add_u32 v194, v194, 3, v84
    v_mul_f32 v96, v96, v83
    v_mul_f32 v101, v101, v83
    v_mul_f32 v106, v106, v83
    v_mul_f32 v111, v111, v83
    v_xor_b32 v195, 3, v86
    v_lshl_add_u32 v195, v195, 3, v84
    v_xor_b32 v196, 4, v86
    v_lshl_add_u32 v196, v196, 3, v84
    v_xor_b32 v197, 5, v86
    v_lshl_add_u32 v197, v197, 3, v84
    v_xor_b32 v198, 6, v86
    v_lshl_add_u32 v198, v198, 3, v84
    v_xor_b32 v199, 7, v86
    v_lshl_add_u32 v199, v199, 3, v84
    v_lshlrev_b32 v85, 8, v3
    v_lshl_add_u32 v85, v2, 6, v85
    v_add_u32 v85, 16400, v85
    s_waitcnt lgkmcnt(3)
    v_mul_f32 v116, v93, v156
    v_mul_f32 v117, v93, v157
    v_mul_f32 v118, v93, v158
    v_mul_f32 v119, v93, v159
    ds_read_b128 v[156:159], v132 offset:3072
    v_accvgpr_read_b32 v160, a32
    v_accvgpr_read_b32 v161, a33
    v_accvgpr_read_b32 v162, a34
    v_accvgpr_read_b32 v163, a35
    v_fma_f32 v116, v98, v160, v116
    v_fma_f32 v117, v98, v161, v117
    v_fma_f32 v118, v98, v162, v118
    v_fma_f32 v119, v98, v163, v119
    s_waitcnt lgkmcnt(3)
    v_fma_f32 v116, v103, v164, v116
    v_fma_f32 v117, v103, v165, v117
    v_fma_f32 v118, v103, v166, v118
    v_fma_f32 v119, v103, v167, v119
    ds_read_b128 v[164:167], v134 offset:11264
    s_waitcnt lgkmcnt(3)
    v_fma_f32 v116, v108, v168, v116
    v_fma_f32 v117, v108, v169, v117
    v_fma_f32 v118, v108, v170, v118
    v_fma_f32 v119, v108, v171, v119
    ds_read_b128 v[168:171], v135 offset:11264
    v_cvt_pk_bf16_f32 v116, v116, v117
    v_cvt_pk_bf16_f32 v117, v118, v119
    ds_write_b64 v192, v[116:117]
    s_waitcnt lgkmcnt(4)
    v_mul_f32 v120, v93, v172
    v_mul_f32 v121, v93, v173
    v_mul_f32 v122, v93, v174
    v_mul_f32 v123, v93, v175
    ds_read_b128 v[172:175], v132 offset:4096
    v_accvgpr_read_b32 v176, a36
    v_accvgpr_read_b32 v177, a37
    v_accvgpr_read_b32 v178, a38
    v_accvgpr_read_b32 v179, a39
    v_fma_f32 v120, v98, v176, v120
    v_fma_f32 v121, v98, v177, v121
    v_fma_f32 v122, v98, v178, v122
    v_fma_f32 v123, v98, v179, v123
    ds_read_b128 v[176:179], v132 offset:2048
    v_fma_f32 v120, v103, v180, v120
    v_fma_f32 v121, v103, v181, v121
    v_fma_f32 v122, v103, v182, v122
    v_fma_f32 v123, v103, v183, v123
    v_fma_f32 v120, v108, v184, v120
    v_fma_f32 v121, v108, v185, v121
    v_fma_f32 v122, v108, v186, v122
    v_fma_f32 v123, v108, v187, v123
    ds_read_b128 v[184:187], v134 offset:10240
    v_cvt_pk_bf16_f32 v120, v120, v121
    v_cvt_pk_bf16_f32 v121, v122, v123
    ds_write_b64 v193, v[120:121]
    v_accvgpr_read_b32 v180, a40
    v_accvgpr_read_b32 v181, a41
    v_accvgpr_read_b32 v182, a42
    v_accvgpr_read_b32 v183, a43
    s_waitcnt lgkmcnt(7)
    v_mul_f32 v128, v93, v156
    v_mul_f32 v129, v93, v157
    v_mul_f32 v130, v93, v158
    v_mul_f32 v131, v93, v159
    ds_read_b128 v[156:159], v132 offset:6144
    v_accvgpr_read_b32 v160, a44
    v_accvgpr_read_b32 v161, a45
    v_accvgpr_read_b32 v162, a46
    s_waitcnt lgkmcnt(3)
    v_mul_f32 v124, v93, v176
    v_mul_f32 v125, v93, v177
    v_mul_f32 v126, v93, v178
    v_mul_f32 v127, v93, v179
    v_fma_f32 v124, v98, v180, v124
    v_fma_f32 v125, v98, v181, v125
    v_fma_f32 v126, v98, v182, v126
    v_fma_f32 v127, v98, v183, v127
    ds_read_b128 v[180:183], v134 offset:12288
    s_waitcnt lgkmcnt(3)
    v_fma_f32 v124, v103, v184, v124
    v_fma_f32 v125, v103, v185, v125
    v_fma_f32 v126, v103, v186, v126
    v_fma_f32 v127, v103, v187, v127
    ds_read_b128 v[184:187], v135 offset:12288
    v_fma_f32 v124, v108, v188, v124
    v_fma_f32 v125, v108, v189, v125
    v_fma_f32 v126, v108, v190, v126
    v_fma_f32 v127, v108, v191, v127
    ds_read_b128 v[188:191], v135 offset:13312
    v_cvt_pk_bf16_f32 v124, v124, v125
    v_cvt_pk_bf16_f32 v125, v126, v127
    ds_write_b64 v194, v[124:125]
    v_accvgpr_read_b32 v163, a47
    v_fma_f32 v128, v98, v160, v128
    v_fma_f32 v129, v98, v161, v129
    v_fma_f32 v130, v98, v162, v130
    v_fma_f32 v131, v98, v163, v131
    v_fma_f32 v128, v103, v164, v128
    v_fma_f32 v129, v103, v165, v129
    v_fma_f32 v130, v103, v166, v130
    v_fma_f32 v131, v103, v167, v131
    ds_read_b128 v[164:167], v134 offset:14336
    v_fma_f32 v128, v108, v168, v128
    v_fma_f32 v129, v108, v169, v129
    v_fma_f32 v130, v108, v170, v130
    v_fma_f32 v131, v108, v171, v131
    ds_read_b128 v[168:171], v135 offset:14336
    v_cvt_pk_bf16_f32 v128, v128, v129
    v_cvt_pk_bf16_f32 v129, v130, v131
    ds_write_b64 v195, v[128:129]
    v_mul_f32 v116, v93, v172
    v_mul_f32 v117, v93, v173
    v_mul_f32 v118, v93, v174
    v_mul_f32 v119, v93, v175
    ds_read_b128 v[172:175], v132 offset:7168
    v_accvgpr_read_b32 v176, a48
    v_accvgpr_read_b32 v177, a49
    v_accvgpr_read_b32 v178, a50
    v_accvgpr_read_b32 v179, a51
    v_fma_f32 v116, v98, v176, v116
    v_fma_f32 v117, v98, v177, v117
    v_fma_f32 v118, v98, v178, v118
    v_fma_f32 v119, v98, v179, v119
    ds_read_b128 v[176:179], v132 offset:5120
    s_waitcnt lgkmcnt(8)
    v_fma_f32 v116, v103, v180, v116
    v_fma_f32 v117, v103, v181, v117
    v_fma_f32 v118, v103, v182, v118
    v_fma_f32 v119, v103, v183, v119
    s_waitcnt lgkmcnt(7)
    v_fma_f32 v116, v108, v184, v116
    v_fma_f32 v117, v108, v185, v117
    v_fma_f32 v118, v108, v186, v118
    v_fma_f32 v119, v108, v187, v119
    ds_read_b128 v[184:187], v134 offset:13312
    v_cvt_pk_bf16_f32 v116, v116, v117
    v_cvt_pk_bf16_f32 v117, v118, v119
    ds_write_b64 v196, v[116:117]
    v_accvgpr_read_b32 v180, a52
    v_accvgpr_read_b32 v181, a53
    v_accvgpr_read_b32 v182, a54
    v_accvgpr_read_b32 v183, a55
    v_mul_f32 v124, v93, v156
    v_mul_f32 v125, v93, v157
    v_mul_f32 v126, v93, v158
    v_mul_f32 v127, v93, v159
    ds_read_b128 v[156:159], v132 offset:25600
    v_accvgpr_read_b32 v160, a56
    v_accvgpr_read_b32 v161, a57
    v_accvgpr_read_b32 v162, a58
    s_waitcnt lgkmcnt(3)
    v_mul_f32 v120, v93, v176
    v_mul_f32 v121, v93, v177
    v_mul_f32 v122, v93, v178
    v_mul_f32 v123, v93, v179
    v_fma_f32 v120, v98, v180, v120
    v_fma_f32 v121, v98, v181, v121
    v_fma_f32 v122, v98, v182, v122
    v_fma_f32 v123, v98, v183, v123
    ds_read_b128 v[180:183], v134 offset:15360
    s_waitcnt lgkmcnt(3)
    v_fma_f32 v120, v103, v184, v120
    v_fma_f32 v121, v103, v185, v121
    v_fma_f32 v122, v103, v186, v122
    v_fma_f32 v123, v103, v187, v123
    ds_read_b128 v[184:187], v135 offset:15360
    v_fma_f32 v120, v108, v188, v120
    v_fma_f32 v121, v108, v189, v121
    v_fma_f32 v122, v108, v190, v122
    v_fma_f32 v123, v108, v191, v123
    ds_read_b128 v[188:191], v135 offset:26624
    v_cvt_pk_bf16_f32 v120, v120, v121
    v_cvt_pk_bf16_f32 v121, v122, v123
    ds_write_b64 v197, v[120:121]
    v_accvgpr_read_b32 v163, a59
    v_fma_f32 v124, v98, v160, v124
    v_fma_f32 v125, v98, v161, v125
    v_fma_f32 v126, v98, v162, v126
    v_fma_f32 v127, v98, v163, v127
    v_fma_f32 v124, v103, v164, v124
    v_fma_f32 v125, v103, v165, v125
    v_fma_f32 v126, v103, v166, v126
    v_fma_f32 v127, v103, v167, v127
    ds_read_b128 v[164:167], v134 offset:27648
    v_fma_f32 v124, v108, v168, v124
    v_fma_f32 v125, v108, v169, v125
    v_fma_f32 v126, v108, v170, v126
    v_fma_f32 v127, v108, v171, v127
    ds_read_b128 v[168:171], v135 offset:27648
    v_cvt_pk_bf16_f32 v124, v124, v125
    v_cvt_pk_bf16_f32 v125, v126, v127
    ds_write_b64 v198, v[124:125]
    v_mul_f32 v128, v93, v172
    v_mul_f32 v129, v93, v173
    v_mul_f32 v130, v93, v174
    v_mul_f32 v131, v93, v175
    v_accvgpr_read_b32 v176, a60
    v_accvgpr_read_b32 v177, a61
    v_accvgpr_read_b32 v178, a62
    v_accvgpr_read_b32 v179, a63
    v_fma_f32 v128, v98, v176, v128
    v_fma_f32 v129, v98, v177, v129
    v_fma_f32 v130, v98, v178, v130
    v_fma_f32 v131, v98, v179, v131
    ds_read_b128 v[176:179], v132 offset:24576
    s_waitcnt lgkmcnt(7)
    v_fma_f32 v128, v103, v180, v128
    v_fma_f32 v129, v103, v181, v129
    v_fma_f32 v130, v103, v182, v130
    v_fma_f32 v131, v103, v183, v131
    s_waitcnt lgkmcnt(6)
    v_fma_f32 v128, v108, v184, v128
    v_fma_f32 v129, v108, v185, v129
    v_fma_f32 v130, v108, v186, v130
    v_fma_f32 v131, v108, v187, v131
    ds_read_b128 v[184:187], v134 offset:26624
    v_cvt_pk_bf16_f32 v128, v128, v129
    v_cvt_pk_bf16_f32 v129, v130, v131
    ds_write_b64 v199, v[128:129]
    v_accvgpr_read_b32 v180, a136
    v_accvgpr_read_b32 v181, a137
    v_accvgpr_read_b32 v182, a138
    v_accvgpr_read_b32 v183, a139
    v_mul_f32 v120, v96, v156
    v_mul_f32 v121, v96, v157
    v_mul_f32 v122, v96, v158
    v_mul_f32 v123, v96, v159
    v_accvgpr_read_b32 v160, a140
    v_accvgpr_read_b32 v161, a141
    v_accvgpr_read_b32 v162, a142
    v_accvgpr_read_b32 v163, a143
    v_fma_f32 v120, v101, v160, v120
    s_waitcnt lgkmcnt(2)
    v_mul_f32 v116, v96, v176
    v_mul_f32 v117, v96, v177
    v_mul_f32 v118, v96, v178
    v_mul_f32 v119, v96, v179
    v_fma_f32 v116, v101, v180, v116
    v_fma_f32 v117, v101, v181, v117
    v_fma_f32 v118, v101, v182, v118
    v_fma_f32 v119, v101, v183, v119
    v_fma_f32 v121, v101, v161, v121
    v_fma_f32 v122, v101, v162, v122
    v_fma_f32 v123, v101, v163, v123
    s_waitcnt lgkmcnt(1)
    v_fma_f32 v116, v106, v184, v116
    v_fma_f32 v117, v106, v185, v117
    v_fma_f32 v118, v106, v186, v118
    v_fma_f32 v119, v106, v187, v119
    v_fma_f32 v116, v111, v188, v116
    v_fma_f32 v117, v111, v189, v117
    v_fma_f32 v118, v111, v190, v118
    v_fma_f32 v119, v111, v191, v119
    v_cvt_pk_bf16_f32 v200, v116, v117
    v_cvt_pk_bf16_f32 v201, v118, v119
    v_fma_f32 v120, v106, v164, v120
    v_fma_f32 v121, v106, v165, v121
    v_fma_f32 v122, v106, v166, v122
    v_fma_f32 v123, v106, v167, v123
    v_fma_f32 v120, v111, v168, v120
    v_fma_f32 v121, v111, v169, v121
    v_fma_f32 v122, v111, v170, v122
    v_fma_f32 v123, v111, v171, v123
    v_cvt_pk_bf16_f32 v202, v120, v121
    v_cvt_pk_bf16_f32 v203, v122, v123
    v_and_b32 v86, 1, v2
    v_cmp_eq_u32 vcc, 1, v86
    v_mul_u32_u24 v208, 272, v2
    v_lshl_add_u32 v208, v3, 4, v208
    v_cndmask_b32 v204, v200, v202, vcc
    v_cndmask_b32 v206, v202, v200, vcc
    v_cndmask_b32 v205, v201, v203, vcc
    v_cndmask_b32 v207, v203, v201, vcc
    buffer_store_dwordx4 v[204:207], v85, s[24:27], 0 offen
    v_add_u32 v208, 87040, v208
    s_waitcnt lgkmcnt(0)
    ds_read_b128 v[212:215], v208
    ds_read_b128 v[216:219], v208 offset:1088
    ds_read_b128 v[220:223], v208 offset:2176
    ds_read_b128 v[224:227], v208 offset:3264
    v_lshlrev_b32 v209, 4, v1
    s_mov_b32 s33, 4096
    s_mov_b32 s34, 5120
    s_mov_b32 s35, 6144
    s_mov_b32 s36, 7168
    s_waitcnt lgkmcnt(3)
    buffer_store_dwordx4 v[212:215], v209, s[24:27], s33 offen
    s_waitcnt lgkmcnt(2)
    buffer_store_dwordx4 v[216:219], v209, s[24:27], s34 offen
    s_waitcnt lgkmcnt(1)
    buffer_store_dwordx4 v[220:223], v209, s[24:27], s35 offen
    s_waitcnt lgkmcnt(0)
    buffer_store_dwordx4 v[224:227], v209, s[24:27], s36 offen
    s_waitcnt vmcnt(0)
    s_branch L_end
L_epi2:
    v_add_u32 v80, 92160, v76
    ds_write_b128 v80, a[0:3]
    ds_write_b128 v80, a[4:7] offset:1024
    ds_write_b128 v80, a[8:11] offset:2048
    ds_write_b128 v80, a[12:15] offset:3072
    ds_write_b128 v80, a[16:19] offset:4096
    ds_write_b128 v80, a[20:23] offset:5120
    ds_write_b128 v80, a[24:27] offset:6144
    ds_write_b128 v80, a[28:31] offset:7168
    ds_write_b128 v80, a[32:35] offset:8192
    ds_write_b128 v80, a[36:39] offset:9216
    ds_write_b128 v80, a[40:43] offset:10240
    ds_write_b128 v80, a[44:47] offset:11264
    ds_write_b128 v80, a[48:51] offset:12288
    ds_write_b128 v80, a[52:55] offset:13312
    ds_write_b128 v80, a[56:59] offset:14336
    s_waitcnt lgkmcnt(14)
    ds_write_b128 v80, a[60:63] offset:15360
    s_waitcnt lgkmcnt(14)
    ds_write_b128 v80, a[96:99] offset:16384
    s_waitcnt lgkmcnt(14)
    ds_write_b128 v80, a[100:103] offset:17408
    s_waitcnt lgkmcnt(14)
    ds_write_b128 v80, a[104:107] offset:18432
    s_waitcnt lgkmcnt(14)
    ds_write_b128 v80, a[108:111] offset:19456
    s_waitcnt lgkmcnt(14)
    ds_write_b128 v80, a[112:115] offset:20480
    s_waitcnt lgkmcnt(14)
    ds_write_b128 v80, a[116:119] offset:21504
    s_waitcnt lgkmcnt(14)
    ds_write_b128 v80, a[120:123] offset:22528
    s_waitcnt lgkmcnt(14)
    ds_write_b128 v80, a[124:127] offset:23552
    s_waitcnt lgkmcnt(14)
    ds_write_b128 v80, a[128:131] offset:24576
    s_waitcnt lgkmcnt(14)
    ds_write_b128 v80, a[132:135] offset:25600
    s_waitcnt lgkmcnt(14)
    ds_write_b128 v80, a[136:139] offset:26624
    s_waitcnt lgkmcnt(14)
    ds_write_b128 v80, a[140:143] offset:27648
    s_waitcnt lgkmcnt(14)
    ds_write_b128 v80, a[152:155] offset:28672
    s_waitcnt lgkmcnt(14)
    ds_write_b128 v80, a[156:159] offset:29696
    s_waitcnt lgkmcnt(0)
    s_barrier
    v_lshlrev_b32 v81, 3, v3
    v_add_u32 v88, 20480, v81
    ds_read_b64 v[136:137], v88 offset:35072
    ds_read_b64 v[144:145], v88 offset:35200
    ds_read_b64 v[152:153], v88 offset:35328
    ds_read_b64 v[160:161], v88 offset:35456
    ds_read_b64 v[168:169], v88 offset:35584
    v_add_u32 v89, 56320, v81
    ds_read_b64 v[138:139], v89 offset:35072
    ds_read_b64 v[146:147], v89 offset:35200
    ds_read_b64 v[154:155], v89 offset:35328
    ds_read_b64 v[162:163], v89 offset:35456
    ds_read_b64 v[170:171], v89 offset:35584
    v_add_u32 v90, 92160, v81
    ds_read_b64 v[140:141], v90 offset:35072
    ds_read_b64 v[148:149], v90 offset:35200
    ds_read_b64 v[156:157], v90 offset:35328
    ds_read_b64 v[164:165], v90 offset:35456
    ds_read_b64 v[172:173], v90 offset:35584
    v_add_u32 v91, 128000, v81
    s_waitcnt lgkmcnt(14)
    ds_read_b64 v[142:143], v91 offset:35072
    s_waitcnt lgkmcnt(14)
    ds_read_b64 v[150:151], v91 offset:35200
    s_waitcnt lgkmcnt(14)
    ds_read_b64 v[158:159], v91 offset:35328
    s_waitcnt lgkmcnt(14)
    ds_read_b64 v[166:167], v91 offset:35456
    s_waitcnt lgkmcnt(14)
    ds_read_b64 v[174:175], v91 offset:35584
    v_add_u32 v132, 20480, v76
    v_add_u32 v133, 56320, v76
    s_waitcnt lgkmcnt(14)
    ds_read_b128 v[176:179], v133 offset:9216
    v_add_u32 v135, 128000, v76
    s_waitcnt lgkmcnt(14)
    ds_read_b128 v[184:187], v135 offset:17408
    s_waitcnt lgkmcnt(14)
    ds_read_b128 v[188:191], v135 offset:18432
    v_max_f32 v82, v136, v138
    v_mul_u32_u24 v84, 272, v3
    v_lshl_add_u32 v84, v2, 6, v84
    v_add_u32 v84, 122880, v84
    v_and_b32 v86, 1, v2
    v_xor_b32 v192, 0, v86
    v_lshl_add_u32 v192, v192, 3, v84
    v_xor_b32 v193, 1, v86
    v_lshl_add_u32 v193, v193, 3, v84
    s_waitcnt lgkmcnt(7)
    v_max3_f32 v82, v82, v140, v142
    v_sub_f32 v92, v136, v82
    v_mul_f32 v92, s30, v92
    v_exp_f32 v92, v92
    v_sub_f32 v97, v138, v82
    v_mul_f32 v83, v92, v137
    v_mul_f32 v97, s30, v97
    v_exp_f32 v97, v97
    v_sub_f32 v102, v140, v82
    v_fma_f32 v83, v97, v139, v83
    v_mul_f32 v102, s30, v102
    v_exp_f32 v102, v102
    v_sub_f32 v107, v142, v82
    v_fma_f32 v83, v102, v141, v83
    v_mul_f32 v107, s30, v107
    v_exp_f32 v107, v107
    v_max_f32 v82, v144, v146
    v_fma_f32 v83, v107, v143, v83
    v_rcp_f32 v83, v83
    s_waitcnt lgkmcnt(6)
    v_max3_f32 v82, v82, v148, v150
    v_mul_f32 v92, v92, v83
    v_mul_f32 v97, v97, v83
    v_mul_f32 v102, v102, v83
    v_mul_f32 v107, v107, v83
    v_sub_f32 v93, v144, v82
    v_mul_f32 v93, s30, v93
    v_exp_f32 v93, v93
    v_sub_f32 v98, v146, v82
    v_mul_f32 v83, v93, v145
    v_mul_f32 v98, s30, v98
    v_exp_f32 v98, v98
    v_sub_f32 v103, v148, v82
    v_fma_f32 v83, v98, v147, v83
    v_mul_f32 v103, s30, v103
    v_exp_f32 v103, v103
    v_sub_f32 v108, v150, v82
    v_fma_f32 v83, v103, v149, v83
    v_mul_f32 v108, s30, v108
    v_exp_f32 v108, v108
    v_max_f32 v82, v152, v154
    v_fma_f32 v83, v108, v151, v83
    v_rcp_f32 v83, v83
    s_waitcnt lgkmcnt(5)
    v_max3_f32 v82, v82, v156, v158
    v_mul_f32 v93, v93, v83
    v_mul_f32 v98, v98, v83
    v_mul_f32 v103, v103, v83
    v_mul_f32 v108, v108, v83
    v_sub_f32 v94, v152, v82
    v_mul_f32 v94, s30, v94
    v_exp_f32 v94, v94
    v_sub_f32 v99, v154, v82
    v_mul_f32 v83, v94, v153
    v_mul_f32 v99, s30, v99
    v_exp_f32 v99, v99
    v_sub_f32 v104, v156, v82
    v_fma_f32 v83, v99, v155, v83
    v_mul_f32 v104, s30, v104
    v_exp_f32 v104, v104
    v_sub_f32 v109, v158, v82
    v_fma_f32 v83, v104, v157, v83
    v_mul_f32 v109, s30, v109
    v_exp_f32 v109, v109
    v_max_f32 v82, v160, v162
    v_fma_f32 v83, v109, v159, v83
    ds_read_b128 v[156:159], v132 offset:8192
    v_rcp_f32 v83, v83
    s_waitcnt lgkmcnt(5)
    v_max3_f32 v82, v82, v164, v166
    v_mul_f32 v94, v94, v83
    v_mul_f32 v99, v99, v83
    v_mul_f32 v104, v104, v83
    v_mul_f32 v109, v109, v83
    v_sub_f32 v95, v160, v82
    v_mul_f32 v95, s30, v95
    v_exp_f32 v95, v95
    v_sub_f32 v100, v162, v82
    v_mul_f32 v83, v95, v161
    v_mul_f32 v100, s30, v100
    v_exp_f32 v100, v100
    v_sub_f32 v105, v164, v82
    v_fma_f32 v83, v100, v163, v83
    ds_read_b128 v[160:163], v133 offset:8192
    v_mul_f32 v105, s30, v105
    v_exp_f32 v105, v105
    v_sub_f32 v110, v166, v82
    v_fma_f32 v83, v105, v165, v83
    v_mul_f32 v110, s30, v110
    v_exp_f32 v110, v110
    v_max_f32 v82, v168, v170
    v_fma_f32 v83, v110, v167, v83
    v_rcp_f32 v83, v83
    s_waitcnt lgkmcnt(5)
    v_max3_f32 v82, v82, v172, v174
    v_mul_f32 v95, v95, v83
    v_mul_f32 v100, v100, v83
    v_mul_f32 v105, v105, v83
    v_mul_f32 v110, v110, v83
    v_sub_f32 v96, v168, v82
    v_mul_f32 v96, s30, v96
    v_exp_f32 v96, v96
    v_sub_f32 v101, v170, v82
    v_mul_f32 v83, v96, v169
    v_mul_f32 v101, s30, v101
    v_exp_f32 v101, v101
    v_sub_f32 v106, v172, v82
    v_fma_f32 v83, v101, v171, v83
    ds_read_b128 v[168:171], v135 offset:16384
    v_mul_f32 v106, s30, v106
    v_exp_f32 v106, v106
    v_sub_f32 v111, v174, v82
    v_fma_f32 v83, v106, v173, v83
    v_mul_f32 v111, s30, v111
    v_exp_f32 v111, v111
    v_xor_b32 v194, 2, v86
    v_fma_f32 v83, v111, v175, v83
    ds_read_b128 v[172:175], v132 offset:9216
    v_rcp_f32 v83, v83
    v_lshl_add_u32 v194, v194, 3, v84
    v_mul_f32 v96, v96, v83
    v_mul_f32 v101, v101, v83
    v_mul_f32 v106, v106, v83
    v_mul_f32 v111, v111, v83
    v_xor_b32 v195, 3, v86
    v_lshl_add_u32 v195, v195, 3, v84
    v_xor_b32 v196, 4, v86
    v_lshl_add_u32 v196, v196, 3, v84
    v_xor_b32 v197, 5, v86
    v_lshl_add_u32 v197, v197, 3, v84
    v_xor_b32 v198, 6, v86
    v_lshl_add_u32 v198, v198, 3, v84
    v_xor_b32 v199, 7, v86
    v_lshl_add_u32 v199, v199, 3, v84
    v_lshlrev_b32 v85, 8, v3
    v_lshl_add_u32 v85, v2, 6, v85
    v_add_u32 v85, 16416, v85
    s_waitcnt lgkmcnt(3)
    v_mul_f32 v116, v94, v156
    v_mul_f32 v117, v94, v157
    v_mul_f32 v118, v94, v158
    v_mul_f32 v119, v94, v159
    ds_read_b128 v[156:159], v132 offset:11264
    s_waitcnt lgkmcnt(3)
    v_fma_f32 v116, v99, v160, v116
    v_fma_f32 v117, v99, v161, v117
    v_fma_f32 v118, v99, v162, v118
    v_fma_f32 v119, v99, v163, v119
    ds_read_b128 v[160:163], v133 offset:11264
    v_accvgpr_read_b32 v164, a64
    v_accvgpr_read_b32 v165, a65
    v_accvgpr_read_b32 v166, a66
    v_accvgpr_read_b32 v167, a67
    v_fma_f32 v116, v104, v164, v116
    v_fma_f32 v117, v104, v165, v117
    v_fma_f32 v118, v104, v166, v118
    v_fma_f32 v119, v104, v167, v119
    s_waitcnt lgkmcnt(3)
    v_fma_f32 v116, v109, v168, v116
    v_fma_f32 v117, v109, v169, v117
    v_fma_f32 v118, v109, v170, v118
    v_fma_f32 v119, v109, v171, v119
    ds_read_b128 v[168:171], v135 offset:19456
    v_cvt_pk_bf16_f32 v116, v116, v117
    v_cvt_pk_bf16_f32 v117, v118, v119
    ds_write_b64 v192, v[116:117]
    s_waitcnt lgkmcnt(4)
    v_mul_f32 v120, v94, v172
    v_mul_f32 v121, v94, v173
    v_mul_f32 v122, v94, v174
    v_mul_f32 v123, v94, v175
    ds_read_b128 v[172:175], v132 offset:12288
    v_fma_f32 v120, v99, v176, v120
    v_fma_f32 v121, v99, v177, v121
    v_fma_f32 v122, v99, v178, v122
    v_fma_f32 v123, v99, v179, v123
    ds_read_b128 v[176:179], v132 offset:10240
    v_accvgpr_read_b32 v180, a68
    v_accvgpr_read_b32 v181, a69
    v_accvgpr_read_b32 v182, a70
    v_accvgpr_read_b32 v183, a71
    v_fma_f32 v120, v104, v180, v120
    v_fma_f32 v121, v104, v181, v121
    v_fma_f32 v122, v104, v182, v122
    v_fma_f32 v123, v104, v183, v123
    ds_read_b128 v[180:183], v133 offset:10240
    v_fma_f32 v120, v109, v184, v120
    v_fma_f32 v121, v109, v185, v121
    v_fma_f32 v122, v109, v186, v122
    v_fma_f32 v123, v109, v187, v123
    v_cvt_pk_bf16_f32 v120, v120, v121
    v_cvt_pk_bf16_f32 v121, v122, v123
    ds_write_b64 v193, v[120:121]
    v_accvgpr_read_b32 v184, a72
    v_accvgpr_read_b32 v185, a73
    v_accvgpr_read_b32 v186, a74
    v_accvgpr_read_b32 v187, a75
    s_waitcnt lgkmcnt(7)
    v_mul_f32 v128, v94, v156
    v_mul_f32 v129, v94, v157
    v_mul_f32 v130, v94, v158
    v_mul_f32 v131, v94, v159
    ds_read_b128 v[156:159], v132 offset:14336
    s_waitcnt lgkmcnt(3)
    v_mul_f32 v124, v94, v176
    v_mul_f32 v125, v94, v177
    v_mul_f32 v126, v94, v178
    v_mul_f32 v127, v94, v179
    ds_read_b128 v[176:179], v133 offset:12288
    v_fma_f32 v128, v99, v160, v128
    v_fma_f32 v129, v99, v161, v129
    v_fma_f32 v130, v99, v162, v130
    s_waitcnt lgkmcnt(3)
    v_fma_f32 v124, v99, v180, v124
    v_fma_f32 v125, v99, v181, v125
    v_fma_f32 v126, v99, v182, v126
    v_fma_f32 v127, v99, v183, v127
    v_fma_f32 v124, v104, v184, v124
    v_fma_f32 v125, v104, v185, v125
    v_fma_f32 v126, v104, v186, v126
    v_fma_f32 v127, v104, v187, v127
    ds_read_b128 v[184:187], v135 offset:20480
    v_fma_f32 v124, v109, v188, v124
    v_fma_f32 v125, v109, v189, v125
    v_fma_f32 v126, v109, v190, v126
    v_fma_f32 v127, v109, v191, v127
    ds_read_b128 v[188:191], v135 offset:21504
    v_cvt_pk_bf16_f32 v124, v124, v125
    v_cvt_pk_bf16_f32 v125, v126, v127
    ds_write_b64 v194, v[124:125]
    v_fma_f32 v131, v99, v163, v131
    ds_read_b128 v[160:163], v133 offset:14336
    v_accvgpr_read_b32 v164, a76
    v_accvgpr_read_b32 v165, a77
    v_accvgpr_read_b32 v166, a78
    v_accvgpr_read_b32 v167, a79
    v_fma_f32 v128, v104, v164, v128
    v_fma_f32 v129, v104, v165, v129
    v_fma_f32 v130, v104, v166, v130
    v_fma_f32 v131, v104, v167, v131
    v_fma_f32 v128, v109, v168, v128
    v_fma_f32 v129, v109, v169, v129
    v_fma_f32 v130, v109, v170, v130
    v_fma_f32 v131, v109, v171, v131
    ds_read_b128 v[168:171], v135 offset:22528
    v_cvt_pk_bf16_f32 v128, v128, v129
    v_cvt_pk_bf16_f32 v129, v130, v131
    ds_write_b64 v195, v[128:129]
    v_mul_f32 v116, v94, v172
    v_mul_f32 v117, v94, v173
    v_mul_f32 v118, v94, v174
    v_mul_f32 v119, v94, v175
    ds_read_b128 v[172:175], v132 offset:15360
    s_waitcnt lgkmcnt(7)
    v_fma_f32 v116, v99, v176, v116
    v_fma_f32 v117, v99, v177, v117
    v_fma_f32 v118, v99, v178, v118
    v_fma_f32 v119, v99, v179, v119
    ds_read_b128 v[176:179], v132 offset:13312
    v_accvgpr_read_b32 v180, a80
    v_accvgpr_read_b32 v181, a81
    v_accvgpr_read_b32 v182, a82
    v_accvgpr_read_b32 v183, a83
    v_fma_f32 v116, v104, v180, v116
    v_fma_f32 v117, v104, v181, v117
    v_fma_f32 v118, v104, v182, v118
    v_fma_f32 v119, v104, v183, v119
    ds_read_b128 v[180:183], v133 offset:13312
    s_waitcnt lgkmcnt(8)
    v_fma_f32 v116, v109, v184, v116
    v_fma_f32 v117, v109, v185, v117
    v_fma_f32 v118, v109, v186, v118
    v_fma_f32 v119, v109, v187, v119
    v_cvt_pk_bf16_f32 v116, v116, v117
    v_cvt_pk_bf16_f32 v117, v118, v119
    ds_write_b64 v196, v[116:117]
    v_accvgpr_read_b32 v184, a84
    v_accvgpr_read_b32 v185, a85
    v_accvgpr_read_b32 v186, a86
    v_accvgpr_read_b32 v187, a87
    v_mul_f32 v124, v94, v156
    v_mul_f32 v125, v94, v157
    v_mul_f32 v126, v94, v158
    v_mul_f32 v127, v94, v159
    ds_read_b128 v[156:159], v132 offset:27648
    s_waitcnt lgkmcnt(3)
    v_mul_f32 v120, v94, v176
    v_mul_f32 v121, v94, v177
    v_mul_f32 v122, v94, v178
    v_mul_f32 v123, v94, v179
    ds_read_b128 v[176:179], v133 offset:15360
    v_fma_f32 v124, v99, v160, v124
    v_fma_f32 v125, v99, v161, v125
    v_fma_f32 v126, v99, v162, v126
    s_waitcnt lgkmcnt(3)
    v_fma_f32 v120, v99, v180, v120
    v_fma_f32 v121, v99, v181, v121
    v_fma_f32 v122, v99, v182, v122
    v_fma_f32 v123, v99, v183, v123
    v_fma_f32 v120, v104, v184, v120
    v_fma_f32 v121, v104, v185, v121
    v_fma_f32 v122, v104, v186, v122
    v_fma_f32 v123, v104, v187, v123
    ds_read_b128 v[184:187], v135 offset:23552
    v_fma_f32 v120, v109, v188, v120
    v_fma_f32 v121, v109, v189, v121
    v_fma_f32 v122, v109, v190, v122
    v_fma_f32 v123, v109, v191, v123
    ds_read_b128 v[188:191], v135 offset:28672
    v_cvt_pk_bf16_f32 v120, v120, v121
    v_cvt_pk_bf16_f32 v121, v122, v123
    ds_write_b64 v197, v[120:121]
    v_fma_f32 v127, v99, v163, v127
    ds_read_b128 v[160:163], v133 offset:27648
    v_accvgpr_read_b32 v164, a88
    v_accvgpr_read_b32 v165, a89
    v_accvgpr_read_b32 v166, a90
    v_accvgpr_read_b32 v167, a91
    v_fma_f32 v124, v104, v164, v124
    v_fma_f32 v125, v104, v165, v125
    v_fma_f32 v126, v104, v166, v126
    v_fma_f32 v127, v104, v167, v127
    v_fma_f32 v124, v109, v168, v124
    v_fma_f32 v125, v109, v169, v125
    v_fma_f32 v126, v109, v170, v126
    v_fma_f32 v127, v109, v171, v127
    ds_read_b128 v[168:171], v135 offset:29696
    v_cvt_pk_bf16_f32 v124, v124, v125
    v_cvt_pk_bf16_f32 v125, v126, v127
    ds_write_b64 v198, v[124:125]
    v_mul_f32 v128, v94, v172
    v_mul_f32 v129, v94, v173
    v_mul_f32 v130, v94, v174
    v_mul_f32 v131, v94, v175
    s_waitcnt lgkmcnt(6)
    v_fma_f32 v128, v99, v176, v128
    v_fma_f32 v129, v99, v177, v129
    v_fma_f32 v130, v99, v178, v130
    v_fma_f32 v131, v99, v179, v131
    ds_read_b128 v[176:179], v132 offset:26624
    v_accvgpr_read_b32 v180, a92
    v_accvgpr_read_b32 v181, a93
    v_accvgpr_read_b32 v182, a94
    v_accvgpr_read_b32 v183, a95
    v_fma_f32 v128, v104, v180, v128
    v_fma_f32 v129, v104, v181, v129
    v_fma_f32 v130, v104, v182, v130
    v_fma_f32 v131, v104, v183, v131
    ds_read_b128 v[180:183], v133 offset:26624
    s_waitcnt lgkmcnt(7)
    v_fma_f32 v128, v109, v184, v128
    v_fma_f32 v129, v109, v185, v129
    v_fma_f32 v130, v109, v186, v130
    v_fma_f32 v131, v109, v187, v131
    v_cvt_pk_bf16_f32 v128, v128, v129
    v_cvt_pk_bf16_f32 v129, v130, v131
    ds_write_b64 v199, v[128:129]
    v_accvgpr_read_b32 v184, a144
    v_accvgpr_read_b32 v185, a145
    v_accvgpr_read_b32 v186, a146
    v_accvgpr_read_b32 v187, a147
    v_mul_f32 v120, v96, v156
    v_mul_f32 v121, v96, v157
    v_mul_f32 v122, v96, v158
    v_mul_f32 v123, v96, v159
    s_waitcnt lgkmcnt(5)
    v_fma_f32 v120, v101, v160, v120
    s_waitcnt lgkmcnt(2)
    v_mul_f32 v116, v96, v176
    v_mul_f32 v117, v96, v177
    v_mul_f32 v118, v96, v178
    v_mul_f32 v119, v96, v179
    v_fma_f32 v121, v101, v161, v121
    v_fma_f32 v122, v101, v162, v122
    v_fma_f32 v123, v101, v163, v123
    v_accvgpr_read_b32 v164, a148
    v_accvgpr_read_b32 v165, a149
    v_accvgpr_read_b32 v166, a150
    v_accvgpr_read_b32 v167, a151
    s_waitcnt lgkmcnt(1)
    v_fma_f32 v116, v101, v180, v116
    v_fma_f32 v117, v101, v181, v117
    v_fma_f32 v118, v101, v182, v118
    v_fma_f32 v119, v101, v183, v119
    v_fma_f32 v116, v106, v184, v116
    v_fma_f32 v117, v106, v185, v117
    v_fma_f32 v118, v106, v186, v118
    v_fma_f32 v119, v106, v187, v119
    v_fma_f32 v116, v111, v188, v116
    v_fma_f32 v117, v111, v189, v117
    v_fma_f32 v118, v111, v190, v118
    v_fma_f32 v119, v111, v191, v119
    v_cvt_pk_bf16_f32 v200, v116, v117
    v_cvt_pk_bf16_f32 v201, v118, v119
    v_fma_f32 v120, v106, v164, v120
    v_fma_f32 v121, v106, v165, v121
    v_fma_f32 v122, v106, v166, v122
    v_fma_f32 v123, v106, v167, v123
    v_fma_f32 v120, v111, v168, v120
    v_fma_f32 v121, v111, v169, v121
    v_fma_f32 v122, v111, v170, v122
    v_fma_f32 v123, v111, v171, v123
    v_cvt_pk_bf16_f32 v202, v120, v121
    v_cvt_pk_bf16_f32 v203, v122, v123
    v_and_b32 v86, 1, v2
    v_cmp_eq_u32 vcc, 1, v86
    v_mul_u32_u24 v208, 272, v2
    v_lshl_add_u32 v208, v3, 4, v208
    v_cndmask_b32 v204, v200, v202, vcc
    v_cndmask_b32 v206, v202, v200, vcc
    v_cndmask_b32 v205, v201, v203, vcc
    v_cndmask_b32 v207, v203, v201, vcc
    buffer_store_dwordx4 v[204:207], v85, s[24:27], 0 offen
    v_add_u32 v208, 122880, v208
    s_waitcnt lgkmcnt(0)
    ds_read_b128 v[212:215], v208
    ds_read_b128 v[216:219], v208 offset:1088
    ds_read_b128 v[220:223], v208 offset:2176
    ds_read_b128 v[224:227], v208 offset:3264
    v_lshlrev_b32 v209, 4, v1
    s_mov_b32 s33, 8192
    s_mov_b32 s34, 9216
    s_mov_b32 s35, 10240
    s_mov_b32 s36, 11264
    s_waitcnt lgkmcnt(3)
    buffer_store_dwordx4 v[212:215], v209, s[24:27], s33 offen
    s_waitcnt lgkmcnt(2)
    buffer_store_dwordx4 v[216:219], v209, s[24:27], s34 offen
    s_waitcnt lgkmcnt(1)
    buffer_store_dwordx4 v[220:223], v209, s[24:27], s35 offen
    s_waitcnt lgkmcnt(0)
    buffer_store_dwordx4 v[224:227], v209, s[24:27], s36 offen
    s_waitcnt vmcnt(0)
    s_branch L_end
L_epi3:
    v_add_u32 v80, 128000, v76
    ds_write_b128 v80, a[0:3]
    ds_write_b128 v80, a[4:7] offset:1024
    ds_write_b128 v80, a[8:11] offset:2048
    ds_write_b128 v80, a[12:15] offset:3072
    ds_write_b128 v80, a[16:19] offset:4096
    ds_write_b128 v80, a[20:23] offset:5120
    ds_write_b128 v80, a[24:27] offset:6144
    ds_write_b128 v80, a[28:31] offset:7168
    ds_write_b128 v80, a[32:35] offset:8192
    ds_write_b128 v80, a[36:39] offset:9216
    ds_write_b128 v80, a[40:43] offset:10240
    ds_write_b128 v80, a[44:47] offset:11264
    ds_write_b128 v80, a[48:51] offset:12288
    ds_write_b128 v80, a[52:55] offset:13312
    ds_write_b128 v80, a[56:59] offset:14336
    s_waitcnt lgkmcnt(14)
    ds_write_b128 v80, a[60:63] offset:15360
    s_waitcnt lgkmcnt(14)
    ds_write_b128 v80, a[64:67] offset:16384
    s_waitcnt lgkmcnt(14)
    ds_write_b128 v80, a[68:71] offset:17408
    s_waitcnt lgkmcnt(14)
    ds_write_b128 v80, a[72:75] offset:18432
    s_waitcnt lgkmcnt(14)
    ds_write_b128 v80, a[76:79] offset:19456
    s_waitcnt lgkmcnt(14)
    ds_write_b128 v80, a[80:83] offset:20480
    s_waitcnt lgkmcnt(14)
    ds_write_b128 v80, a[84:87] offset:21504
    s_waitcnt lgkmcnt(14)
    ds_write_b128 v80, a[88:91] offset:22528
    s_waitcnt lgkmcnt(14)
    ds_write_b128 v80, a[92:95] offset:23552
    s_waitcnt lgkmcnt(14)
    ds_write_b128 v80, a[128:131] offset:24576
    s_waitcnt lgkmcnt(14)
    ds_write_b128 v80, a[132:135] offset:25600
    s_waitcnt lgkmcnt(14)
    ds_write_b128 v80, a[136:139] offset:26624
    s_waitcnt lgkmcnt(14)
    ds_write_b128 v80, a[140:143] offset:27648
    s_waitcnt lgkmcnt(14)
    ds_write_b128 v80, a[144:147] offset:28672
    s_waitcnt lgkmcnt(14)
    ds_write_b128 v80, a[148:151] offset:29696
    s_waitcnt lgkmcnt(0)
    s_barrier
    v_lshlrev_b32 v81, 3, v3
    v_add_u32 v88, 20480, v81
    ds_read_b64 v[136:137], v88 offset:35072
    ds_read_b64 v[144:145], v88 offset:35200
    ds_read_b64 v[152:153], v88 offset:35328
    ds_read_b64 v[160:161], v88 offset:35456
    ds_read_b64 v[168:169], v88 offset:35584
    v_add_u32 v89, 56320, v81
    ds_read_b64 v[138:139], v89 offset:35072
    ds_read_b64 v[146:147], v89 offset:35200
    ds_read_b64 v[154:155], v89 offset:35328
    ds_read_b64 v[162:163], v89 offset:35456
    ds_read_b64 v[170:171], v89 offset:35584
    v_add_u32 v90, 92160, v81
    ds_read_b64 v[140:141], v90 offset:35072
    ds_read_b64 v[148:149], v90 offset:35200
    ds_read_b64 v[156:157], v90 offset:35328
    ds_read_b64 v[164:165], v90 offset:35456
    ds_read_b64 v[172:173], v90 offset:35584
    v_add_u32 v91, 128000, v81
    s_waitcnt lgkmcnt(14)
    ds_read_b64 v[142:143], v91 offset:35072
    s_waitcnt lgkmcnt(14)
    ds_read_b64 v[150:151], v91 offset:35200
    s_waitcnt lgkmcnt(14)
    ds_read_b64 v[158:159], v91 offset:35328
    s_waitcnt lgkmcnt(14)
    ds_read_b64 v[166:167], v91 offset:35456
    s_waitcnt lgkmcnt(14)
    ds_read_b64 v[174:175], v91 offset:35584
    v_add_u32 v132, 20480, v76
    v_add_u32 v133, 56320, v76
    s_waitcnt lgkmcnt(14)
    ds_read_b128 v[176:179], v133 offset:17408
    v_add_u32 v134, 92160, v76
    s_waitcnt lgkmcnt(14)
    ds_read_b128 v[180:183], v134 offset:17408
    v_max_f32 v82, v136, v138
    v_mul_u32_u24 v84, 272, v3
    v_lshl_add_u32 v84, v2, 6, v84
    v_add_u32 v84, 158720, v84
    v_and_b32 v86, 1, v2
    v_xor_b32 v192, 0, v86
    v_lshl_add_u32 v192, v192, 3, v84
    v_xor_b32 v193, 1, v86
    v_lshl_add_u32 v193, v193, 3, v84
    v_xor_b32 v194, 2, v86
    v_lshl_add_u32 v194, v194, 3, v84
    s_waitcnt lgkmcnt(6)
    v_max3_f32 v82, v82, v140, v142
    v_sub_f32 v92, v136, v82
    v_mul_f32 v92, s30, v92
    v_exp_f32 v92, v92
    v_sub_f32 v97, v138, v82
    v_mul_f32 v83, v92, v137
    v_mul_f32 v97, s30, v97
    v_exp_f32 v97, v97
    v_sub_f32 v102, v140, v82
    v_fma_f32 v83, v97, v139, v83
    v_mul_f32 v102, s30, v102
    v_exp_f32 v102, v102
    v_sub_f32 v107, v142, v82
    v_fma_f32 v83, v102, v141, v83
    v_mul_f32 v107, s30, v107
    v_exp_f32 v107, v107
    v_max_f32 v82, v144, v146
    v_fma_f32 v83, v107, v143, v83
    v_rcp_f32 v83, v83
    s_waitcnt lgkmcnt(5)
    v_max3_f32 v82, v82, v148, v150
    v_mul_f32 v92, v92, v83
    v_mul_f32 v97, v97, v83
    v_mul_f32 v102, v102, v83
    v_mul_f32 v107, v107, v83
    v_sub_f32 v93, v144, v82
    v_mul_f32 v93, s30, v93
    v_exp_f32 v93, v93
    v_sub_f32 v98, v146, v82
    v_mul_f32 v83, v93, v145
    v_mul_f32 v98, s30, v98
    v_exp_f32 v98, v98
    v_sub_f32 v103, v148, v82
    v_fma_f32 v83, v98, v147, v83
    v_mul_f32 v103, s30, v103
    v_exp_f32 v103, v103
    v_sub_f32 v108, v150, v82
    v_fma_f32 v83, v103, v149, v83
    v_mul_f32 v108, s30, v108
    v_exp_f32 v108, v108
    v_max_f32 v82, v152, v154
    v_fma_f32 v83, v108, v151, v83
    v_rcp_f32 v83, v83
    s_waitcnt lgkmcnt(4)
    v_max3_f32 v82, v82, v156, v158
    v_mul_f32 v93, v93, v83
    v_mul_f32 v98, v98, v83
    v_mul_f32 v103, v103, v83
    v_mul_f32 v108, v108, v83
    v_sub_f32 v94, v152, v82
    v_mul_f32 v94, s30, v94
    v_exp_f32 v94, v94
    v_sub_f32 v99, v154, v82
    v_mul_f32 v83, v94, v153
    v_mul_f32 v99, s30, v99
    v_exp_f32 v99, v99
    v_sub_f32 v104, v156, v82
    v_fma_f32 v83, v99, v155, v83
    v_mul_f32 v104, s30, v104
    v_exp_f32 v104, v104
    v_sub_f32 v109, v158, v82
    v_fma_f32 v83, v104, v157, v83
    v_mul_f32 v109, s30, v109
    v_exp_f32 v109, v109
    v_max_f32 v82, v160, v162
    v_fma_f32 v83, v109, v159, v83
    ds_read_b128 v[156:159], v132 offset:16384
    v_rcp_f32 v83, v83
    s_waitcnt lgkmcnt(4)
    v_max3_f32 v82, v82, v164, v166
    v_mul_f32 v94, v94, v83
    v_mul_f32 v99, v99, v83
    v_mul_f32 v104, v104, v83
    v_mul_f32 v109, v109, v83
    v_sub_f32 v95, v160, v82
    v_mul_f32 v95, s30, v95
    v_exp_f32 v95, v95
    v_sub_f32 v100, v162, v82
    v_mul_f32 v83, v95, v161
    v_mul_f32 v100, s30, v100
    v_exp_f32 v100, v100
    v_sub_f32 v105, v164, v82
    v_fma_f32 v83, v100, v163, v83
    ds_read_b128 v[160:163], v133 offset:16384
    v_mul_f32 v105, s30, v105
    v_exp_f32 v105, v105
    v_sub_f32 v110, v166, v82
    v_fma_f32 v83, v105, v165, v83
    v_mul_f32 v110, s30, v110
    v_exp_f32 v110, v110
    v_max_f32 v82, v168, v170
    v_fma_f32 v83, v110, v167, v83
    ds_read_b128 v[164:167], v134 offset:16384
    v_rcp_f32 v83, v83
    s_waitcnt lgkmcnt(5)
    v_max3_f32 v82, v82, v172, v174
    v_mul_f32 v95, v95, v83
    v_mul_f32 v100, v100, v83
    v_mul_f32 v105, v105, v83
    v_mul_f32 v110, v110, v83
    v_sub_f32 v96, v168, v82
    v_mul_f32 v96, s30, v96
    v_exp_f32 v96, v96
    v_sub_f32 v101, v170, v82
    v_mul_f32 v83, v96, v169
    v_mul_f32 v101, s30, v101
    v_exp_f32 v101, v101
    v_sub_f32 v106, v172, v82
    v_fma_f32 v83, v101, v171, v83
    v_mul_f32 v106, s30, v106
    v_exp_f32 v106, v106
    v_sub_f32 v111, v174, v82
    v_fma_f32 v83, v106, v173, v83
    v_mul_f32 v111, s30, v111
    v_exp_f32 v111, v111
    v_xor_b32 v195, 3, v86
    v_fma_f32 v83, v111, v175, v83
    ds_read_b128 v[172:175], v132 offset:17408
    v_rcp_f32 v83, v83
    v_lshl_add_u32 v195, v195, 3, v84
    v_mul_f32 v96, v96, v83
    v_mul_f32 v101, v101, v83
    v_mul_f32 v106, v106, v83
    v_mul_f32 v111, v111, v83
    v_xor_b32 v196, 4, v86
    v_lshl_add_u32 v196, v196, 3, v84
    v_xor_b32 v197, 5, v86
    v_lshl_add_u32 v197, v197, 3, v84
    v_xor_b32 v198, 6, v86
    v_lshl_add_u32 v198, v198, 3, v84
    v_xor_b32 v199, 7, v86
    v_lshl_add_u32 v199, v199, 3, v84
    v_lshlrev_b32 v85, 8, v3
    v_lshl_add_u32 v85, v2, 6, v85
    v_add_u32 v85, 16432, v85
    s_waitcnt lgkmcnt(3)
    v_mul_f32 v116, v95, v156
    v_mul_f32 v117, v95, v157
    v_mul_f32 v118, v95, v158
    v_mul_f32 v119, v95, v159
    ds_read_b128 v[156:159], v132 offset:19456
    s_waitcnt lgkmcnt(3)
    v_fma_f32 v116, v100, v160, v116
    v_fma_f32 v117, v100, v161, v117
    v_fma_f32 v118, v100, v162, v118
    v_fma_f32 v119, v100, v163, v119
    ds_read_b128 v[160:163], v133 offset:19456
    s_waitcnt lgkmcnt(3)
    v_fma_f32 v116, v105, v164, v116
    v_fma_f32 v117, v105, v165, v117
    v_fma_f32 v118, v105, v166, v118
    v_fma_f32 v119, v105, v167, v119
    ds_read_b128 v[164:167], v134 offset:19456
    v_accvgpr_read_b32 v168, a96
    v_accvgpr_read_b32 v169, a97
    v_accvgpr_read_b32 v170, a98
    v_accvgpr_read_b32 v171, a99
    v_fma_f32 v116, v110, v168, v116
    v_fma_f32 v117, v110, v169, v117
    v_fma_f32 v118, v110, v170, v118
    v_fma_f32 v119, v110, v171, v119
    v_cvt_pk_bf16_f32 v116, v116, v117
    v_cvt_pk_bf16_f32 v117, v118, v119
    ds_write_b64 v192, v[116:117]
    s_waitcnt lgkmcnt(4)
    v_mul_f32 v120, v95, v172
    v_mul_f32 v121, v95, v173
    v_mul_f32 v122, v95, v174
    v_mul_f32 v123, v95, v175
    ds_read_b128 v[172:175], v132 offset:20480
    v_fma_f32 v120, v100, v176, v120
    v_fma_f32 v121, v100, v177, v121
    v_fma_f32 v122, v100, v178, v122
    v_fma_f32 v123, v100, v179, v123
    ds_read_b128 v[176:179], v132 offset:18432
    v_fma_f32 v120, v105, v180, v120
    v_fma_f32 v121, v105, v181, v121
    v_fma_f32 v122, v105, v182, v122
    v_fma_f32 v123, v105, v183, v123
    ds_read_b128 v[180:183], v133 offset:18432
    v_accvgpr_read_b32 v184, a100
    v_accvgpr_read_b32 v185, a101
    v_accvgpr_read_b32 v186, a102
    v_accvgpr_read_b32 v187, a103
    v_fma_f32 v120, v110, v184, v120
    v_fma_f32 v121, v110, v185, v121
    v_fma_f32 v122, v110, v186, v122
    v_fma_f32 v123, v110, v187, v123
    ds_read_b128 v[184:187], v134 offset:18432
    v_cvt_pk_bf16_f32 v120, v120, v121
    v_cvt_pk_bf16_f32 v121, v122, v123
    ds_write_b64 v193, v[120:121]
    v_accvgpr_read_b32 v188, a104
    v_accvgpr_read_b32 v189, a105
    v_accvgpr_read_b32 v190, a106
    v_accvgpr_read_b32 v191, a107
    s_waitcnt lgkmcnt(8)
    v_mul_f32 v128, v95, v156
    v_mul_f32 v129, v95, v157
    v_mul_f32 v130, v95, v158
    s_waitcnt lgkmcnt(3)
    v_mul_f32 v124, v95, v176
    v_mul_f32 v125, v95, v177
    v_mul_f32 v126, v95, v178
    v_mul_f32 v127, v95, v179
    ds_read_b128 v[176:179], v133 offset:20480
    s_waitcnt lgkmcnt(3)
    v_fma_f32 v124, v100, v180, v124
    v_fma_f32 v125, v100, v181, v125
    v_fma_f32 v126, v100, v182, v126
    v_fma_f32 v127, v100, v183, v127
    ds_read_b128 v[180:183], v134 offset:20480
    v_mul_f32 v131, v95, v159
    ds_read_b128 v[156:159], v132 offset:22528
    v_fma_f32 v128, v100, v160, v128
    s_waitcnt lgkmcnt(4)
    v_fma_f32 v124, v105, v184, v124
    v_fma_f32 v125, v105, v185, v125
    v_fma_f32 v126, v105, v186, v126
    v_fma_f32 v127, v105, v187, v127
    v_fma_f32 v124, v110, v188, v124
    v_fma_f32 v125, v110, v189, v125
    v_fma_f32 v126, v110, v190, v126
    v_fma_f32 v127, v110, v191, v127
    v_cvt_pk_bf16_f32 v124, v124, v125
    v_cvt_pk_bf16_f32 v125, v126, v127
    ds_write_b64 v194, v[124:125]
    v_fma_f32 v129, v100, v161, v129
    v_fma_f32 v130, v100, v162, v130
    v_fma_f32 v131, v100, v163, v131
    ds_read_b128 v[160:163], v133 offset:22528
    v_fma_f32 v128, v105, v164, v128
    v_fma_f32 v129, v105, v165, v129
    v_fma_f32 v130, v105, v166, v130
    v_fma_f32 v131, v105, v167, v131
    ds_read_b128 v[164:167], v134 offset:22528
    v_accvgpr_read_b32 v168, a108
    v_accvgpr_read_b32 v169, a109
    v_accvgpr_read_b32 v170, a110
    v_accvgpr_read_b32 v171, a111
    v_fma_f32 v128, v110, v168, v128
    v_fma_f32 v129, v110, v169, v129
    v_fma_f32 v130, v110, v170, v130
    v_fma_f32 v131, v110, v171, v131
    v_cvt_pk_bf16_f32 v128, v128, v129
    v_cvt_pk_bf16_f32 v129, v130, v131
    ds_write_b64 v195, v[128:129]
    v_mul_f32 v116, v95, v172
    v_mul_f32 v117, v95, v173
    v_mul_f32 v118, v95, v174
    v_mul_f32 v119, v95, v175
    ds_read_b128 v[172:175], v132 offset:23552
    s_waitcnt lgkmcnt(7)
    v_fma_f32 v116, v100, v176, v116
    v_fma_f32 v117, v100, v177, v117
    v_fma_f32 v118, v100, v178, v118
    v_fma_f32 v119, v100, v179, v119
    ds_read_b128 v[176:179], v132 offset:21504
    s_waitcnt lgkmcnt(7)
    v_fma_f32 v116, v105, v180, v116
    v_fma_f32 v117, v105, v181, v117
    v_fma_f32 v118, v105, v182, v118
    v_fma_f32 v119, v105, v183, v119
    ds_read_b128 v[180:183], v133 offset:21504
    v_accvgpr_read_b32 v184, a112
    v_accvgpr_read_b32 v185, a113
    v_accvgpr_read_b32 v186, a114
    v_accvgpr_read_b32 v187, a115
    v_fma_f32 v116, v110, v184, v116
    v_fma_f32 v117, v110, v185, v117
    v_fma_f32 v118, v110, v186, v118
    v_fma_f32 v119, v110, v187, v119
    ds_read_b128 v[184:187], v134 offset:21504
    v_cvt_pk_bf16_f32 v116, v116, v117
    v_cvt_pk_bf16_f32 v117, v118, v119
    ds_write_b64 v196, v[116:117]
    v_accvgpr_read_b32 v188, a116
    v_accvgpr_read_b32 v189, a117
    v_accvgpr_read_b32 v190, a118
    v_accvgpr_read_b32 v191, a119
    s_waitcnt lgkmcnt(9)
    v_mul_f32 v124, v95, v156
    v_mul_f32 v125, v95, v157
    v_mul_f32 v126, v95, v158
    s_waitcnt lgkmcnt(3)
    v_mul_f32 v120, v95, v176
    v_mul_f32 v121, v95, v177
    v_mul_f32 v122, v95, v178
    v_mul_f32 v123, v95, v179
    ds_read_b128 v[176:179], v133 offset:23552
    s_waitcnt lgkmcnt(3)
    v_fma_f32 v120, v100, v180, v120
    v_fma_f32 v121, v100, v181, v121
    v_fma_f32 v122, v100, v182, v122
    v_fma_f32 v123, v100, v183, v123
    ds_read_b128 v[180:183], v134 offset:23552
    v_mul_f32 v127, v95, v159
    ds_read_b128 v[156:159], v132 offset:29696
    v_fma_f32 v124, v100, v160, v124
    s_waitcnt lgkmcnt(4)
    v_fma_f32 v120, v105, v184, v120
    v_fma_f32 v121, v105, v185, v121
    v_fma_f32 v122, v105, v186, v122
    v_fma_f32 v123, v105, v187, v123
    v_fma_f32 v120, v110, v188, v120
    v_fma_f32 v121, v110, v189, v121
    v_fma_f32 v122, v110, v190, v122
    v_fma_f32 v123, v110, v191, v123
    v_cvt_pk_bf16_f32 v120, v120, v121
    v_cvt_pk_bf16_f32 v121, v122, v123
    ds_write_b64 v197, v[120:121]
    v_fma_f32 v125, v100, v161, v125
    v_fma_f32 v126, v100, v162, v126
    v_fma_f32 v127, v100, v163, v127
    ds_read_b128 v[160:163], v133 offset:29696
    v_fma_f32 v124, v105, v164, v124
    v_fma_f32 v125, v105, v165, v125
    v_fma_f32 v126, v105, v166, v126
    v_fma_f32 v127, v105, v167, v127
    ds_read_b128 v[164:167], v134 offset:29696
    v_accvgpr_read_b32 v168, a120
    v_accvgpr_read_b32 v169, a121
    v_accvgpr_read_b32 v170, a122
    v_accvgpr_read_b32 v171, a123
    v_fma_f32 v124, v110, v168, v124
    v_fma_f32 v125, v110, v169, v125
    v_fma_f32 v126, v110, v170, v126
    v_fma_f32 v127, v110, v171, v127
    v_cvt_pk_bf16_f32 v124, v124, v125
    v_cvt_pk_bf16_f32 v125, v126, v127
    ds_write_b64 v198, v[124:125]
    v_mul_f32 v128, v95, v172
    v_mul_f32 v129, v95, v173
    v_mul_f32 v130, v95, v174
    v_mul_f32 v131, v95, v175
    s_waitcnt lgkmcnt(6)
    v_fma_f32 v128, v100, v176, v128
    v_fma_f32 v129, v100, v177, v129
    v_fma_f32 v130, v100, v178, v130
    v_fma_f32 v131, v100, v179, v131
    ds_read_b128 v[176:179], v132 offset:28672
    s_waitcnt lgkmcnt(6)
    v_fma_f32 v128, v105, v180, v128
    v_fma_f32 v129, v105, v181, v129
    v_fma_f32 v130, v105, v182, v130
    v_fma_f32 v131, v105, v183, v131
    ds_read_b128 v[180:183], v133 offset:28672
    v_accvgpr_read_b32 v184, a124
    v_accvgpr_read_b32 v185, a125
    v_accvgpr_read_b32 v186, a126
    v_accvgpr_read_b32 v187, a127
    v_fma_f32 v128, v110, v184, v128
    v_fma_f32 v129, v110, v185, v129
    v_fma_f32 v130, v110, v186, v130
    v_fma_f32 v131, v110, v187, v131
    ds_read_b128 v[184:187], v134 offset:28672
    v_cvt_pk_bf16_f32 v128, v128, v129
    v_cvt_pk_bf16_f32 v129, v130, v131
    ds_write_b64 v199, v[128:129]
    v_accvgpr_read_b32 v188, a152
    v_accvgpr_read_b32 v189, a153
    v_accvgpr_read_b32 v190, a154
    v_accvgpr_read_b32 v191, a155
    s_waitcnt lgkmcnt(8)
    v_mul_f32 v120, v96, v156
    v_mul_f32 v121, v96, v157
    v_mul_f32 v122, v96, v158
    s_waitcnt lgkmcnt(3)
    v_mul_f32 v116, v96, v176
    v_mul_f32 v117, v96, v177
    v_mul_f32 v118, v96, v178
    v_mul_f32 v119, v96, v179
    v_mul_f32 v123, v96, v159
    v_fma_f32 v120, v101, v160, v120
    s_waitcnt lgkmcnt(2)
    v_fma_f32 v116, v101, v180, v116
    v_fma_f32 v117, v101, v181, v117
    v_fma_f32 v118, v101, v182, v118
    v_fma_f32 v119, v101, v183, v119
    v_fma_f32 v121, v101, v161, v121
    v_fma_f32 v122, v101, v162, v122
    v_fma_f32 v123, v101, v163, v123
    v_fma_f32 v120, v106, v164, v120
    v_fma_f32 v121, v106, v165, v121
    v_fma_f32 v122, v106, v166, v122
    v_fma_f32 v123, v106, v167, v123
    s_waitcnt lgkmcnt(1)
    v_fma_f32 v116, v106, v184, v116
    v_fma_f32 v117, v106, v185, v117
    v_fma_f32 v118, v106, v186, v118
    v_fma_f32 v119, v106, v187, v119
    v_fma_f32 v116, v111, v188, v116
    v_fma_f32 v117, v111, v189, v117
    v_fma_f32 v118, v111, v190, v118
    v_fma_f32 v119, v111, v191, v119
    v_cvt_pk_bf16_f32 v200, v116, v117
    v_cvt_pk_bf16_f32 v201, v118, v119
    v_accvgpr_read_b32 v168, a156
    v_accvgpr_read_b32 v169, a157
    v_accvgpr_read_b32 v170, a158
    v_accvgpr_read_b32 v171, a159
    v_fma_f32 v120, v111, v168, v120
    v_fma_f32 v121, v111, v169, v121
    v_fma_f32 v122, v111, v170, v122
    v_fma_f32 v123, v111, v171, v123
    v_cvt_pk_bf16_f32 v202, v120, v121
    v_cvt_pk_bf16_f32 v203, v122, v123
    v_and_b32 v86, 1, v2
    v_cmp_eq_u32 vcc, 1, v86
    v_mul_u32_u24 v208, 272, v2
    v_lshl_add_u32 v208, v3, 4, v208
    v_cndmask_b32 v204, v200, v202, vcc
    v_cndmask_b32 v206, v202, v200, vcc
    v_cndmask_b32 v205, v201, v203, vcc
    v_cndmask_b32 v207, v203, v201, vcc
    buffer_store_dwordx4 v[204:207], v85, s[24:27], 0 offen
    v_add_u32 v208, 158720, v208
    s_waitcnt lgkmcnt(0)
    ds_read_b128 v[212:215], v208
    ds_read_b128 v[216:219], v208 offset:1088
    ds_read_b128 v[220:223], v208 offset:2176
    ds_read_b128 v[224:227], v208 offset:3264
    v_lshlrev_b32 v209, 4, v1
    s_mov_b32 s33, 12288
    s_mov_b32 s34, 13312
    s_mov_b32 s35, 14336
    s_mov_b32 s36, 15360
    s_waitcnt lgkmcnt(3)
    buffer_store_dwordx4 v[212:215], v209, s[24:27], s33 offen
    s_waitcnt lgkmcnt(2)
    buffer_store_dwordx4 v[216:219], v209, s[24:27], s34 offen
    s_waitcnt lgkmcnt(1)
    buffer_store_dwordx4 v[220:223], v209, s[24:27], s35 offen
    s_waitcnt lgkmcnt(0)
    buffer_store_dwordx4 v[224:227], v209, s[24:27], s36 offen
    s_waitcnt vmcnt(0)
    s_branch L_end
L_slow1:
    s_nop 7
    s_nop 7
    v_mov_b32 v68, v63
    v_mov_b32 v69, v63
    s_nop 0
    s_nop 0
    v_permlane32_swap_b32 v68, v69
    v_max_f32 v68, v68, v69
    v_mov_b32 v69, v68
    s_nop 0
    s_nop 0
    v_permlane16_swap_b32 v68, v69
    v_max_f32 v63, v68, v69
    v_max_f32 v63, v48, v63
    v_sub_f32 v70, v48, v63
    v_mul_f32 v70, s30, v70
    v_exp_f32 v70, v70
    v_mov_b32 v48, v63
    v_mul_f32 v53, s30, v48
    v_sub_f32 v53, 0, v53
    v_add_f32 v58, s31, v48
    v_mul_f32 v28, v70, v28
    v_mul_f32 v29, v70, v29
    v_mul_f32 v30, v70, v30
    v_mul_f32 v31, v70, v31
    v_accvgpr_read_b32 v72, a0
    v_mul_f32 v72, v70, v72
    v_accvgpr_write_b32 a0, v72
    v_accvgpr_read_b32 v73, a1
    v_mul_f32 v73, v70, v73
    v_accvgpr_write_b32 a1, v73
    v_accvgpr_read_b32 v74, a2
    v_mul_f32 v74, v70, v74
    v_accvgpr_write_b32 a2, v74
    v_accvgpr_read_b32 v75, a3
    v_mul_f32 v75, v70, v75
    v_accvgpr_write_b32 a3, v75
    v_accvgpr_read_b32 v72, a4
    v_mul_f32 v72, v70, v72
    v_accvgpr_write_b32 a4, v72
    v_accvgpr_read_b32 v73, a5
    v_mul_f32 v73, v70, v73
    v_accvgpr_write_b32 a5, v73
    v_accvgpr_read_b32 v74, a6
    v_mul_f32 v74, v70, v74
    v_accvgpr_write_b32 a6, v74
    v_accvgpr_read_b32 v75, a7
    v_mul_f32 v75, v70, v75
    v_accvgpr_write_b32 a7, v75
    v_accvgpr_read_b32 v72, a8
    v_mul_f32 v72, v70, v72
    v_accvgpr_write_b32 a8, v72
    v_accvgpr_read_b32 v73, a9
    v_mul_f32 v73, v70, v73
    v_accvgpr_write_b32 a9, v73
    v_accvgpr_read_b32 v74, a10
    v_mul_f32 v74, v70, v74
    v_accvgpr_write_b32 a10, v74
    v_accvgpr_read_b32 v75, a11
    v_mul_f32 v75, v70, v75
    v_accvgpr_write_b32 a11, v75
    v_accvgpr_read_b32 v72, a12
    v_mul_f32 v72, v70, v72
    v_accvgpr_write_b32 a12, v72
    v_accvgpr_read_b32 v73, a13
    v_mul_f32 v73, v70, v73
    v_accvgpr_write_b32 a13, v73
    v_accvgpr_read_b32 v74, a14
    v_mul_f32 v74, v70, v74
    v_accvgpr_write_b32 a14, v74
    v_accvgpr_read_b32 v75, a15
    v_mul_f32 v75, v70, v75
    v_accvgpr_write_b32 a15, v75
    v_accvgpr_read_b32 v72, a16
    v_mul_f32 v72, v70, v72
    v_accvgpr_write_b32 a16, v72
    v_accvgpr_read_b32 v73, a17
    v_mul_f32 v73, v70, v73
    v_accvgpr_write_b32 a17, v73
    v_accvgpr_read_b32 v74, a18
    v_mul_f32 v74, v70, v74
    v_accvgpr_write_b32 a18, v74
    v_accvgpr_read_b32 v75, a19
    v_mul_f32 v75, v70, v75
    v_accvgpr_write_b32 a19, v75
    v_accvgpr_read_b32 v72, a20
    v_mul_f32 v72, v70, v72
    v_accvgpr_write_b32 a20, v72
    v_accvgpr_read_b32 v73, a21
    v_mul_f32 v73, v70, v73
    v_accvgpr_write_b32 a21, v73
    v_accvgpr_read_b32 v74, a22
    v_mul_f32 v74, v70, v74
    v_accvgpr_write_b32 a22, v74
    v_accvgpr_read_b32 v75, a23
    v_mul_f32 v75, v70, v75
    v_accvgpr_write_b32 a23, v75
    v_accvgpr_read_b32 v72, a24
    v_mul_f32 v72, v70, v72
    v_accvgpr_write_b32 a24, v72
    v_accvgpr_read_b32 v73, a25
    v_mul_f32 v73, v70, v73
    v_accvgpr_write_b32 a25, v73
    v_accvgpr_read_b32 v74, a26
    v_mul_f32 v74, v70, v74
    v_accvgpr_write_b32 a26, v74
    v_accvgpr_read_b32 v75, a27
    v_mul_f32 v75, v70, v75
    v_accvgpr_write_b32 a27, v75
    v_accvgpr_read_b32 v72, a28
    v_mul_f32 v72, v70, v72
    v_accvgpr_write_b32 a28, v72
    v_accvgpr_read_b32 v73, a29
    v_mul_f32 v73, v70, v73
    v_accvgpr_write_b32 a29, v73
    v_accvgpr_read_b32 v74, a30
    v_mul_f32 v74, v70, v74
    v_accvgpr_write_b32 a30, v74
    v_accvgpr_read_b32 v75, a31
    v_mul_f32 v75, v70, v75
    v_accvgpr_write_b32 a31, v75
    v_mov_b32 v68, v64
    v_mov_b32 v69, v64
    s_nop 0
    s_nop 0
    v_permlane32_swap_b32 v68, v69
    v_max_f32 v68, v68, v69
    v_mov_b32 v69, v68
    s_nop 0
    s_nop 0
    v_permlane16_swap_b32 v68, v69
    v_max_f32 v64, v68, v69
    v_max_f32 v64, v49, v64
    v_sub_f32 v70, v49, v64
    v_mul_f32 v70, s30, v70
    v_exp_f32 v70, v70
    v_mov_b32 v49, v64
    v_mul_f32 v54, s30, v49
    v_sub_f32 v54, 0, v54
    v_add_f32 v59, s31, v49
    v_mul_f32 v32, v70, v32
    v_mul_f32 v33, v70, v33
    v_mul_f32 v34, v70, v34
    v_mul_f32 v35, v70, v35
    v_accvgpr_read_b32 v72, a32
    v_mul_f32 v72, v70, v72
    v_accvgpr_write_b32 a32, v72
    v_accvgpr_read_b32 v73, a33
    v_mul_f32 v73, v70, v73
    v_accvgpr_write_b32 a33, v73
    v_accvgpr_read_b32 v74, a34
    v_mul_f32 v74, v70, v74
    v_accvgpr_write_b32 a34, v74
    v_accvgpr_read_b32 v75, a35
    v_mul_f32 v75, v70, v75
    v_accvgpr_write_b32 a35, v75
    v_accvgpr_read_b32 v72, a36
    v_mul_f32 v72, v70, v72
    v_accvgpr_write_b32 a36, v72
    v_accvgpr_read_b32 v73, a37
    v_mul_f32 v73, v70, v73
    v_accvgpr_write_b32 a37, v73
    v_accvgpr_read_b32 v74, a38
    v_mul_f32 v74, v70, v74
    v_accvgpr_write_b32 a38, v74
    v_accvgpr_read_b32 v75, a39
    v_mul_f32 v75, v70, v75
    v_accvgpr_write_b32 a39, v75
    v_accvgpr_read_b32 v72, a40
    v_mul_f32 v72, v70, v72
    v_accvgpr_write_b32 a40, v72
    v_accvgpr_read_b32 v73, a41
    v_mul_f32 v73, v70, v73
    v_accvgpr_write_b32 a41, v73
    v_accvgpr_read_b32 v74, a42
    v_mul_f32 v74, v70, v74
    v_accvgpr_write_b32 a42, v74
    v_accvgpr_read_b32 v75, a43
    v_mul_f32 v75, v70, v75
    v_accvgpr_write_b32 a43, v75
    v_accvgpr_read_b32 v72, a44
    v_mul_f32 v72, v70, v72
    v_accvgpr_write_b32 a44, v72
    v_accvgpr_read_b32 v73, a45
    v_mul_f32 v73, v70, v73
    v_accvgpr_write_b32 a45, v73
    v_accvgpr_read_b32 v74, a46
    v_mul_f32 v74, v70, v74
    v_accvgpr_write_b32 a46, v74
    v_accvgpr_read_b32 v75, a47
    v_mul_f32 v75, v70, v75
    v_accvgpr_write_b32 a47, v75
    v_accvgpr_read_b32 v72, a48
    v_mul_f32 v72, v70, v72
    v_accvgpr_write_b32 a48, v72
    v_accvgpr_read_b32 v73, a49
    v_mul_f32 v73, v70, v73
    v_accvgpr_write_b32 a49, v73
    v_accvgpr_read_b32 v74, a50
    v_mul_f32 v74, v70, v74
    v_accvgpr_write_b32 a50, v74
    v_accvgpr_read_b32 v75, a51
    v_mul_f32 v75, v70, v75
    v_accvgpr_write_b32 a51, v75
    v_accvgpr_read_b32 v72, a52
    v_mul_f32 v72, v70, v72
    v_accvgpr_write_b32 a52, v72
    v_accvgpr_read_b32 v73, a53
    v_mul_f32 v73, v70, v73
    v_accvgpr_write_b32 a53, v73
    v_accvgpr_read_b32 v74, a54
    v_mul_f32 v74, v70, v74
    v_accvgpr_write_b32 a54, v74
    v_accvgpr_read_b32 v75, a55
    v_mul_f32 v75, v70, v75
    v_accvgpr_write_b32 a55, v75
    v_accvgpr_read_b32 v72, a56
    v_mul_f32 v72, v70, v72
    v_accvgpr_write_b32 a56, v72
    v_accvgpr_read_b32 v73, a57
    v_mul_f32 v73, v70, v73
    v_accvgpr_write_b32 a57, v73
    v_accvgpr_read_b32 v74, a58
    v_mul_f32 v74, v70, v74
    v_accvgpr_write_b32 a58, v74
    v_accvgpr_read_b32 v75, a59
    v_mul_f32 v75, v70, v75
    v_accvgpr_write_b32 a59, v75
    v_accvgpr_read_b32 v72, a60
    v_mul_f32 v72, v70, v72
    v_accvgpr_write_b32 a60, v72
    v_accvgpr_read_b32 v73, a61
    v_mul_f32 v73, v70, v73
    v_accvgpr_write_b32 a61, v73
    v_accvgpr_read_b32 v74, a62
    v_mul_f32 v74, v70, v74
    v_accvgpr_write_b32 a62, v74
    v_accvgpr_read_b32 v75, a63
    v_mul_f32 v75, v70, v75
    v_accvgpr_write_b32 a63, v75
    v_mov_b32 v68, v65
    v_mov_b32 v69, v65
    s_nop 0
    s_nop 0
    v_permlane32_swap_b32 v68, v69
    v_max_f32 v68, v68, v69
    v_mov_b32 v69, v68
    s_nop 0
    s_nop 0
    v_permlane16_swap_b32 v68, v69
    v_max_f32 v65, v68, v69
    v_max_f32 v65, v50, v65
    v_sub_f32 v70, v50, v65
    v_mul_f32 v70, s30, v70
    v_exp_f32 v70, v70
    v_mov_b32 v50, v65
    v_mul_f32 v55, s30, v50
    v_sub_f32 v55, 0, v55
    v_add_f32 v60, s31, v50
    v_mul_f32 v36, v70, v36
    v_mul_f32 v37, v70, v37
    v_mul_f32 v38, v70, v38
    v_mul_f32 v39, v70, v39
    v_accvgpr_read_b32 v72, a64
    v_mul_f32 v72, v70, v72
    v_accvgpr_write_b32 a64, v72
    v_accvgpr_read_b32 v73, a65
    v_mul_f32 v73, v70, v73
    v_accvgpr_write_b32 a65, v73
    v_accvgpr_read_b32 v74, a66
    v_mul_f32 v74, v70, v74
    v_accvgpr_write_b32 a66, v74
    v_accvgpr_read_b32 v75, a67
    v_mul_f32 v75, v70, v75
    v_accvgpr_write_b32 a67, v75
    v_accvgpr_read_b32 v72, a68
    v_mul_f32 v72, v70, v72
    v_accvgpr_write_b32 a68, v72
    v_accvgpr_read_b32 v73, a69
    v_mul_f32 v73, v70, v73
    v_accvgpr_write_b32 a69, v73
    v_accvgpr_read_b32 v74, a70
    v_mul_f32 v74, v70, v74
    v_accvgpr_write_b32 a70, v74
    v_accvgpr_read_b32 v75, a71
    v_mul_f32 v75, v70, v75
    v_accvgpr_write_b32 a71, v75
    v_accvgpr_read_b32 v72, a72
    v_mul_f32 v72, v70, v72
    v_accvgpr_write_b32 a72, v72
    v_accvgpr_read_b32 v73, a73
    v_mul_f32 v73, v70, v73
    v_accvgpr_write_b32 a73, v73
    v_accvgpr_read_b32 v74, a74
    v_mul_f32 v74, v70, v74
    v_accvgpr_write_b32 a74, v74
    v_accvgpr_read_b32 v75, a75
    v_mul_f32 v75, v70, v75
    v_accvgpr_write_b32 a75, v75
    v_accvgpr_read_b32 v72, a76
    v_mul_f32 v72, v70, v72
    v_accvgpr_write_b32 a76, v72
    v_accvgpr_read_b32 v73, a77
    v_mul_f32 v73, v70, v73
    v_accvgpr_write_b32 a77, v73
    v_accvgpr_read_b32 v74, a78
    v_mul_f32 v74, v70, v74
    v_accvgpr_write_b32 a78, v74
    v_accvgpr_read_b32 v75, a79
    v_mul_f32 v75, v70, v75
    v_accvgpr_write_b32 a79, v75
    v_accvgpr_read_b32 v72, a80
    v_mul_f32 v72, v70, v72
    v_accvgpr_write_b32 a80, v72
    v_accvgpr_read_b32 v73, a81
    v_mul_f32 v73, v70, v73
    v_accvgpr_write_b32 a81, v73
    v_accvgpr_read_b32 v74, a82
    v_mul_f32 v74, v70, v74
    v_accvgpr_write_b32 a82, v74
    v_accvgpr_read_b32 v75, a83
    v_mul_f32 v75, v70, v75
    v_accvgpr_write_b32 a83, v75
    v_accvgpr_read_b32 v72, a84
    v_mul_f32 v72, v70, v72
    v_accvgpr_write_b32 a84, v72
    v_accvgpr_read_b32 v73, a85
    v_mul_f32 v73, v70, v73
    v_accvgpr_write_b32 a85, v73
    v_accvgpr_read_b32 v74, a86
    v_mul_f32 v74, v70, v74
    v_accvgpr_write_b32 a86, v74
    v_accvgpr_read_b32 v75, a87
    v_mul_f32 v75, v70, v75
    v_accvgpr_write_b32 a87, v75
    v_accvgpr_read_b32 v72, a88
    v_mul_f32 v72, v70, v72
    v_accvgpr_write_b32 a88, v72
    v_accvgpr_read_b32 v73, a89
    v_mul_f32 v73, v70, v73
    v_accvgpr_write_b32 a89, v73
    v_accvgpr_read_b32 v74, a90
    v_mul_f32 v74, v70, v74
    v_accvgpr_write_b32 a90, v74
    v_accvgpr_read_b32 v75, a91
    v_mul_f32 v75, v70, v75
    v_accvgpr_write_b32 a91, v75
    v_accvgpr_read_b32 v72, a92
    v_mul_f32 v72, v70, v72
    v_accvgpr_write_b32 a92, v72
    v_accvgpr_read_b32 v73, a93
    v_mul_f32 v73, v70, v73
    v_accvgpr_write_b32 a93, v73
    v_accvgpr_read_b32 v74, a94
    v_mul_f32 v74, v70, v74
    v_accvgpr_write_b32 a94, v74
    v_accvgpr_read_b32 v75, a95
    v_mul_f32 v75, v70, v75
    v_accvgpr_write_b32 a95, v75
    v_mov_b32 v68, v66
    v_mov_b32 v69, v66
    s_nop 0
    s_nop 0
    v_permlane32_swap_b32 v68, v69
    v_max_f32 v68, v68, v69
    v_mov_b32 v69, v68
    s_nop 0
    s_nop 0
    v_permlane16_swap_b32 v68, v69
    v_max_f32 v66, v68, v69
    v_max_f32 v66, v51, v66
    v_sub_f32 v70, v51, v66
    v_mul_f32 v70, s30, v70
    v_exp_f32 v70, v70
    v_mov_b32 v51, v66
    v_mul_f32 v56, s30, v51
    v_sub_f32 v56, 0, v56
    v_add_f32 v61, s31, v51
    v_mul_f32 v40, v70, v40
    v_mul_f32 v41, v70, v41
    v_mul_f32 v42, v70, v42
    v_mul_f32 v43, v70, v43
    v_accvgpr_read_b32 v72, a96
    v_mul_f32 v72, v70, v72
    v_accvgpr_write_b32 a96, v72
    v_accvgpr_read_b32 v73, a97
    v_mul_f32 v73, v70, v73
    v_accvgpr_write_b32 a97, v73
    v_accvgpr_read_b32 v74, a98
    v_mul_f32 v74, v70, v74
    v_accvgpr_write_b32 a98, v74
    v_accvgpr_read_b32 v75, a99
    v_mul_f32 v75, v70, v75
    v_accvgpr_write_b32 a99, v75
    v_accvgpr_read_b32 v72, a100
    v_mul_f32 v72, v70, v72
    v_accvgpr_write_b32 a100, v72
    v_accvgpr_read_b32 v73, a101
    v_mul_f32 v73, v70, v73
    v_accvgpr_write_b32 a101, v73
    v_accvgpr_read_b32 v74, a102
    v_mul_f32 v74, v70, v74
    v_accvgpr_write_b32 a102, v74
    v_accvgpr_read_b32 v75, a103
    v_mul_f32 v75, v70, v75
    v_accvgpr_write_b32 a103, v75
    v_accvgpr_read_b32 v72, a104
    v_mul_f32 v72, v70, v72
    v_accvgpr_write_b32 a104, v72
    v_accvgpr_read_b32 v73, a105
    v_mul_f32 v73, v70, v73
    v_accvgpr_write_b32 a105, v73
    v_accvgpr_read_b32 v74, a106
    v_mul_f32 v74, v70, v74
    v_accvgpr_write_b32 a106, v74
    v_accvgpr_read_b32 v75, a107
    v_mul_f32 v75, v70, v75
    v_accvgpr_write_b32 a107, v75
    v_accvgpr_read_b32 v72, a108
    v_mul_f32 v72, v70, v72
    v_accvgpr_write_b32 a108, v72
    v_accvgpr_read_b32 v73, a109
    v_mul_f32 v73, v70, v73
    v_accvgpr_write_b32 a109, v73
    v_accvgpr_read_b32 v74, a110
    v_mul_f32 v74, v70, v74
    v_accvgpr_write_b32 a110, v74
    v_accvgpr_read_b32 v75, a111
    v_mul_f32 v75, v70, v75
    v_accvgpr_write_b32 a111, v75
    v_accvgpr_read_b32 v72, a112
    v_mul_f32 v72, v70, v72
    v_accvgpr_write_b32 a112, v72
    v_accvgpr_read_b32 v73, a113
    v_mul_f32 v73, v70, v73
    v_accvgpr_write_b32 a113, v73
    v_accvgpr_read_b32 v74, a114
    v_mul_f32 v74, v70, v74
    v_accvgpr_write_b32 a114, v74
    v_accvgpr_read_b32 v75, a115
    v_mul_f32 v75, v70, v75
    v_accvgpr_write_b32 a115, v75
    v_accvgpr_read_b32 v72, a116
    v_mul_f32 v72, v70, v72
    v_accvgpr_write_b32 a116, v72
    v_accvgpr_read_b32 v73, a117
    v_mul_f32 v73, v70, v73
    v_accvgpr_write_b32 a117, v73
    v_accvgpr_read_b32 v74, a118
    v_mul_f32 v74, v70, v74
    v_accvgpr_write_b32 a118, v74
    v_accvgpr_read_b32 v75, a119
    v_mul_f32 v75, v70, v75
    v_accvgpr_write_b32 a119, v75
    v_accvgpr_read_b32 v72, a120
    v_mul_f32 v72, v70, v72
    v_accvgpr_write_b32 a120, v72
    v_accvgpr_read_b32 v73, a121
    v_mul_f32 v73, v70, v73
    v_accvgpr_write_b32 a121, v73
    v_accvgpr_read_b32 v74, a122
    v_mul_f32 v74, v70, v74
    v_accvgpr_write_b32 a122, v74
    v_accvgpr_read_b32 v75, a123
    v_mul_f32 v75, v70, v75
    v_accvgpr_write_b32 a123, v75
    v_accvgpr_read_b32 v72, a124
    v_mul_f32 v72, v70, v72
    v_accvgpr_write_b32 a124, v72
    v_accvgpr_read_b32 v73, a125
    v_mul_f32 v73, v70, v73
    v_accvgpr_write_b32 a125, v73
    v_accvgpr_read_b32 v74, a126
    v_mul_f32 v74, v70, v74
    v_accvgpr_write_b32 a126, v74
    v_accvgpr_read_b32 v75, a127
    v_mul_f32 v75, v70, v75
    v_accvgpr_write_b32 a127, v75
    v_mov_b32 v68, v67
    v_mov_b32 v69, v67
    s_nop 0
    s_nop 0
    v_permlane32_swap_b32 v68, v69
    v_max_f32 v68, v68, v69
    v_mov_b32 v69, v68
    s_nop 0
    s_nop 0
    v_permlane16_swap_b32 v68, v69
    v_max_f32 v67, v68, v69
    v_max_f32 v67, v52, v67
    v_sub_f32 v70, v52, v67
    v_mul_f32 v70, s30, v70
    v_exp_f32 v70, v70
    v_mov_b32 v52, v67
    v_mul_f32 v57, s30, v52
    v_sub_f32 v57, 0, v57
    v_add_f32 v62, s31, v52
    v_mul_f32 v44, v70, v44
    v_mul_f32 v45, v70, v45
    v_mul_f32 v46, v70, v46
    v_mul_f32 v47, v70, v47
    v_accvgpr_read_b32 v72, a128
    v_mul_f32 v72, v70, v72
    v_accvgpr_write_b32 a128, v72
    v_accvgpr_read_b32 v73, a129
    v_mul_f32 v73, v70, v73
    v_accvgpr_write_b32 a129, v73
    v_accvgpr_read_b32 v74, a130
    v_mul_f32 v74, v70, v74
    v_accvgpr_write_b32 a130, v74
    v_accvgpr_read_b32 v75, a131
    v_mul_f32 v75, v70, v75
    v_accvgpr_write_b32 a131, v75
    v_accvgpr_read_b32 v72, a132
    v_mul_f32 v72, v70, v72
    v_accvgpr_write_b32 a132, v72
    v_accvgpr_read_b32 v73, a133
    v_mul_f32 v73, v70, v73
    v_accvgpr_write_b32 a133, v73
    v_accvgpr_read_b32 v74, a134
    v_mul_f32 v74, v70, v74
    v_accvgpr_write_b32 a134, v74
    v_accvgpr_read_b32 v75, a135
    v_mul_f32 v75, v70, v75
    v_accvgpr_write_b32 a135, v75
    v_accvgpr_read_b32 v72, a136
    v_mul_f32 v72, v70, v72
    v_accvgpr_write_b32 a136, v72
    v_accvgpr_read_b32 v73, a137
    v_mul_f32 v73, v70, v73
    v_accvgpr_write_b32 a137, v73
    v_accvgpr_read_b32 v74, a138
    v_mul_f32 v74, v70, v74
    v_accvgpr_write_b32 a138, v74
    v_accvgpr_read_b32 v75, a139
    v_mul_f32 v75, v70, v75
    v_accvgpr_write_b32 a139, v75
    v_accvgpr_read_b32 v72, a140
    v_mul_f32 v72, v70, v72
    v_accvgpr_write_b32 a140, v72
    v_accvgpr_read_b32 v73, a141
    v_mul_f32 v73, v70, v73
    v_accvgpr_write_b32 a141, v73
    v_accvgpr_read_b32 v74, a142
    v_mul_f32 v74, v70, v74
    v_accvgpr_write_b32 a142, v74
    v_accvgpr_read_b32 v75, a143
    v_mul_f32 v75, v70, v75
    v_accvgpr_write_b32 a143, v75
    v_accvgpr_read_b32 v72, a144
    v_mul_f32 v72, v70, v72
    v_accvgpr_write_b32 a144, v72
    v_accvgpr_read_b32 v73, a145
    v_mul_f32 v73, v70, v73
    v_accvgpr_write_b32 a145, v73
    v_accvgpr_read_b32 v74, a146
    v_mul_f32 v74, v70, v74
    v_accvgpr_write_b32 a146, v74
    v_accvgpr_read_b32 v75, a147
    v_mul_f32 v75, v70, v75
    v_accvgpr_write_b32 a147, v75
    v_accvgpr_read_b32 v72, a148
    v_mul_f32 v72, v70, v72
    v_accvgpr_write_b32 a148, v72
    v_accvgpr_read_b32 v73, a149
    v_mul_f32 v73, v70, v73
    v_accvgpr_write_b32 a149, v73
    v_accvgpr_read_b32 v74, a150
    v_mul_f32 v74, v70, v74
    v_accvgpr_write_b32 a150, v74
    v_accvgpr_read_b32 v75, a151
    v_mul_f32 v75, v70, v75
    v_accvgpr_write_b32 a151, v75
    v_accvgpr_read_b32 v72, a152
    v_mul_f32 v72, v70, v72
    v_accvgpr_write_b32 a152, v72
    v_accvgpr_read_b32 v73, a153
    v_mul_f32 v73, v70, v73
    v_accvgpr_write_b32 a153, v73
    v_accvgpr_read_b32 v74, a154
    v_mul_f32 v74, v70, v74
    v_accvgpr_write_b32 a154, v74
    v_accvgpr_read_b32 v75, a155
    v_mul_f32 v75, v70, v75
    v_accvgpr_write_b32 a155, v75
    v_accvgpr_read_b32 v72, a156
    v_mul_f32 v72, v70, v72
    v_accvgpr_write_b32 a156, v72
    v_accvgpr_read_b32 v73, a157
    v_mul_f32 v73, v70, v73
    v_accvgpr_write_b32 a157, v73
    v_accvgpr_read_b32 v74, a158
    v_mul_f32 v74, v70, v74
    v_accvgpr_write_b32 a158, v74
    v_accvgpr_read_b32 v75, a159
    v_mul_f32 v75, v70, v75
    v_accvgpr_write_b32 a159, v75
    s_nop 3
    s_branch L_ret1
L_slow2:
    s_nop 7
    s_nop 7
    v_mov_b32 v68, v63
    v_mov_b32 v69, v63
    s_nop 0
    s_nop 0
    v_permlane32_swap_b32 v68, v69
    v_max_f32 v68, v68, v69
    v_mov_b32 v69, v68
    s_nop 0
    s_nop 0
    v_permlane16_swap_b32 v68, v69
    v_max_f32 v63, v68, v69
    v_max_f32 v63, v48, v63
    v_sub_f32 v70, v48, v63
    v_mul_f32 v70, s30, v70
    v_exp_f32 v70, v70
    v_mov_b32 v48, v63
    v_mul_f32 v53, s30, v48
    v_sub_f32 v53, 0, v53
    v_add_f32 v58, s31, v48
    v_mul_f32 v28, v70, v28
    v_mul_f32 v29, v70, v29
    v_mul_f32 v30, v70, v30
    v_mul_f32 v31, v70, v31
    v_accvgpr_read_b32 v72, a0
    v_mul_f32 v72, v70, v72
    v_accvgpr_write_b32 a0, v72
    v_accvgpr_read_b32 v73, a1
    v_mul_f32 v73, v70, v73
    v_accvgpr_write_b32 a1, v73
    v_accvgpr_read_b32 v74, a2
    v_mul_f32 v74, v70, v74
    v_accvgpr_write_b32 a2, v74
    v_accvgpr_read_b32 v75, a3
    v_mul_f32 v75, v70, v75
    v_accvgpr_write_b32 a3, v75
    v_accvgpr_read_b32 v72, a4
    v_mul_f32 v72, v70, v72
    v_accvgpr_write_b32 a4, v72
    v_accvgpr_read_b32 v73, a5
    v_mul_f32 v73, v70, v73
    v_accvgpr_write_b32 a5, v73
    v_accvgpr_read_b32 v74, a6
    v_mul_f32 v74, v70, v74
    v_accvgpr_write_b32 a6, v74
    v_accvgpr_read_b32 v75, a7
    v_mul_f32 v75, v70, v75
    v_accvgpr_write_b32 a7, v75
    v_accvgpr_read_b32 v72, a8
    v_mul_f32 v72, v70, v72
    v_accvgpr_write_b32 a8, v72
    v_accvgpr_read_b32 v73, a9
    v_mul_f32 v73, v70, v73
    v_accvgpr_write_b32 a9, v73
    v_accvgpr_read_b32 v74, a10
    v_mul_f32 v74, v70, v74
    v_accvgpr_write_b32 a10, v74
    v_accvgpr_read_b32 v75, a11
    v_mul_f32 v75, v70, v75
    v_accvgpr_write_b32 a11, v75
    v_accvgpr_read_b32 v72, a12
    v_mul_f32 v72, v70, v72
    v_accvgpr_write_b32 a12, v72
    v_accvgpr_read_b32 v73, a13
    v_mul_f32 v73, v70, v73
    v_accvgpr_write_b32 a13, v73
    v_accvgpr_read_b32 v74, a14
    v_mul_f32 v74, v70, v74
    v_accvgpr_write_b32 a14, v74
    v_accvgpr_read_b32 v75, a15
    v_mul_f32 v75, v70, v75
    v_accvgpr_write_b32 a15, v75
    v_accvgpr_read_b32 v72, a16
    v_mul_f32 v72, v70, v72
    v_accvgpr_write_b32 a16, v72
    v_accvgpr_read_b32 v73, a17
    v_mul_f32 v73, v70, v73
    v_accvgpr_write_b32 a17, v73
    v_accvgpr_read_b32 v74, a18
    v_mul_f32 v74, v70, v74
    v_accvgpr_write_b32 a18, v74
    v_accvgpr_read_b32 v75, a19
    v_mul_f32 v75, v70, v75
    v_accvgpr_write_b32 a19, v75
    v_accvgpr_read_b32 v72, a20
    v_mul_f32 v72, v70, v72
    v_accvgpr_write_b32 a20, v72
    v_accvgpr_read_b32 v73, a21
    v_mul_f32 v73, v70, v73
    v_accvgpr_write_b32 a21, v73
    v_accvgpr_read_b32 v74, a22
    v_mul_f32 v74, v70, v74
    v_accvgpr_write_b32 a22, v74
    v_accvgpr_read_b32 v75, a23
    v_mul_f32 v75, v70, v75
    v_accvgpr_write_b32 a23, v75
    v_accvgpr_read_b32 v72, a24
    v_mul_f32 v72, v70, v72
    v_accvgpr_write_b32 a24, v72
    v_accvgpr_read_b32 v73, a25
    v_mul_f32 v73, v70, v73
    v_accvgpr_write_b32 a25, v73
    v_accvgpr_read_b32 v74, a26
    v_mul_f32 v74, v70, v74
    v_accvgpr_write_b32 a26, v74
    v_accvgpr_read_b32 v75, a27
    v_mul_f32 v75, v70, v75
    v_accvgpr_write_b32 a27, v75
    v_accvgpr_read_b32 v72, a28
    v_mul_f32 v72, v70, v72
    v_accvgpr_write_b32 a28, v72
    v_accvgpr_read_b32 v73, a29
    v_mul_f32 v73, v70, v73
    v_accvgpr_write_b32 a29, v73
    v_accvgpr_read_b32 v74, a30
    v_mul_f32 v74, v70, v74
    v_accvgpr_write_b32 a30, v74
    v_accvgpr_read_b32 v75, a31
    v_mul_f32 v75, v70, v75
    v_accvgpr_write_b32 a31, v75
    v_mov_b32 v68, v64
    v_mov_b32 v69, v64
    s_nop 0
    s_nop 0
    v_permlane32_swap_b32 v68, v69
    v_max_f32 v68, v68, v69
    v_mov_b32 v69, v68
    s_nop 0
    s_nop 0
    v_permlane16_swap_b32 v68, v69
    v_max_f32 v64, v68, v69
    v_max_f32 v64, v49, v64
    v_sub_f32 v70, v49, v64
    v_mul_f32 v70, s30, v70
    v_exp_f32 v70, v70
    v_mov_b32 v49, v64
    v_mul_f32 v54, s30, v49
    v_sub_f32 v54, 0, v54
    v_add_f32 v59, s31, v49
    v_mul_f32 v32, v70, v32
    v_mul_f32 v33, v70, v33
    v_mul_f32 v34, v70, v34
    v_mul_f32 v35, v70, v35
    v_accvgpr_read_b32 v72, a32
    v_mul_f32 v72, v70, v72
    v_accvgpr_write_b32 a32, v72
    v_accvgpr_read_b32 v73, a33
    v_mul_f32 v73, v70, v73
    v_accvgpr_write_b32 a33, v73
    v_accvgpr_read_b32 v74, a34
    v_mul_f32 v74, v70, v74
    v_accvgpr_write_b32 a34, v74
    v_accvgpr_read_b32 v75, a35
    v_mul_f32 v75, v70, v75
    v_accvgpr_write_b32 a35, v75
    v_accvgpr_read_b32 v72, a36
    v_mul_f32 v72, v70, v72
    v_accvgpr_write_b32 a36, v72
    v_accvgpr_read_b32 v73, a37
    v_mul_f32 v73, v70, v73
    v_accvgpr_write_b32 a37, v73
    v_accvgpr_read_b32 v74, a38
    v_mul_f32 v74, v70, v74
    v_accvgpr_write_b32 a38, v74
    v_accvgpr_read_b32 v75, a39
    v_mul_f32 v75, v70, v75
    v_accvgpr_write_b32 a39, v75
    v_accvgpr_read_b32 v72, a40
    v_mul_f32 v72, v70, v72
    v_accvgpr_write_b32 a40, v72
    v_accvgpr_read_b32 v73, a41
    v_mul_f32 v73, v70, v73
    v_accvgpr_write_b32 a41, v73
    v_accvgpr_read_b32 v74, a42
    v_mul_f32 v74, v70, v74
    v_accvgpr_write_b32 a42, v74
    v_accvgpr_read_b32 v75, a43
    v_mul_f32 v75, v70, v75
    v_accvgpr_write_b32 a43, v75
    v_accvgpr_read_b32 v72, a44
    v_mul_f32 v72, v70, v72
    v_accvgpr_write_b32 a44, v72
    v_accvgpr_read_b32 v73, a45
    v_mul_f32 v73, v70, v73
    v_accvgpr_write_b32 a45, v73
    v_accvgpr_read_b32 v74, a46
    v_mul_f32 v74, v70, v74
    v_accvgpr_write_b32 a46, v74
    v_accvgpr_read_b32 v75, a47
    v_mul_f32 v75, v70, v75
    v_accvgpr_write_b32 a47, v75
    v_accvgpr_read_b32 v72, a48
    v_mul_f32 v72, v70, v72
    v_accvgpr_write_b32 a48, v72
    v_accvgpr_read_b32 v73, a49
    v_mul_f32 v73, v70, v73
    v_accvgpr_write_b32 a49, v73
    v_accvgpr_read_b32 v74, a50
    v_mul_f32 v74, v70, v74
    v_accvgpr_write_b32 a50, v74
    v_accvgpr_read_b32 v75, a51
    v_mul_f32 v75, v70, v75
    v_accvgpr_write_b32 a51, v75
    v_accvgpr_read_b32 v72, a52
    v_mul_f32 v72, v70, v72
    v_accvgpr_write_b32 a52, v72
    v_accvgpr_read_b32 v73, a53
    v_mul_f32 v73, v70, v73
    v_accvgpr_write_b32 a53, v73
    v_accvgpr_read_b32 v74, a54
    v_mul_f32 v74, v70, v74
    v_accvgpr_write_b32 a54, v74
    v_accvgpr_read_b32 v75, a55
    v_mul_f32 v75, v70, v75
    v_accvgpr_write_b32 a55, v75
    v_accvgpr_read_b32 v72, a56
    v_mul_f32 v72, v70, v72
    v_accvgpr_write_b32 a56, v72
    v_accvgpr_read_b32 v73, a57
    v_mul_f32 v73, v70, v73
    v_accvgpr_write_b32 a57, v73
    v_accvgpr_read_b32 v74, a58
    v_mul_f32 v74, v70, v74
    v_accvgpr_write_b32 a58, v74
    v_accvgpr_read_b32 v75, a59
    v_mul_f32 v75, v70, v75
    v_accvgpr_write_b32 a59, v75
    v_accvgpr_read_b32 v72, a60
    v_mul_f32 v72, v70, v72
    v_accvgpr_write_b32 a60, v72
    v_accvgpr_read_b32 v73, a61
    v_mul_f32 v73, v70, v73
    v_accvgpr_write_b32 a61, v73
    v_accvgpr_read_b32 v74, a62
    v_mul_f32 v74, v70, v74
    v_accvgpr_write_b32 a62, v74
    v_accvgpr_read_b32 v75, a63
    v_mul_f32 v75, v70, v75
    v_accvgpr_write_b32 a63, v75
    v_mov_b32 v68, v65
    v_mov_b32 v69, v65
    s_nop 0
    s_nop 0
    v_permlane32_swap_b32 v68, v69
    v_max_f32 v68, v68, v69
    v_mov_b32 v69, v68
    s_nop 0
    s_nop 0
    v_permlane16_swap_b32 v68, v69
    v_max_f32 v65, v68, v69
    v_max_f32 v65, v50, v65
    v_sub_f32 v70, v50, v65
    v_mul_f32 v70, s30, v70
    v_exp_f32 v70, v70
    v_mov_b32 v50, v65
    v_mul_f32 v55, s30, v50
    v_sub_f32 v55, 0, v55
    v_add_f32 v60, s31, v50
    v_mul_f32 v36, v70, v36
    v_mul_f32 v37, v70, v37
    v_mul_f32 v38, v70, v38
    v_mul_f32 v39, v70, v39
    v_accvgpr_read_b32 v72, a64
    v_mul_f32 v72, v70, v72
    v_accvgpr_write_b32 a64, v72
    v_accvgpr_read_b32 v73, a65
    v_mul_f32 v73, v70, v73
    v_accvgpr_write_b32 a65, v73
    v_accvgpr_read_b32 v74, a66
    v_mul_f32 v74, v70, v74
    v_accvgpr_write_b32 a66, v74
    v_accvgpr_read_b32 v75, a67
    v_mul_f32 v75, v70, v75
    v_accvgpr_write_b32 a67, v75
    v_accvgpr_read_b32 v72, a68
    v_mul_f32 v72, v70, v72
    v_accvgpr_write_b32 a68, v72
    v_accvgpr_read_b32 v73, a69
    v_mul_f32 v73, v70, v73
    v_accvgpr_write_b32 a69, v73
    v_accvgpr_read_b32 v74, a70
    v_mul_f32 v74, v70, v74
    v_accvgpr_write_b32 a70, v74
    v_accvgpr_read_b32 v75, a71
    v_mul_f32 v75, v70, v75
    v_accvgpr_write_b32 a71, v75
    v_accvgpr_read_b32 v72, a72
    v_mul_f32 v72, v70, v72
    v_accvgpr_write_b32 a72, v72
    v_accvgpr_read_b32 v73, a73
    v_mul_f32 v73, v70, v73
    v_accvgpr_write_b32 a73, v73
    v_accvgpr_read_b32 v74, a74
    v_mul_f32 v74, v70, v74
    v_accvgpr_write_b32 a74, v74
    v_accvgpr_read_b32 v75, a75
    v_mul_f32 v75, v70, v75
    v_accvgpr_write_b32 a75, v75
    v_accvgpr_read_b32 v72, a76
    v_mul_f32 v72, v70, v72
    v_accvgpr_write_b32 a76, v72
    v_accvgpr_read_b32 v73, a77
    v_mul_f32 v73, v70, v73
    v_accvgpr_write_b32 a77, v73
    v_accvgpr_read_b32 v74, a78
    v_mul_f32 v74, v70, v74
    v_accvgpr_write_b32 a78, v74
    v_accvgpr_read_b32 v75, a79
    v_mul_f32 v75, v70, v75
    v_accvgpr_write_b32 a79, v75
    v_accvgpr_read_b32 v72, a80
    v_mul_f32 v72, v70, v72
    v_accvgpr_write_b32 a80, v72
    v_accvgpr_read_b32 v73, a81
    v_mul_f32 v73, v70, v73
    v_accvgpr_write_b32 a81, v73
    v_accvgpr_read_b32 v74, a82
    v_mul_f32 v74, v70, v74
    v_accvgpr_write_b32 a82, v74
    v_accvgpr_read_b32 v75, a83
    v_mul_f32 v75, v70, v75
    v_accvgpr_write_b32 a83, v75
    v_accvgpr_read_b32 v72, a84
    v_mul_f32 v72, v70, v72
    v_accvgpr_write_b32 a84, v72
    v_accvgpr_read_b32 v73, a85
    v_mul_f32 v73, v70, v73
    v_accvgpr_write_b32 a85, v73
    v_accvgpr_read_b32 v74, a86
    v_mul_f32 v74, v70, v74
    v_accvgpr_write_b32 a86, v74
    v_accvgpr_read_b32 v75, a87
    v_mul_f32 v75, v70, v75
    v_accvgpr_write_b32 a87, v75
    v_accvgpr_read_b32 v72, a88
    v_mul_f32 v72, v70, v72
    v_accvgpr_write_b32 a88, v72
    v_accvgpr_read_b32 v73, a89
    v_mul_f32 v73, v70, v73
    v_accvgpr_write_b32 a89, v73
    v_accvgpr_read_b32 v74, a90
    v_mul_f32 v74, v70, v74
    v_accvgpr_write_b32 a90, v74
    v_accvgpr_read_b32 v75, a91
    v_mul_f32 v75, v70, v75
    v_accvgpr_write_b32 a91, v75
    v_accvgpr_read_b32 v72, a92
    v_mul_f32 v72, v70, v72
    v_accvgpr_write_b32 a92, v72
    v_accvgpr_read_b32 v73, a93
    v_mul_f32 v73, v70, v73
    v_accvgpr_write_b32 a93, v73
    v_accvgpr_read_b32 v74, a94
    v_mul_f32 v74, v70, v74
    v_accvgpr_write_b32 a94, v74
    v_accvgpr_read_b32 v75, a95
    v_mul_f32 v75, v70, v75
    v_accvgpr_write_b32 a95, v75
    v_mov_b32 v68, v66
    v_mov_b32 v69, v66
    s_nop 0
    s_nop 0
    v_permlane32_swap_b32 v68, v69
    v_max_f32 v68, v68, v69
    v_mov_b32 v69, v68
    s_nop 0
    s_nop 0
    v_permlane16_swap_b32 v68, v69
    v_max_f32 v66, v68, v69
    v_max_f32 v66, v51, v66
    v_sub_f32 v70, v51, v66
    v_mul_f32 v70, s30, v70
    v_exp_f32 v70, v70
    v_mov_b32 v51, v66
    v_mul_f32 v56, s30, v51
    v_sub_f32 v56, 0, v56
    v_add_f32 v61, s31, v51
    v_mul_f32 v40, v70, v40
    v_mul_f32 v41, v70, v41
    v_mul_f32 v42, v70, v42
    v_mul_f32 v43, v70, v43
    v_accvgpr_read_b32 v72, a96
    v_mul_f32 v72, v70, v72
    v_accvgpr_write_b32 a96, v72
    v_accvgpr_read_b32 v73, a97
    v_mul_f32 v73, v70, v73
    v_accvgpr_write_b32 a97, v73
    v_accvgpr_read_b32 v74, a98
    v_mul_f32 v74, v70, v74
    v_accvgpr_write_b32 a98, v74
    v_accvgpr_read_b32 v75, a99
    v_mul_f32 v75, v70, v75
    v_accvgpr_write_b32 a99, v75
    v_accvgpr_read_b32 v72, a100
    v_mul_f32 v72, v70, v72
    v_accvgpr_write_b32 a100, v72
    v_accvgpr_read_b32 v73, a101
    v_mul_f32 v73, v70, v73
    v_accvgpr_write_b32 a101, v73
    v_accvgpr_read_b32 v74, a102
    v_mul_f32 v74, v70, v74
    v_accvgpr_write_b32 a102, v74
    v_accvgpr_read_b32 v75, a103
    v_mul_f32 v75, v70, v75
    v_accvgpr_write_b32 a103, v75
    v_accvgpr_read_b32 v72, a104
    v_mul_f32 v72, v70, v72
    v_accvgpr_write_b32 a104, v72
    v_accvgpr_read_b32 v73, a105
    v_mul_f32 v73, v70, v73
    v_accvgpr_write_b32 a105, v73
    v_accvgpr_read_b32 v74, a106
    v_mul_f32 v74, v70, v74
    v_accvgpr_write_b32 a106, v74
    v_accvgpr_read_b32 v75, a107
    v_mul_f32 v75, v70, v75
    v_accvgpr_write_b32 a107, v75
    v_accvgpr_read_b32 v72, a108
    v_mul_f32 v72, v70, v72
    v_accvgpr_write_b32 a108, v72
    v_accvgpr_read_b32 v73, a109
    v_mul_f32 v73, v70, v73
    v_accvgpr_write_b32 a109, v73
    v_accvgpr_read_b32 v74, a110
    v_mul_f32 v74, v70, v74
    v_accvgpr_write_b32 a110, v74
    v_accvgpr_read_b32 v75, a111
    v_mul_f32 v75, v70, v75
    v_accvgpr_write_b32 a111, v75
    v_accvgpr_read_b32 v72, a112
    v_mul_f32 v72, v70, v72
    v_accvgpr_write_b32 a112, v72
    v_accvgpr_read_b32 v73, a113
    v_mul_f32 v73, v70, v73
    v_accvgpr_write_b32 a113, v73
    v_accvgpr_read_b32 v74, a114
    v_mul_f32 v74, v70, v74
    v_accvgpr_write_b32 a114, v74
    v_accvgpr_read_b32 v75, a115
    v_mul_f32 v75, v70, v75
    v_accvgpr_write_b32 a115, v75
    v_accvgpr_read_b32 v72, a116
    v_mul_f32 v72, v70, v72
    v_accvgpr_write_b32 a116, v72
    v_accvgpr_read_b32 v73, a117
    v_mul_f32 v73, v70, v73
    v_accvgpr_write_b32 a117, v73
    v_accvgpr_read_b32 v74, a118
    v_mul_f32 v74, v70, v74
    v_accvgpr_write_b32 a118, v74
    v_accvgpr_read_b32 v75, a119
    v_mul_f32 v75, v70, v75
    v_accvgpr_write_b32 a119, v75
    v_accvgpr_read_b32 v72, a120
    v_mul_f32 v72, v70, v72
    v_accvgpr_write_b32 a120, v72
    v_accvgpr_read_b32 v73, a121
    v_mul_f32 v73, v70, v73
    v_accvgpr_write_b32 a121, v73
    v_accvgpr_read_b32 v74, a122
    v_mul_f32 v74, v70, v74
    v_accvgpr_write_b32 a122, v74
    v_accvgpr_read_b32 v75, a123
    v_mul_f32 v75, v70, v75
    v_accvgpr_write_b32 a123, v75
    v_accvgpr_read_b32 v72, a124
    v_mul_f32 v72, v70, v72
    v_accvgpr_write_b32 a124, v72
    v_accvgpr_read_b32 v73, a125
    v_mul_f32 v73, v70, v73
    v_accvgpr_write_b32 a125, v73
    v_accvgpr_read_b32 v74, a126
    v_mul_f32 v74, v70, v74
    v_accvgpr_write_b32 a126, v74
    v_accvgpr_read_b32 v75, a127
    v_mul_f32 v75, v70, v75
    v_accvgpr_write_b32 a127, v75
    v_mov_b32 v68, v67
    v_mov_b32 v69, v67
    s_nop 0
    s_nop 0
    v_permlane32_swap_b32 v68, v69
    v_max_f32 v68, v68, v69
    v_mov_b32 v69, v68
    s_nop 0
    s_nop 0
    v_permlane16_swap_b32 v68, v69
    v_max_f32 v67, v68, v69
    v_max_f32 v67, v52, v67
    v_sub_f32 v70, v52, v67
    v_mul_f32 v70, s30, v70
    v_exp_f32 v70, v70
    v_mov_b32 v52, v67
    v_mul_f32 v57, s30, v52
    v_sub_f32 v57, 0, v57
    v_add_f32 v62, s31, v52
    v_mul_f32 v44, v70, v44
    v_mul_f32 v45, v70, v45
    v_mul_f32 v46, v70, v46
    v_mul_f32 v47, v70, v47
    v_accvgpr_read_b32 v72, a128
    v_mul_f32 v72, v70, v72
    v_accvgpr_write_b32 a128, v72
    v_accvgpr_read_b32 v73, a129
    v_mul_f32 v73, v70, v73
    v_accvgpr_write_b32 a129, v73
    v_accvgpr_read_b32 v74, a130
    v_mul_f32 v74, v70, v74
    v_accvgpr_write_b32 a130, v74
    v_accvgpr_read_b32 v75, a131
    v_mul_f32 v75, v70, v75
    v_accvgpr_write_b32 a131, v75
    v_accvgpr_read_b32 v72, a132
    v_mul_f32 v72, v70, v72
    v_accvgpr_write_b32 a132, v72
    v_accvgpr_read_b32 v73, a133
    v_mul_f32 v73, v70, v73
    v_accvgpr_write_b32 a133, v73
    v_accvgpr_read_b32 v74, a134
    v_mul_f32 v74, v70, v74
    v_accvgpr_write_b32 a134, v74
    v_accvgpr_read_b32 v75, a135
    v_mul_f32 v75, v70, v75
    v_accvgpr_write_b32 a135, v75
    v_accvgpr_read_b32 v72, a136
    v_mul_f32 v72, v70, v72
    v_accvgpr_write_b32 a136, v72
    v_accvgpr_read_b32 v73, a137
    v_mul_f32 v73, v70, v73
    v_accvgpr_write_b32 a137, v73
    v_accvgpr_read_b32 v74, a138
    v_mul_f32 v74, v70, v74
    v_accvgpr_write_b32 a138, v74
    v_accvgpr_read_b32 v75, a139
    v_mul_f32 v75, v70, v75
    v_accvgpr_write_b32 a139, v75
    v_accvgpr_read_b32 v72, a140
    v_mul_f32 v72, v70, v72
    v_accvgpr_write_b32 a140, v72
    v_accvgpr_read_b32 v73, a141
    v_mul_f32 v73, v70, v73
    v_accvgpr_write_b32 a141, v73
    v_accvgpr_read_b32 v74, a142
    v_mul_f32 v74, v70, v74
    v_accvgpr_write_b32 a142, v74
    v_accvgpr_read_b32 v75, a143
    v_mul_f32 v75, v70, v75
    v_accvgpr_write_b32 a143, v75
    v_accvgpr_read_b32 v72, a144
    v_mul_f32 v72, v70, v72
    v_accvgpr_write_b32 a144, v72
    v_accvgpr_read_b32 v73, a145
    v_mul_f32 v73, v70, v73
    v_accvgpr_write_b32 a145, v73
    v_accvgpr_read_b32 v74, a146
    v_mul_f32 v74, v70, v74
    v_accvgpr_write_b32 a146, v74
    v_accvgpr_read_b32 v75, a147
    v_mul_f32 v75, v70, v75
    v_accvgpr_write_b32 a147, v75
    v_accvgpr_read_b32 v72, a148
    v_mul_f32 v72, v70, v72
    v_accvgpr_write_b32 a148, v72
    v_accvgpr_read_b32 v73, a149
    v_mul_f32 v73, v70, v73
    v_accvgpr_write_b32 a149, v73
    v_accvgpr_read_b32 v74, a150
    v_mul_f32 v74, v70, v74
    v_accvgpr_write_b32 a150, v74
    v_accvgpr_read_b32 v75, a151
    v_mul_f32 v75, v70, v75
    v_accvgpr_write_b32 a151, v75
    v_accvgpr_read_b32 v72, a152
    v_mul_f32 v72, v70, v72
    v_accvgpr_write_b32 a152, v72
    v_accvgpr_read_b32 v73, a153
    v_mul_f32 v73, v70, v73
    v_accvgpr_write_b32 a153, v73
    v_accvgpr_read_b32 v74, a154
    v_mul_f32 v74, v70, v74
    v_accvgpr_write_b32 a154, v74
    v_accvgpr_read_b32 v75, a155
    v_mul_f32 v75, v70, v75
    v_accvgpr_write_b32 a155, v75
    v_accvgpr_read_b32 v72, a156
    v_mul_f32 v72, v70, v72
    v_accvgpr_write_b32 a156, v72
    v_accvgpr_read_b32 v73, a157
    v_mul_f32 v73, v70, v73
    v_accvgpr_write_b32 a157, v73
    v_accvgpr_read_b32 v74, a158
    v_mul_f32 v74, v70, v74
    v_accvgpr_write_b32 a158, v74
    v_accvgpr_read_b32 v75, a159
    v_mul_f32 v75, v70, v75
    v_accvgpr_write_b32 a159, v75
    s_nop 3
    s_branch L_ret2
L_slow3:
    s_nop 7
    s_nop 7
    v_mov_b32 v68, v63
    v_mov_b32 v69, v63
    s_nop 0
    s_nop 0
    v_permlane32_swap_b32 v68, v69
    v_max_f32 v68, v68, v69
    v_mov_b32 v69, v68
    s_nop 0
    s_nop 0
    v_permlane16_swap_b32 v68, v69
    v_max_f32 v63, v68, v69
    v_max_f32 v63, v48, v63
    v_sub_f32 v70, v48, v63
    v_mul_f32 v70, s30, v70
    v_exp_f32 v70, v70
    v_mov_b32 v48, v63
    v_mul_f32 v53, s30, v48
    v_sub_f32 v53, 0, v53
    v_add_f32 v58, s31, v48
    v_mul_f32 v28, v70, v28
    v_mul_f32 v29, v70, v29
    v_mul_f32 v30, v70, v30
    v_mul_f32 v31, v70, v31
    v_accvgpr_read_b32 v72, a0
    v_mul_f32 v72, v70, v72
    v_accvgpr_write_b32 a0, v72
    v_accvgpr_read_b32 v73, a1
    v_mul_f32 v73, v70, v73
    v_accvgpr_write_b32 a1, v73
    v_accvgpr_read_b32 v74, a2
    v_mul_f32 v74, v70, v74
    v_accvgpr_write_b32 a2, v74
    v_accvgpr_read_b32 v75, a3
    v_mul_f32 v75, v70, v75
    v_accvgpr_write_b32 a3, v75
    v_accvgpr_read_b32 v72, a4
    v_mul_f32 v72, v70, v72
    v_accvgpr_write_b32 a4, v72
    v_accvgpr_read_b32 v73, a5
    v_mul_f32 v73, v70, v73
    v_accvgpr_write_b32 a5, v73
    v_accvgpr_read_b32 v74, a6
    v_mul_f32 v74, v70, v74
    v_accvgpr_write_b32 a6, v74
    v_accvgpr_read_b32 v75, a7
    v_mul_f32 v75, v70, v75
    v_accvgpr_write_b32 a7, v75
    v_accvgpr_read_b32 v72, a8
    v_mul_f32 v72, v70, v72
    v_accvgpr_write_b32 a8, v72
    v_accvgpr_read_b32 v73, a9
    v_mul_f32 v73, v70, v73
    v_accvgpr_write_b32 a9, v73
    v_accvgpr_read_b32 v74, a10
    v_mul_f32 v74, v70, v74
    v_accvgpr_write_b32 a10, v74
    v_accvgpr_read_b32 v75, a11
    v_mul_f32 v75, v70, v75
    v_accvgpr_write_b32 a11, v75
    v_accvgpr_read_b32 v72, a12
    v_mul_f32 v72, v70, v72
    v_accvgpr_write_b32 a12, v72
    v_accvgpr_read_b32 v73, a13
    v_mul_f32 v73, v70, v73
    v_accvgpr_write_b32 a13, v73
    v_accvgpr_read_b32 v74, a14
    v_mul_f32 v74, v70, v74
    v_accvgpr_write_b32 a14, v74
    v_accvgpr_read_b32 v75, a15
    v_mul_f32 v75, v70, v75
    v_accvgpr_write_b32 a15, v75
    v_accvgpr_read_b32 v72, a16
    v_mul_f32 v72, v70, v72
    v_accvgpr_write_b32 a16, v72
    v_accvgpr_read_b32 v73, a17
    v_mul_f32 v73, v70, v73
    v_accvgpr_write_b32 a17, v73
    v_accvgpr_read_b32 v74, a18
    v_mul_f32 v74, v70, v74
    v_accvgpr_write_b32 a18, v74
    v_accvgpr_read_b32 v75, a19
    v_mul_f32 v75, v70, v75
    v_accvgpr_write_b32 a19, v75
    v_accvgpr_read_b32 v72, a20
    v_mul_f32 v72, v70, v72
    v_accvgpr_write_b32 a20, v72
    v_accvgpr_read_b32 v73, a21
    v_mul_f32 v73, v70, v73
    v_accvgpr_write_b32 a21, v73
    v_accvgpr_read_b32 v74, a22
    v_mul_f32 v74, v70, v74
    v_accvgpr_write_b32 a22, v74
    v_accvgpr_read_b32 v75, a23
    v_mul_f32 v75, v70, v75
    v_accvgpr_write_b32 a23, v75
    v_accvgpr_read_b32 v72, a24
    v_mul_f32 v72, v70, v72
    v_accvgpr_write_b32 a24, v72
    v_accvgpr_read_b32 v73, a25
    v_mul_f32 v73, v70, v73
    v_accvgpr_write_b32 a25, v73
    v_accvgpr_read_b32 v74, a26
    v_mul_f32 v74, v70, v74
    v_accvgpr_write_b32 a26, v74
    v_accvgpr_read_b32 v75, a27
    v_mul_f32 v75, v70, v75
    v_accvgpr_write_b32 a27, v75
    v_accvgpr_read_b32 v72, a28
    v_mul_f32 v72, v70, v72
    v_accvgpr_write_b32 a28, v72
    v_accvgpr_read_b32 v73, a29
    v_mul_f32 v73, v70, v73
    v_accvgpr_write_b32 a29, v73
    v_accvgpr_read_b32 v74, a30
    v_mul_f32 v74, v70, v74
    v_accvgpr_write_b32 a30, v74
    v_accvgpr_read_b32 v75, a31
    v_mul_f32 v75, v70, v75
    v_accvgpr_write_b32 a31, v75
    v_mov_b32 v68, v64
    v_mov_b32 v69, v64
    s_nop 0
    s_nop 0
    v_permlane32_swap_b32 v68, v69
    v_max_f32 v68, v68, v69
    v_mov_b32 v69, v68
    s_nop 0
    s_nop 0
    v_permlane16_swap_b32 v68, v69
    v_max_f32 v64, v68, v69
    v_max_f32 v64, v49, v64
    v_sub_f32 v70, v49, v64
    v_mul_f32 v70, s30, v70
    v_exp_f32 v70, v70
    v_mov_b32 v49, v64
    v_mul_f32 v54, s30, v49
    v_sub_f32 v54, 0, v54
    v_add_f32 v59, s31, v49
    v_mul_f32 v32, v70, v32
    v_mul_f32 v33, v70, v33
    v_mul_f32 v34, v70, v34
    v_mul_f32 v35, v70, v35
    v_accvgpr_read_b32 v72, a32
    v_mul_f32 v72, v70, v72
    v_accvgpr_write_b32 a32, v72
    v_accvgpr_read_b32 v73, a33
    v_mul_f32 v73, v70, v73
    v_accvgpr_write_b32 a33, v73
    v_accvgpr_read_b32 v74, a34
    v_mul_f32 v74, v70, v74
    v_accvgpr_write_b32 a34, v74
    v_accvgpr_read_b32 v75, a35
    v_mul_f32 v75, v70, v75
    v_accvgpr_write_b32 a35, v75
    v_accvgpr_read_b32 v72, a36
    v_mul_f32 v72, v70, v72
    v_accvgpr_write_b32 a36, v72
    v_accvgpr_read_b32 v73, a37
    v_mul_f32 v73, v70, v73
    v_accvgpr_write_b32 a37, v73
    v_accvgpr_read_b32 v74, a38
    v_mul_f32 v74, v70, v74
    v_accvgpr_write_b32 a38, v74
    v_accvgpr_read_b32 v75, a39
    v_mul_f32 v75, v70, v75
    v_accvgpr_write_b32 a39, v75
    v_accvgpr_read_b32 v72, a40
    v_mul_f32 v72, v70, v72
    v_accvgpr_write_b32 a40, v72
    v_accvgpr_read_b32 v73, a41
    v_mul_f32 v73, v70, v73
    v_accvgpr_write_b32 a41, v73
    v_accvgpr_read_b32 v74, a42
    v_mul_f32 v74, v70, v74
    v_accvgpr_write_b32 a42, v74
    v_accvgpr_read_b32 v75, a43
    v_mul_f32 v75, v70, v75
    v_accvgpr_write_b32 a43, v75
    v_accvgpr_read_b32 v72, a44
    v_mul_f32 v72, v70, v72
    v_accvgpr_write_b32 a44, v72
    v_accvgpr_read_b32 v73, a45
    v_mul_f32 v73, v70, v73
    v_accvgpr_write_b32 a45, v73
    v_accvgpr_read_b32 v74, a46
    v_mul_f32 v74, v70, v74
    v_accvgpr_write_b32 a46, v74
    v_accvgpr_read_b32 v75, a47
    v_mul_f32 v75, v70, v75
    v_accvgpr_write_b32 a47, v75
    v_accvgpr_read_b32 v72, a48
    v_mul_f32 v72, v70, v72
    v_accvgpr_write_b32 a48, v72
    v_accvgpr_read_b32 v73, a49
    v_mul_f32 v73, v70, v73
    v_accvgpr_write_b32 a49, v73
    v_accvgpr_read_b32 v74, a50
    v_mul_f32 v74, v70, v74
    v_accvgpr_write_b32 a50, v74
    v_accvgpr_read_b32 v75, a51
    v_mul_f32 v75, v70, v75
    v_accvgpr_write_b32 a51, v75
    v_accvgpr_read_b32 v72, a52
    v_mul_f32 v72, v70, v72
    v_accvgpr_write_b32 a52, v72
    v_accvgpr_read_b32 v73, a53
    v_mul_f32 v73, v70, v73
    v_accvgpr_write_b32 a53, v73
    v_accvgpr_read_b32 v74, a54
    v_mul_f32 v74, v70, v74
    v_accvgpr_write_b32 a54, v74
    v_accvgpr_read_b32 v75, a55
    v_mul_f32 v75, v70, v75
    v_accvgpr_write_b32 a55, v75
    v_accvgpr_read_b32 v72, a56
    v_mul_f32 v72, v70, v72
    v_accvgpr_write_b32 a56, v72
    v_accvgpr_read_b32 v73, a57
    v_mul_f32 v73, v70, v73
    v_accvgpr_write_b32 a57, v73
    v_accvgpr_read_b32 v74, a58
    v_mul_f32 v74, v70, v74
    v_accvgpr_write_b32 a58, v74
    v_accvgpr_read_b32 v75, a59
    v_mul_f32 v75, v70, v75
    v_accvgpr_write_b32 a59, v75
    v_accvgpr_read_b32 v72, a60
    v_mul_f32 v72, v70, v72
    v_accvgpr_write_b32 a60, v72
    v_accvgpr_read_b32 v73, a61
    v_mul_f32 v73, v70, v73
    v_accvgpr_write_b32 a61, v73
    v_accvgpr_read_b32 v74, a62
    v_mul_f32 v74, v70, v74
    v_accvgpr_write_b32 a62, v74
    v_accvgpr_read_b32 v75, a63
    v_mul_f32 v75, v70, v75
    v_accvgpr_write_b32 a63, v75
    v_mov_b32 v68, v65
    v_mov_b32 v69, v65
    s_nop 0
    s_nop 0
    v_permlane32_swap_b32 v68, v69
    v_max_f32 v68, v68, v69
    v_mov_b32 v69, v68
    s_nop 0
    s_nop 0
    v_permlane16_swap_b32 v68, v69
    v_max_f32 v65, v68, v69
    v_max_f32 v65, v50, v65
    v_sub_f32 v70, v50, v65
    v_mul_f32 v70, s30, v70
    v_exp_f32 v70, v70
    v_mov_b32 v50, v65
    v_mul_f32 v55, s30, v50
    v_sub_f32 v55, 0, v55
    v_add_f32 v60, s31, v50
    v_mul_f32 v36, v70, v36
    v_mul_f32 v37, v70, v37
    v_mul_f32 v38, v70, v38
    v_mul_f32 v39, v70, v39
    v_accvgpr_read_b32 v72, a64
    v_mul_f32 v72, v70, v72
    v_accvgpr_write_b32 a64, v72
    v_accvgpr_read_b32 v73, a65
    v_mul_f32 v73, v70, v73
    v_accvgpr_write_b32 a65, v73
    v_accvgpr_read_b32 v74, a66
    v_mul_f32 v74, v70, v74
    v_accvgpr_write_b32 a66, v74
    v_accvgpr_read_b32 v75, a67
    v_mul_f32 v75, v70, v75
    v_accvgpr_write_b32 a67, v75
    v_accvgpr_read_b32 v72, a68
    v_mul_f32 v72, v70, v72
    v_accvgpr_write_b32 a68, v72
    v_accvgpr_read_b32 v73, a69
    v_mul_f32 v73, v70, v73
    v_accvgpr_write_b32 a69, v73
    v_accvgpr_read_b32 v74, a70
    v_mul_f32 v74, v70, v74
    v_accvgpr_write_b32 a70, v74
    v_accvgpr_read_b32 v75, a71
    v_mul_f32 v75, v70, v75
    v_accvgpr_write_b32 a71, v75
    v_accvgpr_read_b32 v72, a72
    v_mul_f32 v72, v70, v72
    v_accvgpr_write_b32 a72, v72
    v_accvgpr_read_b32 v73, a73
    v_mul_f32 v73, v70, v73
    v_accvgpr_write_b32 a73, v73
    v_accvgpr_read_b32 v74, a74
    v_mul_f32 v74, v70, v74
    v_accvgpr_write_b32 a74, v74
    v_accvgpr_read_b32 v75, a75
    v_mul_f32 v75, v70, v75
    v_accvgpr_write_b32 a75, v75
    v_accvgpr_read_b32 v72, a76
    v_mul_f32 v72, v70, v72
    v_accvgpr_write_b32 a76, v72
    v_accvgpr_read_b32 v73, a77
    v_mul_f32 v73, v70, v73
    v_accvgpr_write_b32 a77, v73
    v_accvgpr_read_b32 v74, a78
    v_mul_f32 v74, v70, v74
    v_accvgpr_write_b32 a78, v74
    v_accvgpr_read_b32 v75, a79
    v_mul_f32 v75, v70, v75
    v_accvgpr_write_b32 a79, v75
    v_accvgpr_read_b32 v72, a80
    v_mul_f32 v72, v70, v72
    v_accvgpr_write_b32 a80, v72
    v_accvgpr_read_b32 v73, a81
    v_mul_f32 v73, v70, v73
    v_accvgpr_write_b32 a81, v73
    v_accvgpr_read_b32 v74, a82
    v_mul_f32 v74, v70, v74
    v_accvgpr_write_b32 a82, v74
    v_accvgpr_read_b32 v75, a83
    v_mul_f32 v75, v70, v75
    v_accvgpr_write_b32 a83, v75
    v_accvgpr_read_b32 v72, a84
    v_mul_f32 v72, v70, v72
    v_accvgpr_write_b32 a84, v72
    v_accvgpr_read_b32 v73, a85
    v_mul_f32 v73, v70, v73
    v_accvgpr_write_b32 a85, v73
    v_accvgpr_read_b32 v74, a86
    v_mul_f32 v74, v70, v74
    v_accvgpr_write_b32 a86, v74
    v_accvgpr_read_b32 v75, a87
    v_mul_f32 v75, v70, v75
    v_accvgpr_write_b32 a87, v75
    v_accvgpr_read_b32 v72, a88
    v_mul_f32 v72, v70, v72
    v_accvgpr_write_b32 a88, v72
    v_accvgpr_read_b32 v73, a89
    v_mul_f32 v73, v70, v73
    v_accvgpr_write_b32 a89, v73
    v_accvgpr_read_b32 v74, a90
    v_mul_f32 v74, v70, v74
    v_accvgpr_write_b32 a90, v74
    v_accvgpr_read_b32 v75, a91
    v_mul_f32 v75, v70, v75
    v_accvgpr_write_b32 a91, v75
    v_accvgpr_read_b32 v72, a92
    v_mul_f32 v72, v70, v72
    v_accvgpr_write_b32 a92, v72
    v_accvgpr_read_b32 v73, a93
    v_mul_f32 v73, v70, v73
    v_accvgpr_write_b32 a93, v73
    v_accvgpr_read_b32 v74, a94
    v_mul_f32 v74, v70, v74
    v_accvgpr_write_b32 a94, v74
    v_accvgpr_read_b32 v75, a95
    v_mul_f32 v75, v70, v75
    v_accvgpr_write_b32 a95, v75
    v_mov_b32 v68, v66
    v_mov_b32 v69, v66
    s_nop 0
    s_nop 0
    v_permlane32_swap_b32 v68, v69
    v_max_f32 v68, v68, v69
    v_mov_b32 v69, v68
    s_nop 0
    s_nop 0
    v_permlane16_swap_b32 v68, v69
    v_max_f32 v66, v68, v69
    v_max_f32 v66, v51, v66
    v_sub_f32 v70, v51, v66
    v_mul_f32 v70, s30, v70
    v_exp_f32 v70, v70
    v_mov_b32 v51, v66
    v_mul_f32 v56, s30, v51
    v_sub_f32 v56, 0, v56
    v_add_f32 v61, s31, v51
    v_mul_f32 v40, v70, v40
    v_mul_f32 v41, v70, v41
    v_mul_f32 v42, v70, v42
    v_mul_f32 v43, v70, v43
    v_accvgpr_read_b32 v72, a96
    v_mul_f32 v72, v70, v72
    v_accvgpr_write_b32 a96, v72
    v_accvgpr_read_b32 v73, a97
    v_mul_f32 v73, v70, v73
    v_accvgpr_write_b32 a97, v73
    v_accvgpr_read_b32 v74, a98
    v_mul_f32 v74, v70, v74
    v_accvgpr_write_b32 a98, v74
    v_accvgpr_read_b32 v75, a99
    v_mul_f32 v75, v70, v75
    v_accvgpr_write_b32 a99, v75
    v_accvgpr_read_b32 v72, a100
    v_mul_f32 v72, v70, v72
    v_accvgpr_write_b32 a100, v72
    v_accvgpr_read_b32 v73, a101
    v_mul_f32 v73, v70, v73
    v_accvgpr_write_b32 a101, v73
    v_accvgpr_read_b32 v74, a102
    v_mul_f32 v74, v70, v74
    v_accvgpr_write_b32 a102, v74
    v_accvgpr_read_b32 v75, a103
    v_mul_f32 v75, v70, v75
    v_accvgpr_write_b32 a103, v75
    v_accvgpr_read_b32 v72, a104
    v_mul_f32 v72, v70, v72
    v_accvgpr_write_b32 a104, v72
    v_accvgpr_read_b32 v73, a105
    v_mul_f32 v73, v70, v73
    v_accvgpr_write_b32 a105, v73
    v_accvgpr_read_b32 v74, a106
    v_mul_f32 v74, v70, v74
    v_accvgpr_write_b32 a106, v74
    v_accvgpr_read_b32 v75, a107
    v_mul_f32 v75, v70, v75
    v_accvgpr_write_b32 a107, v75
    v_accvgpr_read_b32 v72, a108
    v_mul_f32 v72, v70, v72
    v_accvgpr_write_b32 a108, v72
    v_accvgpr_read_b32 v73, a109
    v_mul_f32 v73, v70, v73
    v_accvgpr_write_b32 a109, v73
    v_accvgpr_read_b32 v74, a110
    v_mul_f32 v74, v70, v74
    v_accvgpr_write_b32 a110, v74
    v_accvgpr_read_b32 v75, a111
    v_mul_f32 v75, v70, v75
    v_accvgpr_write_b32 a111, v75
    v_accvgpr_read_b32 v72, a112
    v_mul_f32 v72, v70, v72
    v_accvgpr_write_b32 a112, v72
    v_accvgpr_read_b32 v73, a113
    v_mul_f32 v73, v70, v73
    v_accvgpr_write_b32 a113, v73
    v_accvgpr_read_b32 v74, a114
    v_mul_f32 v74, v70, v74
    v_accvgpr_write_b32 a114, v74
    v_accvgpr_read_b32 v75, a115
    v_mul_f32 v75, v70, v75
    v_accvgpr_write_b32 a115, v75
    v_accvgpr_read_b32 v72, a116
    v_mul_f32 v72, v70, v72
    v_accvgpr_write_b32 a116, v72
    v_accvgpr_read_b32 v73, a117
    v_mul_f32 v73, v70, v73
    v_accvgpr_write_b32 a117, v73
    v_accvgpr_read_b32 v74, a118
    v_mul_f32 v74, v70, v74
    v_accvgpr_write_b32 a118, v74
    v_accvgpr_read_b32 v75, a119
    v_mul_f32 v75, v70, v75
    v_accvgpr_write_b32 a119, v75
    v_accvgpr_read_b32 v72, a120
    v_mul_f32 v72, v70, v72
    v_accvgpr_write_b32 a120, v72
    v_accvgpr_read_b32 v73, a121
    v_mul_f32 v73, v70, v73
    v_accvgpr_write_b32 a121, v73
    v_accvgpr_read_b32 v74, a122
    v_mul_f32 v74, v70, v74
    v_accvgpr_write_b32 a122, v74
    v_accvgpr_read_b32 v75, a123
    v_mul_f32 v75, v70, v75
    v_accvgpr_write_b32 a123, v75
    v_accvgpr_read_b32 v72, a124
    v_mul_f32 v72, v70, v72
    v_accvgpr_write_b32 a124, v72
    v_accvgpr_read_b32 v73, a125
    v_mul_f32 v73, v70, v73
    v_accvgpr_write_b32 a125, v73
    v_accvgpr_read_b32 v74, a126
    v_mul_f32 v74, v70, v74
    v_accvgpr_write_b32 a126, v74
    v_accvgpr_read_b32 v75, a127
    v_mul_f32 v75, v70, v75
    v_accvgpr_write_b32 a127, v75
    v_mov_b32 v68, v67
    v_mov_b32 v69, v67
    s_nop 0
    s_nop 0
    v_permlane32_swap_b32 v68, v69
    v_max_f32 v68, v68, v69
    v_mov_b32 v69, v68
    s_nop 0
    s_nop 0
    v_permlane16_swap_b32 v68, v69
    v_max_f32 v67, v68, v69
    v_max_f32 v67, v52, v67
    v_sub_f32 v70, v52, v67
    v_mul_f32 v70, s30, v70
    v_exp_f32 v70, v70
    v_mov_b32 v52, v67
    v_mul_f32 v57, s30, v52
    v_sub_f32 v57, 0, v57
    v_add_f32 v62, s31, v52
    v_mul_f32 v44, v70, v44
    v_mul_f32 v45, v70, v45
    v_mul_f32 v46, v70, v46
    v_mul_f32 v47, v70, v47
    v_accvgpr_read_b32 v72, a128
    v_mul_f32 v72, v70, v72
    v_accvgpr_write_b32 a128, v72
    v_accvgpr_read_b32 v73, a129
    v_mul_f32 v73, v70, v73
    v_accvgpr_write_b32 a129, v73
    v_accvgpr_read_b32 v74, a130
    v_mul_f32 v74, v70, v74
    v_accvgpr_write_b32 a130, v74
    v_accvgpr_read_b32 v75, a131
    v_mul_f32 v75, v70, v75
    v_accvgpr_write_b32 a131, v75
    v_accvgpr_read_b32 v72, a132
    v_mul_f32 v72, v70, v72
    v_accvgpr_write_b32 a132, v72
    v_accvgpr_read_b32 v73, a133
    v_mul_f32 v73, v70, v73
    v_accvgpr_write_b32 a133, v73
    v_accvgpr_read_b32 v74, a134
    v_mul_f32 v74, v70, v74
    v_accvgpr_write_b32 a134, v74
    v_accvgpr_read_b32 v75, a135
    v_mul_f32 v75, v70, v75
    v_accvgpr_write_b32 a135, v75
    v_accvgpr_read_b32 v72, a136
    v_mul_f32 v72, v70, v72
    v_accvgpr_write_b32 a136, v72
    v_accvgpr_read_b32 v73, a137
    v_mul_f32 v73, v70, v73
    v_accvgpr_write_b32 a137, v73
    v_accvgpr_read_b32 v74, a138
    v_mul_f32 v74, v70, v74
    v_accvgpr_write_b32 a138, v74
    v_accvgpr_read_b32 v75, a139
    v_mul_f32 v75, v70, v75
    v_accvgpr_write_b32 a139, v75
    v_accvgpr_read_b32 v72, a140
    v_mul_f32 v72, v70, v72
    v_accvgpr_write_b32 a140, v72
    v_accvgpr_read_b32 v73, a141
    v_mul_f32 v73, v70, v73
    v_accvgpr_write_b32 a141, v73
    v_accvgpr_read_b32 v74, a142
    v_mul_f32 v74, v70, v74
    v_accvgpr_write_b32 a142, v74
    v_accvgpr_read_b32 v75, a143
    v_mul_f32 v75, v70, v75
    v_accvgpr_write_b32 a143, v75
    v_accvgpr_read_b32 v72, a144
    v_mul_f32 v72, v70, v72
    v_accvgpr_write_b32 a144, v72
    v_accvgpr_read_b32 v73, a145
    v_mul_f32 v73, v70, v73
    v_accvgpr_write_b32 a145, v73
    v_accvgpr_read_b32 v74, a146
    v_mul_f32 v74, v70, v74
    v_accvgpr_write_b32 a146, v74
    v_accvgpr_read_b32 v75, a147
    v_mul_f32 v75, v70, v75
    v_accvgpr_write_b32 a147, v75
    v_accvgpr_read_b32 v72, a148
    v_mul_f32 v72, v70, v72
    v_accvgpr_write_b32 a148, v72
    v_accvgpr_read_b32 v73, a149
    v_mul_f32 v73, v70, v73
    v_accvgpr_write_b32 a149, v73
    v_accvgpr_read_b32 v74, a150
    v_mul_f32 v74, v70, v74
    v_accvgpr_write_b32 a150, v74
    v_accvgpr_read_b32 v75, a151
    v_mul_f32 v75, v70, v75
    v_accvgpr_write_b32 a151, v75
    v_accvgpr_read_b32 v72, a152
    v_mul_f32 v72, v70, v72
    v_accvgpr_write_b32 a152, v72
    v_accvgpr_read_b32 v73, a153
    v_mul_f32 v73, v70, v73
    v_accvgpr_write_b32 a153, v73
    v_accvgpr_read_b32 v74, a154
    v_mul_f32 v74, v70, v74
    v_accvgpr_write_b32 a154, v74
    v_accvgpr_read_b32 v75, a155
    v_mul_f32 v75, v70, v75
    v_accvgpr_write_b32 a155, v75
    v_accvgpr_read_b32 v72, a156
    v_mul_f32 v72, v70, v72
    v_accvgpr_write_b32 a156, v72
    v_accvgpr_read_b32 v73, a157
    v_mul_f32 v73, v70, v73
    v_accvgpr_write_b32 a157, v73
    v_accvgpr_read_b32 v74, a158
    v_mul_f32 v74, v70, v74
    v_accvgpr_write_b32 a158, v74
    v_accvgpr_read_b32 v75, a159
    v_mul_f32 v75, v70, v75
    v_accvgpr_write_b32 a159, v75
    s_nop 3
    s_branch L_ret3
L_slow4:
    s_nop 7
    s_nop 7
    v_mov_b32 v68, v63
    v_mov_b32 v69, v63
    s_nop 0
    s_nop 0
    v_permlane32_swap_b32 v68, v69
    v_max_f32 v68, v68, v69
    v_mov_b32 v69, v68
    s_nop 0
    s_nop 0
    v_permlane16_swap_b32 v68, v69
    v_max_f32 v63, v68, v69
    v_max_f32 v63, v48, v63
    v_sub_f32 v70, v48, v63
    v_mul_f32 v70, s30, v70
    v_exp_f32 v70, v70
    v_mov_b32 v48, v63
    v_mul_f32 v53, s30, v48
    v_sub_f32 v53, 0, v53
    v_add_f32 v58, s31, v48
    v_mul_f32 v28, v70, v28
    v_mul_f32 v29, v70, v29
    v_mul_f32 v30, v70, v30
    v_mul_f32 v31, v70, v31
    v_accvgpr_read_b32 v72, a0
    v_mul_f32 v72, v70, v72
    v_accvgpr_write_b32 a0, v72
    v_accvgpr_read_b32 v73, a1
    v_mul_f32 v73, v70, v73
    v_accvgpr_write_b32 a1, v73
    v_accvgpr_read_b32 v74, a2
    v_mul_f32 v74, v70, v74
    v_accvgpr_write_b32 a2, v74
    v_accvgpr_read_b32 v75, a3
    v_mul_f32 v75, v70, v75
    v_accvgpr_write_b32 a3, v75
    v_accvgpr_read_b32 v72, a4
    v_mul_f32 v72, v70, v72
    v_accvgpr_write_b32 a4, v72
    v_accvgpr_read_b32 v73, a5
    v_mul_f32 v73, v70, v73
    v_accvgpr_write_b32 a5, v73
    v_accvgpr_read_b32 v74, a6
    v_mul_f32 v74, v70, v74
    v_accvgpr_write_b32 a6, v74
    v_accvgpr_read_b32 v75, a7
    v_mul_f32 v75, v70, v75
    v_accvgpr_write_b32 a7, v75
    v_accvgpr_read_b32 v72, a8
    v_mul_f32 v72, v70, v72
    v_accvgpr_write_b32 a8, v72
    v_accvgpr_read_b32 v73, a9
    v_mul_f32 v73, v70, v73
    v_accvgpr_write_b32 a9, v73
    v_accvgpr_read_b32 v74, a10
    v_mul_f32 v74, v70, v74
    v_accvgpr_write_b32 a10, v74
    v_accvgpr_read_b32 v75, a11
    v_mul_f32 v75, v70, v75
    v_accvgpr_write_b32 a11, v75
    v_accvgpr_read_b32 v72, a12
    v_mul_f32 v72, v70, v72
    v_accvgpr_write_b32 a12, v72
    v_accvgpr_read_b32 v73, a13
    v_mul_f32 v73, v70, v73
    v_accvgpr_write_b32 a13, v73
    v_accvgpr_read_b32 v74, a14
    v_mul_f32 v74, v70, v74
    v_accvgpr_write_b32 a14, v74
    v_accvgpr_read_b32 v75, a15
    v_mul_f32 v75, v70, v75
    v_accvgpr_write_b32 a15, v75
    v_accvgpr_read_b32 v72, a16
    v_mul_f32 v72, v70, v72
    v_accvgpr_write_b32 a16, v72
    v_accvgpr_read_b32 v73, a17
    v_mul_f32 v73, v70, v73
    v_accvgpr_write_b32 a17, v73
    v_accvgpr_read_b32 v74, a18
    v_mul_f32 v74, v70, v74
    v_accvgpr_write_b32 a18, v74
    v_accvgpr_read_b32 v75, a19
    v_mul_f32 v75, v70, v75
    v_accvgpr_write_b32 a19, v75
    v_accvgpr_read_b32 v72, a20
    v_mul_f32 v72, v70, v72
    v_accvgpr_write_b32 a20, v72
    v_accvgpr_read_b32 v73, a21
    v_mul_f32 v73, v70, v73
    v_accvgpr_write_b32 a21, v73
    v_accvgpr_read_b32 v74, a22
    v_mul_f32 v74, v70, v74
    v_accvgpr_write_b32 a22, v74
    v_accvgpr_read_b32 v75, a23
    v_mul_f32 v75, v70, v75
    v_accvgpr_write_b32 a23, v75
    v_accvgpr_read_b32 v72, a24
    v_mul_f32 v72, v70, v72
    v_accvgpr_write_b32 a24, v72
    v_accvgpr_read_b32 v73, a25
    v_mul_f32 v73, v70, v73
    v_accvgpr_write_b32 a25, v73
    v_accvgpr_read_b32 v74, a26
    v_mul_f32 v74, v70, v74
    v_accvgpr_write_b32 a26, v74
    v_accvgpr_read_b32 v75, a27
    v_mul_f32 v75, v70, v75
    v_accvgpr_write_b32 a27, v75
    v_accvgpr_read_b32 v72, a28
    v_mul_f32 v72, v70, v72
    v_accvgpr_write_b32 a28, v72
    v_accvgpr_read_b32 v73, a29
    v_mul_f32 v73, v70, v73
    v_accvgpr_write_b32 a29, v73
    v_accvgpr_read_b32 v74, a30
    v_mul_f32 v74, v70, v74
    v_accvgpr_write_b32 a30, v74
    v_accvgpr_read_b32 v75, a31
    v_mul_f32 v75, v70, v75
    v_accvgpr_write_b32 a31, v75
    v_mov_b32 v68, v64
    v_mov_b32 v69, v64
    s_nop 0
    s_nop 0
    v_permlane32_swap_b32 v68, v69
    v_max_f32 v68, v68, v69
    v_mov_b32 v69, v68
    s_nop 0
    s_nop 0
    v_permlane16_swap_b32 v68, v69
    v_max_f32 v64, v68, v69
    v_max_f32 v64, v49, v64
    v_sub_f32 v70, v49, v64
    v_mul_f32 v70, s30, v70
    v_exp_f32 v70, v70
    v_mov_b32 v49, v64
    v_mul_f32 v54, s30, v49
    v_sub_f32 v54, 0, v54
    v_add_f32 v59, s31, v49
    v_mul_f32 v32, v70, v32
    v_mul_f32 v33, v70, v33
    v_mul_f32 v34, v70, v34
    v_mul_f32 v35, v70, v35
    v_accvgpr_read_b32 v72, a32
    v_mul_f32 v72, v70, v72
    v_accvgpr_write_b32 a32, v72
    v_accvgpr_read_b32 v73, a33
    v_mul_f32 v73, v70, v73
    v_accvgpr_write_b32 a33, v73
    v_accvgpr_read_b32 v74, a34
    v_mul_f32 v74, v70, v74
    v_accvgpr_write_b32 a34, v74
    v_accvgpr_read_b32 v75, a35
    v_mul_f32 v75, v70, v75
    v_accvgpr_write_b32 a35, v75
    v_accvgpr_read_b32 v72, a36
    v_mul_f32 v72, v70, v72
    v_accvgpr_write_b32 a36, v72
    v_accvgpr_read_b32 v73, a37
    v_mul_f32 v73, v70, v73
    v_accvgpr_write_b32 a37, v73
    v_accvgpr_read_b32 v74, a38
    v_mul_f32 v74, v70, v74
    v_accvgpr_write_b32 a38, v74
    v_accvgpr_read_b32 v75, a39
    v_mul_f32 v75, v70, v75
    v_accvgpr_write_b32 a39, v75
    v_accvgpr_read_b32 v72, a40
    v_mul_f32 v72, v70, v72
    v_accvgpr_write_b32 a40, v72
    v_accvgpr_read_b32 v73, a41
    v_mul_f32 v73, v70, v73
    v_accvgpr_write_b32 a41, v73
    v_accvgpr_read_b32 v74, a42
    v_mul_f32 v74, v70, v74
    v_accvgpr_write_b32 a42, v74
    v_accvgpr_read_b32 v75, a43
    v_mul_f32 v75, v70, v75
    v_accvgpr_write_b32 a43, v75
    v_accvgpr_read_b32 v72, a44
    v_mul_f32 v72, v70, v72
    v_accvgpr_write_b32 a44, v72
    v_accvgpr_read_b32 v73, a45
    v_mul_f32 v73, v70, v73
    v_accvgpr_write_b32 a45, v73
    v_accvgpr_read_b32 v74, a46
    v_mul_f32 v74, v70, v74
    v_accvgpr_write_b32 a46, v74
    v_accvgpr_read_b32 v75, a47
    v_mul_f32 v75, v70, v75
    v_accvgpr_write_b32 a47, v75
    v_accvgpr_read_b32 v72, a48
    v_mul_f32 v72, v70, v72
    v_accvgpr_write_b32 a48, v72
    v_accvgpr_read_b32 v73, a49
    v_mul_f32 v73, v70, v73
    v_accvgpr_write_b32 a49, v73
    v_accvgpr_read_b32 v74, a50
    v_mul_f32 v74, v70, v74
    v_accvgpr_write_b32 a50, v74
    v_accvgpr_read_b32 v75, a51
    v_mul_f32 v75, v70, v75
    v_accvgpr_write_b32 a51, v75
    v_accvgpr_read_b32 v72, a52
    v_mul_f32 v72, v70, v72
    v_accvgpr_write_b32 a52, v72
    v_accvgpr_read_b32 v73, a53
    v_mul_f32 v73, v70, v73
    v_accvgpr_write_b32 a53, v73
    v_accvgpr_read_b32 v74, a54
    v_mul_f32 v74, v70, v74
    v_accvgpr_write_b32 a54, v74
    v_accvgpr_read_b32 v75, a55
    v_mul_f32 v75, v70, v75
    v_accvgpr_write_b32 a55, v75
    v_accvgpr_read_b32 v72, a56
    v_mul_f32 v72, v70, v72
    v_accvgpr_write_b32 a56, v72
    v_accvgpr_read_b32 v73, a57
    v_mul_f32 v73, v70, v73
    v_accvgpr_write_b32 a57, v73
    v_accvgpr_read_b32 v74, a58
    v_mul_f32 v74, v70, v74
    v_accvgpr_write_b32 a58, v74
    v_accvgpr_read_b32 v75, a59
    v_mul_f32 v75, v70, v75
    v_accvgpr_write_b32 a59, v75
    v_accvgpr_read_b32 v72, a60
    v_mul_f32 v72, v70, v72
    v_accvgpr_write_b32 a60, v72
    v_accvgpr_read_b32 v73, a61
    v_mul_f32 v73, v70, v73
    v_accvgpr_write_b32 a61, v73
    v_accvgpr_read_b32 v74, a62
    v_mul_f32 v74, v70, v74
    v_accvgpr_write_b32 a62, v74
    v_accvgpr_read_b32 v75, a63
    v_mul_f32 v75, v70, v75
    v_accvgpr_write_b32 a63, v75
    v_mov_b32 v68, v65
    v_mov_b32 v69, v65
    s_nop 0
    s_nop 0
    v_permlane32_swap_b32 v68, v69
    v_max_f32 v68, v68, v69
    v_mov_b32 v69, v68
    s_nop 0
    s_nop 0
    v_permlane16_swap_b32 v68, v69
    v_max_f32 v65, v68, v69
    v_max_f32 v65, v50, v65
    v_sub_f32 v70, v50, v65
    v_mul_f32 v70, s30, v70
    v_exp_f32 v70, v70
    v_mov_b32 v50, v65
    v_mul_f32 v55, s30, v50
    v_sub_f32 v55, 0, v55
    v_add_f32 v60, s31, v50
    v_mul_f32 v36, v70, v36
    v_mul_f32 v37, v70, v37
    v_mul_f32 v38, v70, v38
    v_mul_f32 v39, v70, v39
    v_accvgpr_read_b32 v72, a64
    v_mul_f32 v72, v70, v72
    v_accvgpr_write_b32 a64, v72
    v_accvgpr_read_b32 v73, a65
    v_mul_f32 v73, v70, v73
    v_accvgpr_write_b32 a65, v73
    v_accvgpr_read_b32 v74, a66
    v_mul_f32 v74, v70, v74
    v_accvgpr_write_b32 a66, v74
    v_accvgpr_read_b32 v75, a67
    v_mul_f32 v75, v70, v75
    v_accvgpr_write_b32 a67, v75
    v_accvgpr_read_b32 v72, a68
    v_mul_f32 v72, v70, v72
    v_accvgpr_write_b32 a68, v72
    v_accvgpr_read_b32 v73, a69
    v_mul_f32 v73, v70, v73
    v_accvgpr_write_b32 a69, v73
    v_accvgpr_read_b32 v74, a70
    v_mul_f32 v74, v70, v74
    v_accvgpr_write_b32 a70, v74
    v_accvgpr_read_b32 v75, a71
    v_mul_f32 v75, v70, v75
    v_accvgpr_write_b32 a71, v75
    v_accvgpr_read_b32 v72, a72
    v_mul_f32 v72, v70, v72
    v_accvgpr_write_b32 a72, v72
    v_accvgpr_read_b32 v73, a73
    v_mul_f32 v73, v70, v73
    v_accvgpr_write_b32 a73, v73
    v_accvgpr_read_b32 v74, a74
    v_mul_f32 v74, v70, v74
    v_accvgpr_write_b32 a74, v74
    v_accvgpr_read_b32 v75, a75
    v_mul_f32 v75, v70, v75
    v_accvgpr_write_b32 a75, v75
    v_accvgpr_read_b32 v72, a76
    v_mul_f32 v72, v70, v72
    v_accvgpr_write_b32 a76, v72
    v_accvgpr_read_b32 v73, a77
    v_mul_f32 v73, v70, v73
    v_accvgpr_write_b32 a77, v73
    v_accvgpr_read_b32 v74, a78
    v_mul_f32 v74, v70, v74
    v_accvgpr_write_b32 a78, v74
    v_accvgpr_read_b32 v75, a79
    v_mul_f32 v75, v70, v75
    v_accvgpr_write_b32 a79, v75
    v_accvgpr_read_b32 v72, a80
    v_mul_f32 v72, v70, v72
    v_accvgpr_write_b32 a80, v72
    v_accvgpr_read_b32 v73, a81
    v_mul_f32 v73, v70, v73
    v_accvgpr_write_b32 a81, v73
    v_accvgpr_read_b32 v74, a82
    v_mul_f32 v74, v70, v74
    v_accvgpr_write_b32 a82, v74
    v_accvgpr_read_b32 v75, a83
    v_mul_f32 v75, v70, v75
    v_accvgpr_write_b32 a83, v75
    v_accvgpr_read_b32 v72, a84
    v_mul_f32 v72, v70, v72
    v_accvgpr_write_b32 a84, v72
    v_accvgpr_read_b32 v73, a85
    v_mul_f32 v73, v70, v73
    v_accvgpr_write_b32 a85, v73
    v_accvgpr_read_b32 v74, a86
    v_mul_f32 v74, v70, v74
    v_accvgpr_write_b32 a86, v74
    v_accvgpr_read_b32 v75, a87
    v_mul_f32 v75, v70, v75
    v_accvgpr_write_b32 a87, v75
    v_accvgpr_read_b32 v72, a88
    v_mul_f32 v72, v70, v72
    v_accvgpr_write_b32 a88, v72
    v_accvgpr_read_b32 v73, a89
    v_mul_f32 v73, v70, v73
    v_accvgpr_write_b32 a89, v73
    v_accvgpr_read_b32 v74, a90
    v_mul_f32 v74, v70, v74
    v_accvgpr_write_b32 a90, v74
    v_accvgpr_read_b32 v75, a91
    v_mul_f32 v75, v70, v75
    v_accvgpr_write_b32 a91, v75
    v_accvgpr_read_b32 v72, a92
    v_mul_f32 v72, v70, v72
    v_accvgpr_write_b32 a92, v72
    v_accvgpr_read_b32 v73, a93
    v_mul_f32 v73, v70, v73
    v_accvgpr_write_b32 a93, v73
    v_accvgpr_read_b32 v74, a94
    v_mul_f32 v74, v70, v74
    v_accvgpr_write_b32 a94, v74
    v_accvgpr_read_b32 v75, a95
    v_mul_f32 v75, v70, v75
    v_accvgpr_write_b32 a95, v75
    v_mov_b32 v68, v66
    v_mov_b32 v69, v66
    s_nop 0
    s_nop 0
    v_permlane32_swap_b32 v68, v69
    v_max_f32 v68, v68, v69
    v_mov_b32 v69, v68
    s_nop 0
    s_nop 0
    v_permlane16_swap_b32 v68, v69
    v_max_f32 v66, v68, v69
    v_max_f32 v66, v51, v66
    v_sub_f32 v70, v51, v66
    v_mul_f32 v70, s30, v70
    v_exp_f32 v70, v70
    v_mov_b32 v51, v66
    v_mul_f32 v56, s30, v51
    v_sub_f32 v56, 0, v56
    v_add_f32 v61, s31, v51
    v_mul_f32 v40, v70, v40
    v_mul_f32 v41, v70, v41
    v_mul_f32 v42, v70, v42
    v_mul_f32 v43, v70, v43
    v_accvgpr_read_b32 v72, a96
    v_mul_f32 v72, v70, v72
    v_accvgpr_write_b32 a96, v72
    v_accvgpr_read_b32 v73, a97
    v_mul_f32 v73, v70, v73
    v_accvgpr_write_b32 a97, v73
    v_accvgpr_read_b32 v74, a98
    v_mul_f32 v74, v70, v74
    v_accvgpr_write_b32 a98, v74
    v_accvgpr_read_b32 v75, a99
    v_mul_f32 v75, v70, v75
    v_accvgpr_write_b32 a99, v75
    v_accvgpr_read_b32 v72, a100
    v_mul_f32 v72, v70, v72
    v_accvgpr_write_b32 a100, v72
    v_accvgpr_read_b32 v73, a101
    v_mul_f32 v73, v70, v73
    v_accvgpr_write_b32 a101, v73
    v_accvgpr_read_b32 v74, a102
    v_mul_f32 v74, v70, v74
    v_accvgpr_write_b32 a102, v74
    v_accvgpr_read_b32 v75, a103
    v_mul_f32 v75, v70, v75
    v_accvgpr_write_b32 a103, v75
    v_accvgpr_read_b32 v72, a104
    v_mul_f32 v72, v70, v72
    v_accvgpr_write_b32 a104, v72
    v_accvgpr_read_b32 v73, a105
    v_mul_f32 v73, v70, v73
    v_accvgpr_write_b32 a105, v73
    v_accvgpr_read_b32 v74, a106
    v_mul_f32 v74, v70, v74
    v_accvgpr_write_b32 a106, v74
    v_accvgpr_read_b32 v75, a107
    v_mul_f32 v75, v70, v75
    v_accvgpr_write_b32 a107, v75
    v_accvgpr_read_b32 v72, a108
    v_mul_f32 v72, v70, v72
    v_accvgpr_write_b32 a108, v72
    v_accvgpr_read_b32 v73, a109
    v_mul_f32 v73, v70, v73
    v_accvgpr_write_b32 a109, v73
    v_accvgpr_read_b32 v74, a110
    v_mul_f32 v74, v70, v74
    v_accvgpr_write_b32 a110, v74
    v_accvgpr_read_b32 v75, a111
    v_mul_f32 v75, v70, v75
    v_accvgpr_write_b32 a111, v75
    v_accvgpr_read_b32 v72, a112
    v_mul_f32 v72, v70, v72
    v_accvgpr_write_b32 a112, v72
    v_accvgpr_read_b32 v73, a113
    v_mul_f32 v73, v70, v73
    v_accvgpr_write_b32 a113, v73
    v_accvgpr_read_b32 v74, a114
    v_mul_f32 v74, v70, v74
    v_accvgpr_write_b32 a114, v74
    v_accvgpr_read_b32 v75, a115
    v_mul_f32 v75, v70, v75
    v_accvgpr_write_b32 a115, v75
    v_accvgpr_read_b32 v72, a116
    v_mul_f32 v72, v70, v72
    v_accvgpr_write_b32 a116, v72
    v_accvgpr_read_b32 v73, a117
    v_mul_f32 v73, v70, v73
    v_accvgpr_write_b32 a117, v73
    v_accvgpr_read_b32 v74, a118
    v_mul_f32 v74, v70, v74
    v_accvgpr_write_b32 a118, v74
    v_accvgpr_read_b32 v75, a119
    v_mul_f32 v75, v70, v75
    v_accvgpr_write_b32 a119, v75
    v_accvgpr_read_b32 v72, a120
    v_mul_f32 v72, v70, v72
    v_accvgpr_write_b32 a120, v72
    v_accvgpr_read_b32 v73, a121
    v_mul_f32 v73, v70, v73
    v_accvgpr_write_b32 a121, v73
    v_accvgpr_read_b32 v74, a122
    v_mul_f32 v74, v70, v74
    v_accvgpr_write_b32 a122, v74
    v_accvgpr_read_b32 v75, a123
    v_mul_f32 v75, v70, v75
    v_accvgpr_write_b32 a123, v75
    v_accvgpr_read_b32 v72, a124
    v_mul_f32 v72, v70, v72
    v_accvgpr_write_b32 a124, v72
    v_accvgpr_read_b32 v73, a125
    v_mul_f32 v73, v70, v73
    v_accvgpr_write_b32 a125, v73
    v_accvgpr_read_b32 v74, a126
    v_mul_f32 v74, v70, v74
    v_accvgpr_write_b32 a126, v74
    v_accvgpr_read_b32 v75, a127
    v_mul_f32 v75, v70, v75
    v_accvgpr_write_b32 a127, v75
    v_mov_b32 v68, v67
    v_mov_b32 v69, v67
    s_nop 0
    s_nop 0
    v_permlane32_swap_b32 v68, v69
    v_max_f32 v68, v68, v69
    v_mov_b32 v69, v68
    s_nop 0
    s_nop 0
    v_permlane16_swap_b32 v68, v69
    v_max_f32 v67, v68, v69
    v_max_f32 v67, v52, v67
    v_sub_f32 v70, v52, v67
    v_mul_f32 v70, s30, v70
    v_exp_f32 v70, v70
    v_mov_b32 v52, v67
    v_mul_f32 v57, s30, v52
    v_sub_f32 v57, 0, v57
    v_add_f32 v62, s31, v52
    v_mul_f32 v44, v70, v44
    v_mul_f32 v45, v70, v45
    v_mul_f32 v46, v70, v46
    v_mul_f32 v47, v70, v47
    v_accvgpr_read_b32 v72, a128
    v_mul_f32 v72, v70, v72
    v_accvgpr_write_b32 a128, v72
    v_accvgpr_read_b32 v73, a129
    v_mul_f32 v73, v70, v73
    v_accvgpr_write_b32 a129, v73
    v_accvgpr_read_b32 v74, a130
    v_mul_f32 v74, v70, v74
    v_accvgpr_write_b32 a130, v74
    v_accvgpr_read_b32 v75, a131
    v_mul_f32 v75, v70, v75
    v_accvgpr_write_b32 a131, v75
    v_accvgpr_read_b32 v72, a132
    v_mul_f32 v72, v70, v72
    v_accvgpr_write_b32 a132, v72
    v_accvgpr_read_b32 v73, a133
    v_mul_f32 v73, v70, v73
    v_accvgpr_write_b32 a133, v73
    v_accvgpr_read_b32 v74, a134
    v_mul_f32 v74, v70, v74
    v_accvgpr_write_b32 a134, v74
    v_accvgpr_read_b32 v75, a135
    v_mul_f32 v75, v70, v75
    v_accvgpr_write_b32 a135, v75
    v_accvgpr_read_b32 v72, a136
    v_mul_f32 v72, v70, v72
    v_accvgpr_write_b32 a136, v72
    v_accvgpr_read_b32 v73, a137
    v_mul_f32 v73, v70, v73
    v_accvgpr_write_b32 a137, v73
    v_accvgpr_read_b32 v74, a138
    v_mul_f32 v74, v70, v74
    v_accvgpr_write_b32 a138, v74
    v_accvgpr_read_b32 v75, a139
    v_mul_f32 v75, v70, v75
    v_accvgpr_write_b32 a139, v75
    v_accvgpr_read_b32 v72, a140
    v_mul_f32 v72, v70, v72
    v_accvgpr_write_b32 a140, v72
    v_accvgpr_read_b32 v73, a141
    v_mul_f32 v73, v70, v73
    v_accvgpr_write_b32 a141, v73
    v_accvgpr_read_b32 v74, a142
    v_mul_f32 v74, v70, v74
    v_accvgpr_write_b32 a142, v74
    v_accvgpr_read_b32 v75, a143
    v_mul_f32 v75, v70, v75
    v_accvgpr_write_b32 a143, v75
    v_accvgpr_read_b32 v72, a144
    v_mul_f32 v72, v70, v72
    v_accvgpr_write_b32 a144, v72
    v_accvgpr_read_b32 v73, a145
    v_mul_f32 v73, v70, v73
    v_accvgpr_write_b32 a145, v73
    v_accvgpr_read_b32 v74, a146
    v_mul_f32 v74, v70, v74
    v_accvgpr_write_b32 a146, v74
    v_accvgpr_read_b32 v75, a147
    v_mul_f32 v75, v70, v75
    v_accvgpr_write_b32 a147, v75
    v_accvgpr_read_b32 v72, a148
    v_mul_f32 v72, v70, v72
    v_accvgpr_write_b32 a148, v72
    v_accvgpr_read_b32 v73, a149
    v_mul_f32 v73, v70, v73
    v_accvgpr_write_b32 a149, v73
    v_accvgpr_read_b32 v74, a150
    v_mul_f32 v74, v70, v74
    v_accvgpr_write_b32 a150, v74
    v_accvgpr_read_b32 v75, a151
    v_mul_f32 v75, v70, v75
    v_accvgpr_write_b32 a151, v75
    v_accvgpr_read_b32 v72, a152
    v_mul_f32 v72, v70, v72
    v_accvgpr_write_b32 a152, v72
    v_accvgpr_read_b32 v73, a153
    v_mul_f32 v73, v70, v73
    v_accvgpr_write_b32 a153, v73
    v_accvgpr_read_b32 v74, a154
    v_mul_f32 v74, v70, v74
    v_accvgpr_write_b32 a154, v74
    v_accvgpr_read_b32 v75, a155
    v_mul_f32 v75, v70, v75
    v_accvgpr_write_b32 a155, v75
    v_accvgpr_read_b32 v72, a156
    v_mul_f32 v72, v70, v72
    v_accvgpr_write_b32 a156, v72
    v_accvgpr_read_b32 v73, a157
    v_mul_f32 v73, v70, v73
    v_accvgpr_write_b32 a157, v73
    v_accvgpr_read_b32 v74, a158
    v_mul_f32 v74, v70, v74
    v_accvgpr_write_b32 a158, v74
    v_accvgpr_read_b32 v75, a159
    v_mul_f32 v75, v70, v75
    v_accvgpr_write_b32 a159, v75
    s_nop 3
    s_branch L_ret4
L_slow5:
    s_nop 7
    s_nop 7
    v_mov_b32 v68, v63
    v_mov_b32 v69, v63
    s_nop 0
    s_nop 0
    v_permlane32_swap_b32 v68, v69
    v_max_f32 v68, v68, v69
    v_mov_b32 v69, v68
    s_nop 0
    s_nop 0
    v_permlane16_swap_b32 v68, v69
    v_max_f32 v63, v68, v69
    v_max_f32 v63, v48, v63
    v_sub_f32 v70, v48, v63
    v_mul_f32 v70, s30, v70
    v_exp_f32 v70, v70
    v_mov_b32 v48, v63
    v_mul_f32 v53, s30, v48
    v_sub_f32 v53, 0, v53
    v_add_f32 v58, s31, v48
    v_mul_f32 v28, v70, v28
    v_mul_f32 v29, v70, v29
    v_mul_f32 v30, v70, v30
    v_mul_f32 v31, v70, v31
    v_accvgpr_read_b32 v72, a0
    v_mul_f32 v72, v70, v72
    v_accvgpr_write_b32 a0, v72
    v_accvgpr_read_b32 v73, a1
    v_mul_f32 v73, v70, v73
    v_accvgpr_write_b32 a1, v73
    v_accvgpr_read_b32 v74, a2
    v_mul_f32 v74, v70, v74
    v_accvgpr_write_b32 a2, v74
    v_accvgpr_read_b32 v75, a3
    v_mul_f32 v75, v70, v75
    v_accvgpr_write_b32 a3, v75
    v_accvgpr_read_b32 v72, a4
    v_mul_f32 v72, v70, v72
    v_accvgpr_write_b32 a4, v72
    v_accvgpr_read_b32 v73, a5
    v_mul_f32 v73, v70, v73
    v_accvgpr_write_b32 a5, v73
    v_accvgpr_read_b32 v74, a6
    v_mul_f32 v74, v70, v74
    v_accvgpr_write_b32 a6, v74
    v_accvgpr_read_b32 v75, a7
    v_mul_f32 v75, v70, v75
    v_accvgpr_write_b32 a7, v75
    v_accvgpr_read_b32 v72, a8
    v_mul_f32 v72, v70, v72
    v_accvgpr_write_b32 a8, v72
    v_accvgpr_read_b32 v73, a9
    v_mul_f32 v73, v70, v73
    v_accvgpr_write_b32 a9, v73
    v_accvgpr_read_b32 v74, a10
    v_mul_f32 v74, v70, v74
    v_accvgpr_write_b32 a10, v74
    v_accvgpr_read_b32 v75, a11
    v_mul_f32 v75, v70, v75
    v_accvgpr_write_b32 a11, v75
    v_accvgpr_read_b32 v72, a12
    v_mul_f32 v72, v70, v72
    v_accvgpr_write_b32 a12, v72
    v_accvgpr_read_b32 v73, a13
    v_mul_f32 v73, v70, v73
    v_accvgpr_write_b32 a13, v73
    v_accvgpr_read_b32 v74, a14
    v_mul_f32 v74, v70, v74
    v_accvgpr_write_b32 a14, v74
    v_accvgpr_read_b32 v75, a15
    v_mul_f32 v75, v70, v75
    v_accvgpr_write_b32 a15, v75
    v_accvgpr_read_b32 v72, a16
    v_mul_f32 v72, v70, v72
    v_accvgpr_write_b32 a16, v72
    v_accvgpr_read_b32 v73, a17
    v_mul_f32 v73, v70, v73
    v_accvgpr_write_b32 a17, v73
    v_accvgpr_read_b32 v74, a18
    v_mul_f32 v74, v70, v74
    v_accvgpr_write_b32 a18, v74
    v_accvgpr_read_b32 v75, a19
    v_mul_f32 v75, v70, v75
    v_accvgpr_write_b32 a19, v75
    v_accvgpr_read_b32 v72, a20
    v_mul_f32 v72, v70, v72
    v_accvgpr_write_b32 a20, v72
    v_accvgpr_read_b32 v73, a21
    v_mul_f32 v73, v70, v73
    v_accvgpr_write_b32 a21, v73
    v_accvgpr_read_b32 v74, a22
    v_mul_f32 v74, v70, v74
    v_accvgpr_write_b32 a22, v74
    v_accvgpr_read_b32 v75, a23
    v_mul_f32 v75, v70, v75
    v_accvgpr_write_b32 a23, v75
    v_accvgpr_read_b32 v72, a24
    v_mul_f32 v72, v70, v72
    v_accvgpr_write_b32 a24, v72
    v_accvgpr_read_b32 v73, a25
    v_mul_f32 v73, v70, v73
    v_accvgpr_write_b32 a25, v73
    v_accvgpr_read_b32 v74, a26
    v_mul_f32 v74, v70, v74
    v_accvgpr_write_b32 a26, v74
    v_accvgpr_read_b32 v75, a27
    v_mul_f32 v75, v70, v75
    v_accvgpr_write_b32 a27, v75
    v_accvgpr_read_b32 v72, a28
    v_mul_f32 v72, v70, v72
    v_accvgpr_write_b32 a28, v72
    v_accvgpr_read_b32 v73, a29
    v_mul_f32 v73, v70, v73
    v_accvgpr_write_b32 a29, v73
    v_accvgpr_read_b32 v74, a30
    v_mul_f32 v74, v70, v74
    v_accvgpr_write_b32 a30, v74
    v_accvgpr_read_b32 v75, a31
    v_mul_f32 v75, v70, v75
    v_accvgpr_write_b32 a31, v75
    v_mov_b32 v68, v64
    v_mov_b32 v69, v64
    s_nop 0
    s_nop 0
    v_permlane32_swap_b32 v68, v69
    v_max_f32 v68, v68, v69
    v_mov_b32 v69, v68
    s_nop 0
    s_nop 0
    v_permlane16_swap_b32 v68, v69
    v_max_f32 v64, v68, v69
    v_max_f32 v64, v49, v64
    v_sub_f32 v70, v49, v64
    v_mul_f32 v70, s30, v70
    v_exp_f32 v70, v70
    v_mov_b32 v49, v64
    v_mul_f32 v54, s30, v49
    v_sub_f32 v54, 0, v54
    v_add_f32 v59, s31, v49
    v_mul_f32 v32, v70, v32
    v_mul_f32 v33, v70, v33
    v_mul_f32 v34, v70, v34
    v_mul_f32 v35, v70, v35
    v_accvgpr_read_b32 v72, a32
    v_mul_f32 v72, v70, v72
    v_accvgpr_write_b32 a32, v72
    v_accvgpr_read_b32 v73, a33
    v_mul_f32 v73, v70, v73
    v_accvgpr_write_b32 a33, v73
    v_accvgpr_read_b32 v74, a34
    v_mul_f32 v74, v70, v74
    v_accvgpr_write_b32 a34, v74
    v_accvgpr_read_b32 v75, a35
    v_mul_f32 v75, v70, v75
    v_accvgpr_write_b32 a35, v75
    v_accvgpr_read_b32 v72, a36
    v_mul_f32 v72, v70, v72
    v_accvgpr_write_b32 a36, v72
    v_accvgpr_read_b32 v73, a37
    v_mul_f32 v73, v70, v73
    v_accvgpr_write_b32 a37, v73
    v_accvgpr_read_b32 v74, a38
    v_mul_f32 v74, v70, v74
    v_accvgpr_write_b32 a38, v74
    v_accvgpr_read_b32 v75, a39
    v_mul_f32 v75, v70, v75
    v_accvgpr_write_b32 a39, v75
    v_accvgpr_read_b32 v72, a40
    v_mul_f32 v72, v70, v72
    v_accvgpr_write_b32 a40, v72
    v_accvgpr_read_b32 v73, a41
    v_mul_f32 v73, v70, v73
    v_accvgpr_write_b32 a41, v73
    v_accvgpr_read_b32 v74, a42
    v_mul_f32 v74, v70, v74
    v_accvgpr_write_b32 a42, v74
    v_accvgpr_read_b32 v75, a43
    v_mul_f32 v75, v70, v75
    v_accvgpr_write_b32 a43, v75
    v_accvgpr_read_b32 v72, a44
    v_mul_f32 v72, v70, v72
    v_accvgpr_write_b32 a44, v72
    v_accvgpr_read_b32 v73, a45
    v_mul_f32 v73, v70, v73
    v_accvgpr_write_b32 a45, v73
    v_accvgpr_read_b32 v74, a46
    v_mul_f32 v74, v70, v74
    v_accvgpr_write_b32 a46, v74
    v_accvgpr_read_b32 v75, a47
    v_mul_f32 v75, v70, v75
    v_accvgpr_write_b32 a47, v75
    v_accvgpr_read_b32 v72, a48
    v_mul_f32 v72, v70, v72
    v_accvgpr_write_b32 a48, v72
    v_accvgpr_read_b32 v73, a49
    v_mul_f32 v73, v70, v73
    v_accvgpr_write_b32 a49, v73
    v_accvgpr_read_b32 v74, a50
    v_mul_f32 v74, v70, v74
    v_accvgpr_write_b32 a50, v74
    v_accvgpr_read_b32 v75, a51
    v_mul_f32 v75, v70, v75
    v_accvgpr_write_b32 a51, v75
    v_accvgpr_read_b32 v72, a52
    v_mul_f32 v72, v70, v72
    v_accvgpr_write_b32 a52, v72
    v_accvgpr_read_b32 v73, a53
    v_mul_f32 v73, v70, v73
    v_accvgpr_write_b32 a53, v73
    v_accvgpr_read_b32 v74, a54
    v_mul_f32 v74, v70, v74
    v_accvgpr_write_b32 a54, v74
    v_accvgpr_read_b32 v75, a55
    v_mul_f32 v75, v70, v75
    v_accvgpr_write_b32 a55, v75
    v_accvgpr_read_b32 v72, a56
    v_mul_f32 v72, v70, v72
    v_accvgpr_write_b32 a56, v72
    v_accvgpr_read_b32 v73, a57
    v_mul_f32 v73, v70, v73
    v_accvgpr_write_b32 a57, v73
    v_accvgpr_read_b32 v74, a58
    v_mul_f32 v74, v70, v74
    v_accvgpr_write_b32 a58, v74
    v_accvgpr_read_b32 v75, a59
    v_mul_f32 v75, v70, v75
    v_accvgpr_write_b32 a59, v75
    v_accvgpr_read_b32 v72, a60
    v_mul_f32 v72, v70, v72
    v_accvgpr_write_b32 a60, v72
    v_accvgpr_read_b32 v73, a61
    v_mul_f32 v73, v70, v73
    v_accvgpr_write_b32 a61, v73
    v_accvgpr_read_b32 v74, a62
    v_mul_f32 v74, v70, v74
    v_accvgpr_write_b32 a62, v74
    v_accvgpr_read_b32 v75, a63
    v_mul_f32 v75, v70, v75
    v_accvgpr_write_b32 a63, v75
    v_mov_b32 v68, v65
    v_mov_b32 v69, v65
    s_nop 0
    s_nop 0
    v_permlane32_swap_b32 v68, v69
    v_max_f32 v68, v68, v69
    v_mov_b32 v69, v68
    s_nop 0
    s_nop 0
    v_permlane16_swap_b32 v68, v69
    v_max_f32 v65, v68, v69
    v_max_f32 v65, v50, v65
    v_sub_f32 v70, v50, v65
    v_mul_f32 v70, s30, v70
    v_exp_f32 v70, v70
    v_mov_b32 v50, v65
    v_mul_f32 v55, s30, v50
    v_sub_f32 v55, 0, v55
    v_add_f32 v60, s31, v50
    v_mul_f32 v36, v70, v36
    v_mul_f32 v37, v70, v37
    v_mul_f32 v38, v70, v38
    v_mul_f32 v39, v70, v39
    v_accvgpr_read_b32 v72, a64
    v_mul_f32 v72, v70, v72
    v_accvgpr_write_b32 a64, v72
    v_accvgpr_read_b32 v73, a65
    v_mul_f32 v73, v70, v73
    v_accvgpr_write_b32 a65, v73
    v_accvgpr_read_b32 v74, a66
    v_mul_f32 v74, v70, v74
    v_accvgpr_write_b32 a66, v74
    v_accvgpr_read_b32 v75, a67
    v_mul_f32 v75, v70, v75
    v_accvgpr_write_b32 a67, v75
    v_accvgpr_read_b32 v72, a68
    v_mul_f32 v72, v70, v72
    v_accvgpr_write_b32 a68, v72
    v_accvgpr_read_b32 v73, a69
    v_mul_f32 v73, v70, v73
    v_accvgpr_write_b32 a69, v73
    v_accvgpr_read_b32 v74, a70
    v_mul_f32 v74, v70, v74
    v_accvgpr_write_b32 a70, v74
    v_accvgpr_read_b32 v75, a71
    v_mul_f32 v75, v70, v75
    v_accvgpr_write_b32 a71, v75
    v_accvgpr_read_b32 v72, a72
    v_mul_f32 v72, v70, v72
    v_accvgpr_write_b32 a72, v72
    v_accvgpr_read_b32 v73, a73
    v_mul_f32 v73, v70, v73
    v_accvgpr_write_b32 a73, v73
    v_accvgpr_read_b32 v74, a74
    v_mul_f32 v74, v70, v74
    v_accvgpr_write_b32 a74, v74
    v_accvgpr_read_b32 v75, a75
    v_mul_f32 v75, v70, v75
    v_accvgpr_write_b32 a75, v75
    v_accvgpr_read_b32 v72, a76
    v_mul_f32 v72, v70, v72
    v_accvgpr_write_b32 a76, v72
    v_accvgpr_read_b32 v73, a77
    v_mul_f32 v73, v70, v73
    v_accvgpr_write_b32 a77, v73
    v_accvgpr_read_b32 v74, a78
    v_mul_f32 v74, v70, v74
    v_accvgpr_write_b32 a78, v74
    v_accvgpr_read_b32 v75, a79
    v_mul_f32 v75, v70, v75
    v_accvgpr_write_b32 a79, v75
    v_accvgpr_read_b32 v72, a80
    v_mul_f32 v72, v70, v72
    v_accvgpr_write_b32 a80, v72
    v_accvgpr_read_b32 v73, a81
    v_mul_f32 v73, v70, v73
    v_accvgpr_write_b32 a81, v73
    v_accvgpr_read_b32 v74, a82
    v_mul_f32 v74, v70, v74
    v_accvgpr_write_b32 a82, v74
    v_accvgpr_read_b32 v75, a83
    v_mul_f32 v75, v70, v75
    v_accvgpr_write_b32 a83, v75
    v_accvgpr_read_b32 v72, a84
    v_mul_f32 v72, v70, v72
    v_accvgpr_write_b32 a84, v72
    v_accvgpr_read_b32 v73, a85
    v_mul_f32 v73, v70, v73
    v_accvgpr_write_b32 a85, v73
    v_accvgpr_read_b32 v74, a86
    v_mul_f32 v74, v70, v74
    v_accvgpr_write_b32 a86, v74
    v_accvgpr_read_b32 v75, a87
    v_mul_f32 v75, v70, v75
    v_accvgpr_write_b32 a87, v75
    v_accvgpr_read_b32 v72, a88
    v_mul_f32 v72, v70, v72
    v_accvgpr_write_b32 a88, v72
    v_accvgpr_read_b32 v73, a89
    v_mul_f32 v73, v70, v73
    v_accvgpr_write_b32 a89, v73
    v_accvgpr_read_b32 v74, a90
    v_mul_f32 v74, v70, v74
    v_accvgpr_write_b32 a90, v74
    v_accvgpr_read_b32 v75, a91
    v_mul_f32 v75, v70, v75
    v_accvgpr_write_b32 a91, v75
    v_accvgpr_read_b32 v72, a92
    v_mul_f32 v72, v70, v72
    v_accvgpr_write_b32 a92, v72
    v_accvgpr_read_b32 v73, a93
    v_mul_f32 v73, v70, v73
    v_accvgpr_write_b32 a93, v73
    v_accvgpr_read_b32 v74, a94
    v_mul_f32 v74, v70, v74
    v_accvgpr_write_b32 a94, v74
    v_accvgpr_read_b32 v75, a95
    v_mul_f32 v75, v70, v75
    v_accvgpr_write_b32 a95, v75
    v_mov_b32 v68, v66
    v_mov_b32 v69, v66
    s_nop 0
    s_nop 0
    v_permlane32_swap_b32 v68, v69
    v_max_f32 v68, v68, v69
    v_mov_b32 v69, v68
    s_nop 0
    s_nop 0
    v_permlane16_swap_b32 v68, v69
    v_max_f32 v66, v68, v69
    v_max_f32 v66, v51, v66
    v_sub_f32 v70, v51, v66
    v_mul_f32 v70, s30, v70
    v_exp_f32 v70, v70
    v_mov_b32 v51, v66
    v_mul_f32 v56, s30, v51
    v_sub_f32 v56, 0, v56
    v_add_f32 v61, s31, v51
    v_mul_f32 v40, v70, v40
    v_mul_f32 v41, v70, v41
    v_mul_f32 v42, v70, v42
    v_mul_f32 v43, v70, v43
    v_accvgpr_read_b32 v72, a96
    v_mul_f32 v72, v70, v72
    v_accvgpr_write_b32 a96, v72
    v_accvgpr_read_b32 v73, a97
    v_mul_f32 v73, v70, v73
    v_accvgpr_write_b32 a97, v73
    v_accvgpr_read_b32 v74, a98
    v_mul_f32 v74, v70, v74
    v_accvgpr_write_b32 a98, v74
    v_accvgpr_read_b32 v75, a99
    v_mul_f32 v75, v70, v75
    v_accvgpr_write_b32 a99, v75
    v_accvgpr_read_b32 v72, a100
    v_mul_f32 v72, v70, v72
    v_accvgpr_write_b32 a100, v72
    v_accvgpr_read_b32 v73, a101
    v_mul_f32 v73, v70, v73
    v_accvgpr_write_b32 a101, v73
    v_accvgpr_read_b32 v74, a102
    v_mul_f32 v74, v70, v74
    v_accvgpr_write_b32 a102, v74
    v_accvgpr_read_b32 v75, a103
    v_mul_f32 v75, v70, v75
    v_accvgpr_write_b32 a103, v75
    v_accvgpr_read_b32 v72, a104
    v_mul_f32 v72, v70, v72
    v_accvgpr_write_b32 a104, v72
    v_accvgpr_read_b32 v73, a105
    v_mul_f32 v73, v70, v73
    v_accvgpr_write_b32 a105, v73
    v_accvgpr_read_b32 v74, a106
    v_mul_f32 v74, v70, v74
    v_accvgpr_write_b32 a106, v74
    v_accvgpr_read_b32 v75, a107
    v_mul_f32 v75, v70, v75
    v_accvgpr_write_b32 a107, v75
    v_accvgpr_read_b32 v72, a108
    v_mul_f32 v72, v70, v72
    v_accvgpr_write_b32 a108, v72
    v_accvgpr_read_b32 v73, a109
    v_mul_f32 v73, v70, v73
    v_accvgpr_write_b32 a109, v73
    v_accvgpr_read_b32 v74, a110
    v_mul_f32 v74, v70, v74
    v_accvgpr_write_b32 a110, v74
    v_accvgpr_read_b32 v75, a111
    v_mul_f32 v75, v70, v75
    v_accvgpr_write_b32 a111, v75
    v_accvgpr_read_b32 v72, a112
    v_mul_f32 v72, v70, v72
    v_accvgpr_write_b32 a112, v72
    v_accvgpr_read_b32 v73, a113
    v_mul_f32 v73, v70, v73
    v_accvgpr_write_b32 a113, v73
    v_accvgpr_read_b32 v74, a114
    v_mul_f32 v74, v70, v74
    v_accvgpr_write_b32 a114, v74
    v_accvgpr_read_b32 v75, a115
    v_mul_f32 v75, v70, v75
    v_accvgpr_write_b32 a115, v75
    v_accvgpr_read_b32 v72, a116
    v_mul_f32 v72, v70, v72
    v_accvgpr_write_b32 a116, v72
    v_accvgpr_read_b32 v73, a117
    v_mul_f32 v73, v70, v73
    v_accvgpr_write_b32 a117, v73
    v_accvgpr_read_b32 v74, a118
    v_mul_f32 v74, v70, v74
    v_accvgpr_write_b32 a118, v74
    v_accvgpr_read_b32 v75, a119
    v_mul_f32 v75, v70, v75
    v_accvgpr_write_b32 a119, v75
    v_accvgpr_read_b32 v72, a120
    v_mul_f32 v72, v70, v72
    v_accvgpr_write_b32 a120, v72
    v_accvgpr_read_b32 v73, a121
    v_mul_f32 v73, v70, v73
    v_accvgpr_write_b32 a121, v73
    v_accvgpr_read_b32 v74, a122
    v_mul_f32 v74, v70, v74
    v_accvgpr_write_b32 a122, v74
    v_accvgpr_read_b32 v75, a123
    v_mul_f32 v75, v70, v75
    v_accvgpr_write_b32 a123, v75
    v_accvgpr_read_b32 v72, a124
    v_mul_f32 v72, v70, v72
    v_accvgpr_write_b32 a124, v72
    v_accvgpr_read_b32 v73, a125
    v_mul_f32 v73, v70, v73
    v_accvgpr_write_b32 a125, v73
    v_accvgpr_read_b32 v74, a126
    v_mul_f32 v74, v70, v74
    v_accvgpr_write_b32 a126, v74
    v_accvgpr_read_b32 v75, a127
    v_mul_f32 v75, v70, v75
    v_accvgpr_write_b32 a127, v75
    v_mov_b32 v68, v67
    v_mov_b32 v69, v67
    s_nop 0
    s_nop 0
    v_permlane32_swap_b32 v68, v69
    v_max_f32 v68, v68, v69
    v_mov_b32 v69, v68
    s_nop 0
    s_nop 0
    v_permlane16_swap_b32 v68, v69
    v_max_f32 v67, v68, v69
    v_max_f32 v67, v52, v67
    v_sub_f32 v70, v52, v67
    v_mul_f32 v70, s30, v70
    v_exp_f32 v70, v70
    v_mov_b32 v52, v67
    v_mul_f32 v57, s30, v52
    v_sub_f32 v57, 0, v57
    v_add_f32 v62, s31, v52
    v_mul_f32 v44, v70, v44
    v_mul_f32 v45, v70, v45
    v_mul_f32 v46, v70, v46
    v_mul_f32 v47, v70, v47
    v_accvgpr_read_b32 v72, a128
    v_mul_f32 v72, v70, v72
    v_accvgpr_write_b32 a128, v72
    v_accvgpr_read_b32 v73, a129
    v_mul_f32 v73, v70, v73
    v_accvgpr_write_b32 a129, v73
    v_accvgpr_read_b32 v74, a130
    v_mul_f32 v74, v70, v74
    v_accvgpr_write_b32 a130, v74
    v_accvgpr_read_b32 v75, a131
    v_mul_f32 v75, v70, v75
    v_accvgpr_write_b32 a131, v75
    v_accvgpr_read_b32 v72, a132
    v_mul_f32 v72, v70, v72
    v_accvgpr_write_b32 a132, v72
    v_accvgpr_read_b32 v73, a133
    v_mul_f32 v73, v70, v73
    v_accvgpr_write_b32 a133, v73
    v_accvgpr_read_b32 v74, a134
    v_mul_f32 v74, v70, v74
    v_accvgpr_write_b32 a134, v74
    v_accvgpr_read_b32 v75, a135
    v_mul_f32 v75, v70, v75
    v_accvgpr_write_b32 a135, v75
    v_accvgpr_read_b32 v72, a136
    v_mul_f32 v72, v70, v72
    v_accvgpr_write_b32 a136, v72
    v_accvgpr_read_b32 v73, a137
    v_mul_f32 v73, v70, v73
    v_accvgpr_write_b32 a137, v73
    v_accvgpr_read_b32 v74, a138
    v_mul_f32 v74, v70, v74
    v_accvgpr_write_b32 a138, v74
    v_accvgpr_read_b32 v75, a139
    v_mul_f32 v75, v70, v75
    v_accvgpr_write_b32 a139, v75
    v_accvgpr_read_b32 v72, a140
    v_mul_f32 v72, v70, v72
    v_accvgpr_write_b32 a140, v72
    v_accvgpr_read_b32 v73, a141
    v_mul_f32 v73, v70, v73
    v_accvgpr_write_b32 a141, v73
    v_accvgpr_read_b32 v74, a142
    v_mul_f32 v74, v70, v74
    v_accvgpr_write_b32 a142, v74
    v_accvgpr_read_b32 v75, a143
    v_mul_f32 v75, v70, v75
    v_accvgpr_write_b32 a143, v75
    v_accvgpr_read_b32 v72, a144
    v_mul_f32 v72, v70, v72
    v_accvgpr_write_b32 a144, v72
    v_accvgpr_read_b32 v73, a145
    v_mul_f32 v73, v70, v73
    v_accvgpr_write_b32 a145, v73
    v_accvgpr_read_b32 v74, a146
    v_mul_f32 v74, v70, v74
    v_accvgpr_write_b32 a146, v74
    v_accvgpr_read_b32 v75, a147
    v_mul_f32 v75, v70, v75
    v_accvgpr_write_b32 a147, v75
    v_accvgpr_read_b32 v72, a148
    v_mul_f32 v72, v70, v72
    v_accvgpr_write_b32 a148, v72
    v_accvgpr_read_b32 v73, a149
    v_mul_f32 v73, v70, v73
    v_accvgpr_write_b32 a149, v73
    v_accvgpr_read_b32 v74, a150
    v_mul_f32 v74, v70, v74
    v_accvgpr_write_b32 a150, v74
    v_accvgpr_read_b32 v75, a151
    v_mul_f32 v75, v70, v75
    v_accvgpr_write_b32 a151, v75
    v_accvgpr_read_b32 v72, a152
    v_mul_f32 v72, v70, v72
    v_accvgpr_write_b32 a152, v72
    v_accvgpr_read_b32 v73, a153
    v_mul_f32 v73, v70, v73
    v_accvgpr_write_b32 a153, v73
    v_accvgpr_read_b32 v74, a154
    v_mul_f32 v74, v70, v74
    v_accvgpr_write_b32 a154, v74
    v_accvgpr_read_b32 v75, a155
    v_mul_f32 v75, v70, v75
    v_accvgpr_write_b32 a155, v75
    v_accvgpr_read_b32 v72, a156
    v_mul_f32 v72, v70, v72
    v_accvgpr_write_b32 a156, v72
    v_accvgpr_read_b32 v73, a157
    v_mul_f32 v73, v70, v73
    v_accvgpr_write_b32 a157, v73
    v_accvgpr_read_b32 v74, a158
    v_mul_f32 v74, v70, v74
    v_accvgpr_write_b32 a158, v74
    v_accvgpr_read_b32 v75, a159
    v_mul_f32 v75, v70, v75
    v_accvgpr_write_b32 a159, v75
    s_nop 3
    s_branch L_ret5
L_slow6:
    s_nop 7
    s_nop 7
    v_mov_b32 v68, v63
    v_mov_b32 v69, v63
    s_nop 0
    s_nop 0
    v_permlane32_swap_b32 v68, v69
    v_max_f32 v68, v68, v69
    v_mov_b32 v69, v68
    s_nop 0
    s_nop 0
    v_permlane16_swap_b32 v68, v69
    v_max_f32 v63, v68, v69
    v_max_f32 v63, v48, v63
    v_sub_f32 v70, v48, v63
    v_mul_f32 v70, s30, v70
    v_exp_f32 v70, v70
    v_mov_b32 v48, v63
    v_mul_f32 v53, s30, v48
    v_sub_f32 v53, 0, v53
    v_add_f32 v58, s31, v48
    v_mul_f32 v28, v70, v28
    v_mul_f32 v29, v70, v29
    v_mul_f32 v30, v70, v30
    v_mul_f32 v31, v70, v31
    v_accvgpr_read_b32 v72, a0
    v_mul_f32 v72, v70, v72
    v_accvgpr_write_b32 a0, v72
    v_accvgpr_read_b32 v73, a1
    v_mul_f32 v73, v70, v73
    v_accvgpr_write_b32 a1, v73
    v_accvgpr_read_b32 v74, a2
    v_mul_f32 v74, v70, v74
    v_accvgpr_write_b32 a2, v74
    v_accvgpr_read_b32 v75, a3
    v_mul_f32 v75, v70, v75
    v_accvgpr_write_b32 a3, v75
    v_accvgpr_read_b32 v72, a4
    v_mul_f32 v72, v70, v72
    v_accvgpr_write_b32 a4, v72
    v_accvgpr_read_b32 v73, a5
    v_mul_f32 v73, v70, v73
    v_accvgpr_write_b32 a5, v73
    v_accvgpr_read_b32 v74, a6
    v_mul_f32 v74, v70, v74
    v_accvgpr_write_b32 a6, v74
    v_accvgpr_read_b32 v75, a7
    v_mul_f32 v75, v70, v75
    v_accvgpr_write_b32 a7, v75
    v_accvgpr_read_b32 v72, a8
    v_mul_f32 v72, v70, v72
    v_accvgpr_write_b32 a8, v72
    v_accvgpr_read_b32 v73, a9
    v_mul_f32 v73, v70, v73
    v_accvgpr_write_b32 a9, v73
    v_accvgpr_read_b32 v74, a10
    v_mul_f32 v74, v70, v74
    v_accvgpr_write_b32 a10, v74
    v_accvgpr_read_b32 v75, a11
    v_mul_f32 v75, v70, v75
    v_accvgpr_write_b32 a11, v75
    v_accvgpr_read_b32 v72, a12
    v_mul_f32 v72, v70, v72
    v_accvgpr_write_b32 a12, v72
    v_accvgpr_read_b32 v73, a13
    v_mul_f32 v73, v70, v73
    v_accvgpr_write_b32 a13, v73
    v_accvgpr_read_b32 v74, a14
    v_mul_f32 v74, v70, v74
    v_accvgpr_write_b32 a14, v74
    v_accvgpr_read_b32 v75, a15
    v_mul_f32 v75, v70, v75
    v_accvgpr_write_b32 a15, v75
    v_accvgpr_read_b32 v72, a16
    v_mul_f32 v72, v70, v72
    v_accvgpr_write_b32 a16, v72
    v_accvgpr_read_b32 v73, a17
    v_mul_f32 v73, v70, v73
    v_accvgpr_write_b32 a17, v73
    v_accvgpr_read_b32 v74, a18
    v_mul_f32 v74, v70, v74
    v_accvgpr_write_b32 a18, v74
    v_accvgpr_read_b32 v75, a19
    v_mul_f32 v75, v70, v75
    v_accvgpr_write_b32 a19, v75
    v_accvgpr_read_b32 v72, a20
    v_mul_f32 v72, v70, v72
    v_accvgpr_write_b32 a20, v72
    v_accvgpr_read_b32 v73, a21
    v_mul_f32 v73, v70, v73
    v_accvgpr_write_b32 a21, v73
    v_accvgpr_read_b32 v74, a22
    v_mul_f32 v74, v70, v74
    v_accvgpr_write_b32 a22, v74
    v_accvgpr_read_b32 v75, a23
    v_mul_f32 v75, v70, v75
    v_accvgpr_write_b32 a23, v75
    v_accvgpr_read_b32 v72, a24
    v_mul_f32 v72, v70, v72
    v_accvgpr_write_b32 a24, v72
    v_accvgpr_read_b32 v73, a25
    v_mul_f32 v73, v70, v73
    v_accvgpr_write_b32 a25, v73
    v_accvgpr_read_b32 v74, a26
    v_mul_f32 v74, v70, v74
    v_accvgpr_write_b32 a26, v74
    v_accvgpr_read_b32 v75, a27
    v_mul_f32 v75, v70, v75
    v_accvgpr_write_b32 a27, v75
    v_accvgpr_read_b32 v72, a28
    v_mul_f32 v72, v70, v72
    v_accvgpr_write_b32 a28, v72
    v_accvgpr_read_b32 v73, a29
    v_mul_f32 v73, v70, v73
    v_accvgpr_write_b32 a29, v73
    v_accvgpr_read_b32 v74, a30
    v_mul_f32 v74, v70, v74
    v_accvgpr_write_b32 a30, v74
    v_accvgpr_read_b32 v75, a31
    v_mul_f32 v75, v70, v75
    v_accvgpr_write_b32 a31, v75
    v_mov_b32 v68, v64
    v_mov_b32 v69, v64
    s_nop 0
    s_nop 0
    v_permlane32_swap_b32 v68, v69
    v_max_f32 v68, v68, v69
    v_mov_b32 v69, v68
    s_nop 0
    s_nop 0
    v_permlane16_swap_b32 v68, v69
    v_max_f32 v64, v68, v69
    v_max_f32 v64, v49, v64
    v_sub_f32 v70, v49, v64
    v_mul_f32 v70, s30, v70
    v_exp_f32 v70, v70
    v_mov_b32 v49, v64
    v_mul_f32 v54, s30, v49
    v_sub_f32 v54, 0, v54
    v_add_f32 v59, s31, v49
    v_mul_f32 v32, v70, v32
    v_mul_f32 v33, v70, v33
    v_mul_f32 v34, v70, v34
    v_mul_f32 v35, v70, v35
    v_accvgpr_read_b32 v72, a32
    v_mul_f32 v72, v70, v72
    v_accvgpr_write_b32 a32, v72
    v_accvgpr_read_b32 v73, a33
    v_mul_f32 v73, v70, v73
    v_accvgpr_write_b32 a33, v73
    v_accvgpr_read_b32 v74, a34
    v_mul_f32 v74, v70, v74
    v_accvgpr_write_b32 a34, v74
    v_accvgpr_read_b32 v75, a35
    v_mul_f32 v75, v70, v75
    v_accvgpr_write_b32 a35, v75
    v_accvgpr_read_b32 v72, a36
    v_mul_f32 v72, v70, v72
    v_accvgpr_write_b32 a36, v72
    v_accvgpr_read_b32 v73, a37
    v_mul_f32 v73, v70, v73
    v_accvgpr_write_b32 a37, v73
    v_accvgpr_read_b32 v74, a38
    v_mul_f32 v74, v70, v74
    v_accvgpr_write_b32 a38, v74
    v_accvgpr_read_b32 v75, a39
    v_mul_f32 v75, v70, v75
    v_accvgpr_write_b32 a39, v75
    v_accvgpr_read_b32 v72, a40
    v_mul_f32 v72, v70, v72
    v_accvgpr_write_b32 a40, v72
    v_accvgpr_read_b32 v73, a41
    v_mul_f32 v73, v70, v73
    v_accvgpr_write_b32 a41, v73
    v_accvgpr_read_b32 v74, a42
    v_mul_f32 v74, v70, v74
    v_accvgpr_write_b32 a42, v74
    v_accvgpr_read_b32 v75, a43
    v_mul_f32 v75, v70, v75
    v_accvgpr_write_b32 a43, v75
    v_accvgpr_read_b32 v72, a44
    v_mul_f32 v72, v70, v72
    v_accvgpr_write_b32 a44, v72
    v_accvgpr_read_b32 v73, a45
    v_mul_f32 v73, v70, v73
    v_accvgpr_write_b32 a45, v73
    v_accvgpr_read_b32 v74, a46
    v_mul_f32 v74, v70, v74
    v_accvgpr_write_b32 a46, v74
    v_accvgpr_read_b32 v75, a47
    v_mul_f32 v75, v70, v75
    v_accvgpr_write_b32 a47, v75
    v_accvgpr_read_b32 v72, a48
    v_mul_f32 v72, v70, v72
    v_accvgpr_write_b32 a48, v72
    v_accvgpr_read_b32 v73, a49
    v_mul_f32 v73, v70, v73
    v_accvgpr_write_b32 a49, v73
    v_accvgpr_read_b32 v74, a50
    v_mul_f32 v74, v70, v74
    v_accvgpr_write_b32 a50, v74
    v_accvgpr_read_b32 v75, a51
    v_mul_f32 v75, v70, v75
    v_accvgpr_write_b32 a51, v75
    v_accvgpr_read_b32 v72, a52
    v_mul_f32 v72, v70, v72
    v_accvgpr_write_b32 a52, v72
    v_accvgpr_read_b32 v73, a53
    v_mul_f32 v73, v70, v73
    v_accvgpr_write_b32 a53, v73
    v_accvgpr_read_b32 v74, a54
    v_mul_f32 v74, v70, v74
    v_accvgpr_write_b32 a54, v74
    v_accvgpr_read_b32 v75, a55
    v_mul_f32 v75, v70, v75
    v_accvgpr_write_b32 a55, v75
    v_accvgpr_read_b32 v72, a56
    v_mul_f32 v72, v70, v72
    v_accvgpr_write_b32 a56, v72
    v_accvgpr_read_b32 v73, a57
    v_mul_f32 v73, v70, v73
    v_accvgpr_write_b32 a57, v73
    v_accvgpr_read_b32 v74, a58
    v_mul_f32 v74, v70, v74
    v_accvgpr_write_b32 a58, v74
    v_accvgpr_read_b32 v75, a59
    v_mul_f32 v75, v70, v75
    v_accvgpr_write_b32 a59, v75
    v_accvgpr_read_b32 v72, a60
    v_mul_f32 v72, v70, v72
    v_accvgpr_write_b32 a60, v72
    v_accvgpr_read_b32 v73, a61
    v_mul_f32 v73, v70, v73
    v_accvgpr_write_b32 a61, v73
    v_accvgpr_read_b32 v74, a62
    v_mul_f32 v74, v70, v74
    v_accvgpr_write_b32 a62, v74
    v_accvgpr_read_b32 v75, a63
    v_mul_f32 v75, v70, v75
    v_accvgpr_write_b32 a63, v75
    v_mov_b32 v68, v65
    v_mov_b32 v69, v65
    s_nop 0
    s_nop 0
    v_permlane32_swap_b32 v68, v69
    v_max_f32 v68, v68, v69
    v_mov_b32 v69, v68
    s_nop 0
    s_nop 0
    v_permlane16_swap_b32 v68, v69
    v_max_f32 v65, v68, v69
    v_max_f32 v65, v50, v65
    v_sub_f32 v70, v50, v65
    v_mul_f32 v70, s30, v70
    v_exp_f32 v70, v70
    v_mov_b32 v50, v65
    v_mul_f32 v55, s30, v50
    v_sub_f32 v55, 0, v55
    v_add_f32 v60, s31, v50
    v_mul_f32 v36, v70, v36
    v_mul_f32 v37, v70, v37
    v_mul_f32 v38, v70, v38
    v_mul_f32 v39, v70, v39
    v_accvgpr_read_b32 v72, a64
    v_mul_f32 v72, v70, v72
    v_accvgpr_write_b32 a64, v72
    v_accvgpr_read_b32 v73, a65
    v_mul_f32 v73, v70, v73
    v_accvgpr_write_b32 a65, v73
    v_accvgpr_read_b32 v74, a66
    v_mul_f32 v74, v70, v74
    v_accvgpr_write_b32 a66, v74
    v_accvgpr_read_b32 v75, a67
    v_mul_f32 v75, v70, v75
    v_accvgpr_write_b32 a67, v75
    v_accvgpr_read_b32 v72, a68
    v_mul_f32 v72, v70, v72
    v_accvgpr_write_b32 a68, v72
    v_accvgpr_read_b32 v73, a69
    v_mul_f32 v73, v70, v73
    v_accvgpr_write_b32 a69, v73
    v_accvgpr_read_b32 v74, a70
    v_mul_f32 v74, v70, v74
    v_accvgpr_write_b32 a70, v74
    v_accvgpr_read_b32 v75, a71
    v_mul_f32 v75, v70, v75
    v_accvgpr_write_b32 a71, v75
    v_accvgpr_read_b32 v72, a72
    v_mul_f32 v72, v70, v72
    v_accvgpr_write_b32 a72, v72
    v_accvgpr_read_b32 v73, a73
    v_mul_f32 v73, v70, v73
    v_accvgpr_write_b32 a73, v73
    v_accvgpr_read_b32 v74, a74
    v_mul_f32 v74, v70, v74
    v_accvgpr_write_b32 a74, v74
    v_accvgpr_read_b32 v75, a75
    v_mul_f32 v75, v70, v75
    v_accvgpr_write_b32 a75, v75
    v_accvgpr_read_b32 v72, a76
    v_mul_f32 v72, v70, v72
    v_accvgpr_write_b32 a76, v72
    v_accvgpr_read_b32 v73, a77
    v_mul_f32 v73, v70, v73
    v_accvgpr_write_b32 a77, v73
    v_accvgpr_read_b32 v74, a78
    v_mul_f32 v74, v70, v74
    v_accvgpr_write_b32 a78, v74
    v_accvgpr_read_b32 v75, a79
    v_mul_f32 v75, v70, v75
    v_accvgpr_write_b32 a79, v75
    v_accvgpr_read_b32 v72, a80
    v_mul_f32 v72, v70, v72
    v_accvgpr_write_b32 a80, v72
    v_accvgpr_read_b32 v73, a81
    v_mul_f32 v73, v70, v73
    v_accvgpr_write_b32 a81, v73
    v_accvgpr_read_b32 v74, a82
    v_mul_f32 v74, v70, v74
    v_accvgpr_write_b32 a82, v74
    v_accvgpr_read_b32 v75, a83
    v_mul_f32 v75, v70, v75
    v_accvgpr_write_b32 a83, v75
    v_accvgpr_read_b32 v72, a84
    v_mul_f32 v72, v70, v72
    v_accvgpr_write_b32 a84, v72
    v_accvgpr_read_b32 v73, a85
    v_mul_f32 v73, v70, v73
    v_accvgpr_write_b32 a85, v73
    v_accvgpr_read_b32 v74, a86
    v_mul_f32 v74, v70, v74
    v_accvgpr_write_b32 a86, v74
    v_accvgpr_read_b32 v75, a87
    v_mul_f32 v75, v70, v75
    v_accvgpr_write_b32 a87, v75
    v_accvgpr_read_b32 v72, a88
    v_mul_f32 v72, v70, v72
    v_accvgpr_write_b32 a88, v72
    v_accvgpr_read_b32 v73, a89
    v_mul_f32 v73, v70, v73
    v_accvgpr_write_b32 a89, v73
    v_accvgpr_read_b32 v74, a90
    v_mul_f32 v74, v70, v74
    v_accvgpr_write_b32 a90, v74
    v_accvgpr_read_b32 v75, a91
    v_mul_f32 v75, v70, v75
    v_accvgpr_write_b32 a91, v75
    v_accvgpr_read_b32 v72, a92
    v_mul_f32 v72, v70, v72
    v_accvgpr_write_b32 a92, v72
    v_accvgpr_read_b32 v73, a93
    v_mul_f32 v73, v70, v73
    v_accvgpr_write_b32 a93, v73
    v_accvgpr_read_b32 v74, a94
    v_mul_f32 v74, v70, v74
    v_accvgpr_write_b32 a94, v74
    v_accvgpr_read_b32 v75, a95
    v_mul_f32 v75, v70, v75
    v_accvgpr_write_b32 a95, v75
    v_mov_b32 v68, v66
    v_mov_b32 v69, v66
    s_nop 0
    s_nop 0
    v_permlane32_swap_b32 v68, v69
    v_max_f32 v68, v68, v69
    v_mov_b32 v69, v68
    s_nop 0
    s_nop 0
    v_permlane16_swap_b32 v68, v69
    v_max_f32 v66, v68, v69
    v_max_f32 v66, v51, v66
    v_sub_f32 v70, v51, v66
    v_mul_f32 v70, s30, v70
    v_exp_f32 v70, v70
    v_mov_b32 v51, v66
    v_mul_f32 v56, s30, v51
    v_sub_f32 v56, 0, v56
    v_add_f32 v61, s31, v51
    v_mul_f32 v40, v70, v40
    v_mul_f32 v41, v70, v41
    v_mul_f32 v42, v70, v42
    v_mul_f32 v43, v70, v43
    v_accvgpr_read_b32 v72, a96
    v_mul_f32 v72, v70, v72
    v_accvgpr_write_b32 a96, v72
    v_accvgpr_read_b32 v73, a97
    v_mul_f32 v73, v70, v73
    v_accvgpr_write_b32 a97, v73
    v_accvgpr_read_b32 v74, a98
    v_mul_f32 v74, v70, v74
    v_accvgpr_write_b32 a98, v74
    v_accvgpr_read_b32 v75, a99
    v_mul_f32 v75, v70, v75
    v_accvgpr_write_b32 a99, v75
    v_accvgpr_read_b32 v72, a100
    v_mul_f32 v72, v70, v72
    v_accvgpr_write_b32 a100, v72
    v_accvgpr_read_b32 v73, a101
    v_mul_f32 v73, v70, v73
    v_accvgpr_write_b32 a101, v73
    v_accvgpr_read_b32 v74, a102
    v_mul_f32 v74, v70, v74
    v_accvgpr_write_b32 a102, v74
    v_accvgpr_read_b32 v75, a103
    v_mul_f32 v75, v70, v75
    v_accvgpr_write_b32 a103, v75
    v_accvgpr_read_b32 v72, a104
    v_mul_f32 v72, v70, v72
    v_accvgpr_write_b32 a104, v72
    v_accvgpr_read_b32 v73, a105
    v_mul_f32 v73, v70, v73
    v_accvgpr_write_b32 a105, v73
    v_accvgpr_read_b32 v74, a106
    v_mul_f32 v74, v70, v74
    v_accvgpr_write_b32 a106, v74
    v_accvgpr_read_b32 v75, a107
    v_mul_f32 v75, v70, v75
    v_accvgpr_write_b32 a107, v75
    v_accvgpr_read_b32 v72, a108
    v_mul_f32 v72, v70, v72
    v_accvgpr_write_b32 a108, v72
    v_accvgpr_read_b32 v73, a109
    v_mul_f32 v73, v70, v73
    v_accvgpr_write_b32 a109, v73
    v_accvgpr_read_b32 v74, a110
    v_mul_f32 v74, v70, v74
    v_accvgpr_write_b32 a110, v74
    v_accvgpr_read_b32 v75, a111
    v_mul_f32 v75, v70, v75
    v_accvgpr_write_b32 a111, v75
    v_accvgpr_read_b32 v72, a112
    v_mul_f32 v72, v70, v72
    v_accvgpr_write_b32 a112, v72
    v_accvgpr_read_b32 v73, a113
    v_mul_f32 v73, v70, v73
    v_accvgpr_write_b32 a113, v73
    v_accvgpr_read_b32 v74, a114
    v_mul_f32 v74, v70, v74
    v_accvgpr_write_b32 a114, v74
    v_accvgpr_read_b32 v75, a115
    v_mul_f32 v75, v70, v75
    v_accvgpr_write_b32 a115, v75
    v_accvgpr_read_b32 v72, a116
    v_mul_f32 v72, v70, v72
    v_accvgpr_write_b32 a116, v72
    v_accvgpr_read_b32 v73, a117
    v_mul_f32 v73, v70, v73
    v_accvgpr_write_b32 a117, v73
    v_accvgpr_read_b32 v74, a118
    v_mul_f32 v74, v70, v74
    v_accvgpr_write_b32 a118, v74
    v_accvgpr_read_b32 v75, a119
    v_mul_f32 v75, v70, v75
    v_accvgpr_write_b32 a119, v75
    v_accvgpr_read_b32 v72, a120
    v_mul_f32 v72, v70, v72
    v_accvgpr_write_b32 a120, v72
    v_accvgpr_read_b32 v73, a121
    v_mul_f32 v73, v70, v73
    v_accvgpr_write_b32 a121, v73
    v_accvgpr_read_b32 v74, a122
    v_mul_f32 v74, v70, v74
    v_accvgpr_write_b32 a122, v74
    v_accvgpr_read_b32 v75, a123
    v_mul_f32 v75, v70, v75
    v_accvgpr_write_b32 a123, v75
    v_accvgpr_read_b32 v72, a124
    v_mul_f32 v72, v70, v72
    v_accvgpr_write_b32 a124, v72
    v_accvgpr_read_b32 v73, a125
    v_mul_f32 v73, v70, v73
    v_accvgpr_write_b32 a125, v73
    v_accvgpr_read_b32 v74, a126
    v_mul_f32 v74, v70, v74
    v_accvgpr_write_b32 a126, v74
    v_accvgpr_read_b32 v75, a127
    v_mul_f32 v75, v70, v75
    v_accvgpr_write_b32 a127, v75
    v_mov_b32 v68, v67
    v_mov_b32 v69, v67
    s_nop 0
    s_nop 0
    v_permlane32_swap_b32 v68, v69
    v_max_f32 v68, v68, v69
    v_mov_b32 v69, v68
    s_nop 0
    s_nop 0
    v_permlane16_swap_b32 v68, v69
    v_max_f32 v67, v68, v69
    v_max_f32 v67, v52, v67
    v_sub_f32 v70, v52, v67
    v_mul_f32 v70, s30, v70
    v_exp_f32 v70, v70
    v_mov_b32 v52, v67
    v_mul_f32 v57, s30, v52
    v_sub_f32 v57, 0, v57
    v_add_f32 v62, s31, v52
    v_mul_f32 v44, v70, v44
    v_mul_f32 v45, v70, v45
    v_mul_f32 v46, v70, v46
    v_mul_f32 v47, v70, v47
    v_accvgpr_read_b32 v72, a128
    v_mul_f32 v72, v70, v72
    v_accvgpr_write_b32 a128, v72
    v_accvgpr_read_b32 v73, a129
    v_mul_f32 v73, v70, v73
    v_accvgpr_write_b32 a129, v73
    v_accvgpr_read_b32 v74, a130
    v_mul_f32 v74, v70, v74
    v_accvgpr_write_b32 a130, v74
    v_accvgpr_read_b32 v75, a131
    v_mul_f32 v75, v70, v75
    v_accvgpr_write_b32 a131, v75
    v_accvgpr_read_b32 v72, a132
    v_mul_f32 v72, v70, v72
    v_accvgpr_write_b32 a132, v72
    v_accvgpr_read_b32 v73, a133
    v_mul_f32 v73, v70, v73
    v_accvgpr_write_b32 a133, v73
    v_accvgpr_read_b32 v74, a134
    v_mul_f32 v74, v70, v74
    v_accvgpr_write_b32 a134, v74
    v_accvgpr_read_b32 v75, a135
    v_mul_f32 v75, v70, v75
    v_accvgpr_write_b32 a135, v75
    v_accvgpr_read_b32 v72, a136
    v_mul_f32 v72, v70, v72
    v_accvgpr_write_b32 a136, v72
    v_accvgpr_read_b32 v73, a137
    v_mul_f32 v73, v70, v73
    v_accvgpr_write_b32 a137, v73
    v_accvgpr_read_b32 v74, a138
    v_mul_f32 v74, v70, v74
    v_accvgpr_write_b32 a138, v74
    v_accvgpr_read_b32 v75, a139
    v_mul_f32 v75, v70, v75
    v_accvgpr_write_b32 a139, v75
    v_accvgpr_read_b32 v72, a140
    v_mul_f32 v72, v70, v72
    v_accvgpr_write_b32 a140, v72
    v_accvgpr_read_b32 v73, a141
    v_mul_f32 v73, v70, v73
    v_accvgpr_write_b32 a141, v73
    v_accvgpr_read_b32 v74, a142
    v_mul_f32 v74, v70, v74
    v_accvgpr_write_b32 a142, v74
    v_accvgpr_read_b32 v75, a143
    v_mul_f32 v75, v70, v75
    v_accvgpr_write_b32 a143, v75
    v_accvgpr_read_b32 v72, a144
    v_mul_f32 v72, v70, v72
    v_accvgpr_write_b32 a144, v72
    v_accvgpr_read_b32 v73, a145
    v_mul_f32 v73, v70, v73
    v_accvgpr_write_b32 a145, v73
    v_accvgpr_read_b32 v74, a146
    v_mul_f32 v74, v70, v74
    v_accvgpr_write_b32 a146, v74
    v_accvgpr_read_b32 v75, a147
    v_mul_f32 v75, v70, v75
    v_accvgpr_write_b32 a147, v75
    v_accvgpr_read_b32 v72, a148
    v_mul_f32 v72, v70, v72
    v_accvgpr_write_b32 a148, v72
    v_accvgpr_read_b32 v73, a149
    v_mul_f32 v73, v70, v73
    v_accvgpr_write_b32 a149, v73
    v_accvgpr_read_b32 v74, a150
    v_mul_f32 v74, v70, v74
    v_accvgpr_write_b32 a150, v74
    v_accvgpr_read_b32 v75, a151
    v_mul_f32 v75, v70, v75
    v_accvgpr_write_b32 a151, v75
    v_accvgpr_read_b32 v72, a152
    v_mul_f32 v72, v70, v72
    v_accvgpr_write_b32 a152, v72
    v_accvgpr_read_b32 v73, a153
    v_mul_f32 v73, v70, v73
    v_accvgpr_write_b32 a153, v73
    v_accvgpr_read_b32 v74, a154
    v_mul_f32 v74, v70, v74
    v_accvgpr_write_b32 a154, v74
    v_accvgpr_read_b32 v75, a155
    v_mul_f32 v75, v70, v75
    v_accvgpr_write_b32 a155, v75
    v_accvgpr_read_b32 v72, a156
    v_mul_f32 v72, v70, v72
    v_accvgpr_write_b32 a156, v72
    v_accvgpr_read_b32 v73, a157
    v_mul_f32 v73, v70, v73
    v_accvgpr_write_b32 a157, v73
    v_accvgpr_read_b32 v74, a158
    v_mul_f32 v74, v70, v74
    v_accvgpr_write_b32 a158, v74
    v_accvgpr_read_b32 v75, a159
    v_mul_f32 v75, v70, v75
    v_accvgpr_write_b32 a159, v75
    s_nop 3
    s_branch L_ret6
L_slow7:
    s_nop 7
    s_nop 7
    v_mov_b32 v68, v63
    v_mov_b32 v69, v63
    s_nop 0
    s_nop 0
    v_permlane32_swap_b32 v68, v69
    v_max_f32 v68, v68, v69
    v_mov_b32 v69, v68
    s_nop 0
    s_nop 0
    v_permlane16_swap_b32 v68, v69
    v_max_f32 v63, v68, v69
    v_max_f32 v63, v48, v63
    v_sub_f32 v70, v48, v63
    v_mul_f32 v70, s30, v70
    v_exp_f32 v70, v70
    v_mov_b32 v48, v63
    v_mul_f32 v53, s30, v48
    v_sub_f32 v53, 0, v53
    v_add_f32 v58, s31, v48
    v_mul_f32 v28, v70, v28
    v_mul_f32 v29, v70, v29
    v_mul_f32 v30, v70, v30
    v_mul_f32 v31, v70, v31
    v_accvgpr_read_b32 v72, a0
    v_mul_f32 v72, v70, v72
    v_accvgpr_write_b32 a0, v72
    v_accvgpr_read_b32 v73, a1
    v_mul_f32 v73, v70, v73
    v_accvgpr_write_b32 a1, v73
    v_accvgpr_read_b32 v74, a2
    v_mul_f32 v74, v70, v74
    v_accvgpr_write_b32 a2, v74
    v_accvgpr_read_b32 v75, a3
    v_mul_f32 v75, v70, v75
    v_accvgpr_write_b32 a3, v75
    v_accvgpr_read_b32 v72, a4
    v_mul_f32 v72, v70, v72
    v_accvgpr_write_b32 a4, v72
    v_accvgpr_read_b32 v73, a5
    v_mul_f32 v73, v70, v73
    v_accvgpr_write_b32 a5, v73
    v_accvgpr_read_b32 v74, a6
    v_mul_f32 v74, v70, v74
    v_accvgpr_write_b32 a6, v74
    v_accvgpr_read_b32 v75, a7
    v_mul_f32 v75, v70, v75
    v_accvgpr_write_b32 a7, v75
    v_accvgpr_read_b32 v72, a8
    v_mul_f32 v72, v70, v72
    v_accvgpr_write_b32 a8, v72
    v_accvgpr_read_b32 v73, a9
    v_mul_f32 v73, v70, v73
    v_accvgpr_write_b32 a9, v73
    v_accvgpr_read_b32 v74, a10
    v_mul_f32 v74, v70, v74
    v_accvgpr_write_b32 a10, v74
    v_accvgpr_read_b32 v75, a11
    v_mul_f32 v75, v70, v75
    v_accvgpr_write_b32 a11, v75
    v_accvgpr_read_b32 v72, a12
    v_mul_f32 v72, v70, v72
    v_accvgpr_write_b32 a12, v72
    v_accvgpr_read_b32 v73, a13
    v_mul_f32 v73, v70, v73
    v_accvgpr_write_b32 a13, v73
    v_accvgpr_read_b32 v74, a14
    v_mul_f32 v74, v70, v74
    v_accvgpr_write_b32 a14, v74
    v_accvgpr_read_b32 v75, a15
    v_mul_f32 v75, v70, v75
    v_accvgpr_write_b32 a15, v75
    v_accvgpr_read_b32 v72, a16
    v_mul_f32 v72, v70, v72
    v_accvgpr_write_b32 a16, v72
    v_accvgpr_read_b32 v73, a17
    v_mul_f32 v73, v70, v73
    v_accvgpr_write_b32 a17, v73
    v_accvgpr_read_b32 v74, a18
    v_mul_f32 v74, v70, v74
    v_accvgpr_write_b32 a18, v74
    v_accvgpr_read_b32 v75, a19
    v_mul_f32 v75, v70, v75
    v_accvgpr_write_b32 a19, v75
    v_accvgpr_read_b32 v72, a20
    v_mul_f32 v72, v70, v72
    v_accvgpr_write_b32 a20, v72
    v_accvgpr_read_b32 v73, a21
    v_mul_f32 v73, v70, v73
    v_accvgpr_write_b32 a21, v73
    v_accvgpr_read_b32 v74, a22
    v_mul_f32 v74, v70, v74
    v_accvgpr_write_b32 a22, v74
    v_accvgpr_read_b32 v75, a23
    v_mul_f32 v75, v70, v75
    v_accvgpr_write_b32 a23, v75
    v_accvgpr_read_b32 v72, a24
    v_mul_f32 v72, v70, v72
    v_accvgpr_write_b32 a24, v72
    v_accvgpr_read_b32 v73, a25
    v_mul_f32 v73, v70, v73
    v_accvgpr_write_b32 a25, v73
    v_accvgpr_read_b32 v74, a26
    v_mul_f32 v74, v70, v74
    v_accvgpr_write_b32 a26, v74
    v_accvgpr_read_b32 v75, a27
    v_mul_f32 v75, v70, v75
    v_accvgpr_write_b32 a27, v75
    v_accvgpr_read_b32 v72, a28
    v_mul_f32 v72, v70, v72
    v_accvgpr_write_b32 a28, v72
    v_accvgpr_read_b32 v73, a29
    v_mul_f32 v73, v70, v73
    v_accvgpr_write_b32 a29, v73
    v_accvgpr_read_b32 v74, a30
    v_mul_f32 v74, v70, v74
    v_accvgpr_write_b32 a30, v74
    v_accvgpr_read_b32 v75, a31
    v_mul_f32 v75, v70, v75
    v_accvgpr_write_b32 a31, v75
    v_mov_b32 v68, v64
    v_mov_b32 v69, v64
    s_nop 0
    s_nop 0
    v_permlane32_swap_b32 v68, v69
    v_max_f32 v68, v68, v69
    v_mov_b32 v69, v68
    s_nop 0
    s_nop 0
    v_permlane16_swap_b32 v68, v69
    v_max_f32 v64, v68, v69
    v_max_f32 v64, v49, v64
    v_sub_f32 v70, v49, v64
    v_mul_f32 v70, s30, v70
    v_exp_f32 v70, v70
    v_mov_b32 v49, v64
    v_mul_f32 v54, s30, v49
    v_sub_f32 v54, 0, v54
    v_add_f32 v59, s31, v49
    v_mul_f32 v32, v70, v32
    v_mul_f32 v33, v70, v33
    v_mul_f32 v34, v70, v34
    v_mul_f32 v35, v70, v35
    v_accvgpr_read_b32 v72, a32
    v_mul_f32 v72, v70, v72
    v_accvgpr_write_b32 a32, v72
    v_accvgpr_read_b32 v73, a33
    v_mul_f32 v73, v70, v73
    v_accvgpr_write_b32 a33, v73
    v_accvgpr_read_b32 v74, a34
    v_mul_f32 v74, v70, v74
    v_accvgpr_write_b32 a34, v74
    v_accvgpr_read_b32 v75, a35
    v_mul_f32 v75, v70, v75
    v_accvgpr_write_b32 a35, v75
    v_accvgpr_read_b32 v72, a36
    v_mul_f32 v72, v70, v72
    v_accvgpr_write_b32 a36, v72
    v_accvgpr_read_b32 v73, a37
    v_mul_f32 v73, v70, v73
    v_accvgpr_write_b32 a37, v73
    v_accvgpr_read_b32 v74, a38
    v_mul_f32 v74, v70, v74
    v_accvgpr_write_b32 a38, v74
    v_accvgpr_read_b32 v75, a39
    v_mul_f32 v75, v70, v75
    v_accvgpr_write_b32 a39, v75
    v_accvgpr_read_b32 v72, a40
    v_mul_f32 v72, v70, v72
    v_accvgpr_write_b32 a40, v72
    v_accvgpr_read_b32 v73, a41
    v_mul_f32 v73, v70, v73
    v_accvgpr_write_b32 a41, v73
    v_accvgpr_read_b32 v74, a42
    v_mul_f32 v74, v70, v74
    v_accvgpr_write_b32 a42, v74
    v_accvgpr_read_b32 v75, a43
    v_mul_f32 v75, v70, v75
    v_accvgpr_write_b32 a43, v75
    v_accvgpr_read_b32 v72, a44
    v_mul_f32 v72, v70, v72
    v_accvgpr_write_b32 a44, v72
    v_accvgpr_read_b32 v73, a45
    v_mul_f32 v73, v70, v73
    v_accvgpr_write_b32 a45, v73
    v_accvgpr_read_b32 v74, a46
    v_mul_f32 v74, v70, v74
    v_accvgpr_write_b32 a46, v74
    v_accvgpr_read_b32 v75, a47
    v_mul_f32 v75, v70, v75
    v_accvgpr_write_b32 a47, v75
    v_accvgpr_read_b32 v72, a48
    v_mul_f32 v72, v70, v72
    v_accvgpr_write_b32 a48, v72
    v_accvgpr_read_b32 v73, a49
    v_mul_f32 v73, v70, v73
    v_accvgpr_write_b32 a49, v73
    v_accvgpr_read_b32 v74, a50
    v_mul_f32 v74, v70, v74
    v_accvgpr_write_b32 a50, v74
    v_accvgpr_read_b32 v75, a51
    v_mul_f32 v75, v70, v75
    v_accvgpr_write_b32 a51, v75
    v_accvgpr_read_b32 v72, a52
    v_mul_f32 v72, v70, v72
    v_accvgpr_write_b32 a52, v72
    v_accvgpr_read_b32 v73, a53
    v_mul_f32 v73, v70, v73
    v_accvgpr_write_b32 a53, v73
    v_accvgpr_read_b32 v74, a54
    v_mul_f32 v74, v70, v74
    v_accvgpr_write_b32 a54, v74
    v_accvgpr_read_b32 v75, a55
    v_mul_f32 v75, v70, v75
    v_accvgpr_write_b32 a55, v75
    v_accvgpr_read_b32 v72, a56
    v_mul_f32 v72, v70, v72
    v_accvgpr_write_b32 a56, v72
    v_accvgpr_read_b32 v73, a57
    v_mul_f32 v73, v70, v73
    v_accvgpr_write_b32 a57, v73
    v_accvgpr_read_b32 v74, a58
    v_mul_f32 v74, v70, v74
    v_accvgpr_write_b32 a58, v74
    v_accvgpr_read_b32 v75, a59
    v_mul_f32 v75, v70, v75
    v_accvgpr_write_b32 a59, v75
    v_accvgpr_read_b32 v72, a60
    v_mul_f32 v72, v70, v72
    v_accvgpr_write_b32 a60, v72
    v_accvgpr_read_b32 v73, a61
    v_mul_f32 v73, v70, v73
    v_accvgpr_write_b32 a61, v73
    v_accvgpr_read_b32 v74, a62
    v_mul_f32 v74, v70, v74
    v_accvgpr_write_b32 a62, v74
    v_accvgpr_read_b32 v75, a63
    v_mul_f32 v75, v70, v75
    v_accvgpr_write_b32 a63, v75
    v_mov_b32 v68, v65
    v_mov_b32 v69, v65
    s_nop 0
    s_nop 0
    v_permlane32_swap_b32 v68, v69
    v_max_f32 v68, v68, v69
    v_mov_b32 v69, v68
    s_nop 0
    s_nop 0
    v_permlane16_swap_b32 v68, v69
    v_max_f32 v65, v68, v69
    v_max_f32 v65, v50, v65
    v_sub_f32 v70, v50, v65
    v_mul_f32 v70, s30, v70
    v_exp_f32 v70, v70
    v_mov_b32 v50, v65
    v_mul_f32 v55, s30, v50
    v_sub_f32 v55, 0, v55
    v_add_f32 v60, s31, v50
    v_mul_f32 v36, v70, v36
    v_mul_f32 v37, v70, v37
    v_mul_f32 v38, v70, v38
    v_mul_f32 v39, v70, v39
    v_accvgpr_read_b32 v72, a64
    v_mul_f32 v72, v70, v72
    v_accvgpr_write_b32 a64, v72
    v_accvgpr_read_b32 v73, a65
    v_mul_f32 v73, v70, v73
    v_accvgpr_write_b32 a65, v73
    v_accvgpr_read_b32 v74, a66
    v_mul_f32 v74, v70, v74
    v_accvgpr_write_b32 a66, v74
    v_accvgpr_read_b32 v75, a67
    v_mul_f32 v75, v70, v75
    v_accvgpr_write_b32 a67, v75
    v_accvgpr_read_b32 v72, a68
    v_mul_f32 v72, v70, v72
    v_accvgpr_write_b32 a68, v72
    v_accvgpr_read_b32 v73, a69
    v_mul_f32 v73, v70, v73
    v_accvgpr_write_b32 a69, v73
    v_accvgpr_read_b32 v74, a70
    v_mul_f32 v74, v70, v74
    v_accvgpr_write_b32 a70, v74
    v_accvgpr_read_b32 v75, a71
    v_mul_f32 v75, v70, v75
    v_accvgpr_write_b32 a71, v75
    v_accvgpr_read_b32 v72, a72
    v_mul_f32 v72, v70, v72
    v_accvgpr_write_b32 a72, v72
    v_accvgpr_read_b32 v73, a73
    v_mul_f32 v73, v70, v73
    v_accvgpr_write_b32 a73, v73
    v_accvgpr_read_b32 v74, a74
    v_mul_f32 v74, v70, v74
    v_accvgpr_write_b32 a74, v74
    v_accvgpr_read_b32 v75, a75
    v_mul_f32 v75, v70, v75
    v_accvgpr_write_b32 a75, v75
    v_accvgpr_read_b32 v72, a76
    v_mul_f32 v72, v70, v72
    v_accvgpr_write_b32 a76, v72
    v_accvgpr_read_b32 v73, a77
    v_mul_f32 v73, v70, v73
    v_accvgpr_write_b32 a77, v73
    v_accvgpr_read_b32 v74, a78
    v_mul_f32 v74, v70, v74
    v_accvgpr_write_b32 a78, v74
    v_accvgpr_read_b32 v75, a79
    v_mul_f32 v75, v70, v75
    v_accvgpr_write_b32 a79, v75
    v_accvgpr_read_b32 v72, a80
    v_mul_f32 v72, v70, v72
    v_accvgpr_write_b32 a80, v72
    v_accvgpr_read_b32 v73, a81
    v_mul_f32 v73, v70, v73
    v_accvgpr_write_b32 a81, v73
    v_accvgpr_read_b32 v74, a82
    v_mul_f32 v74, v70, v74
    v_accvgpr_write_b32 a82, v74
    v_accvgpr_read_b32 v75, a83
    v_mul_f32 v75, v70, v75
    v_accvgpr_write_b32 a83, v75
    v_accvgpr_read_b32 v72, a84
    v_mul_f32 v72, v70, v72
    v_accvgpr_write_b32 a84, v72
    v_accvgpr_read_b32 v73, a85
    v_mul_f32 v73, v70, v73
    v_accvgpr_write_b32 a85, v73
    v_accvgpr_read_b32 v74, a86
    v_mul_f32 v74, v70, v74
    v_accvgpr_write_b32 a86, v74
    v_accvgpr_read_b32 v75, a87
    v_mul_f32 v75, v70, v75
    v_accvgpr_write_b32 a87, v75
    v_accvgpr_read_b32 v72, a88
    v_mul_f32 v72, v70, v72
    v_accvgpr_write_b32 a88, v72
    v_accvgpr_read_b32 v73, a89
    v_mul_f32 v73, v70, v73
    v_accvgpr_write_b32 a89, v73
    v_accvgpr_read_b32 v74, a90
    v_mul_f32 v74, v70, v74
    v_accvgpr_write_b32 a90, v74
    v_accvgpr_read_b32 v75, a91
    v_mul_f32 v75, v70, v75
    v_accvgpr_write_b32 a91, v75
    v_accvgpr_read_b32 v72, a92
    v_mul_f32 v72, v70, v72
    v_accvgpr_write_b32 a92, v72
    v_accvgpr_read_b32 v73, a93
    v_mul_f32 v73, v70, v73
    v_accvgpr_write_b32 a93, v73
    v_accvgpr_read_b32 v74, a94
    v_mul_f32 v74, v70, v74
    v_accvgpr_write_b32 a94, v74
    v_accvgpr_read_b32 v75, a95
    v_mul_f32 v75, v70, v75
    v_accvgpr_write_b32 a95, v75
    v_mov_b32 v68, v66
    v_mov_b32 v69, v66
    s_nop 0
    s_nop 0
    v_permlane32_swap_b32 v68, v69
    v_max_f32 v68, v68, v69
    v_mov_b32 v69, v68
    s_nop 0
    s_nop 0
    v_permlane16_swap_b32 v68, v69
    v_max_f32 v66, v68, v69
    v_max_f32 v66, v51, v66
    v_sub_f32 v70, v51, v66
    v_mul_f32 v70, s30, v70
    v_exp_f32 v70, v70
    v_mov_b32 v51, v66
    v_mul_f32 v56, s30, v51
    v_sub_f32 v56, 0, v56
    v_add_f32 v61, s31, v51
    v_mul_f32 v40, v70, v40
    v_mul_f32 v41, v70, v41
    v_mul_f32 v42, v70, v42
    v_mul_f32 v43, v70, v43
    v_accvgpr_read_b32 v72, a96
    v_mul_f32 v72, v70, v72
    v_accvgpr_write_b32 a96, v72
    v_accvgpr_read_b32 v73, a97
    v_mul_f32 v73, v70, v73
    v_accvgpr_write_b32 a97, v73
    v_accvgpr_read_b32 v74, a98
    v_mul_f32 v74, v70, v74
    v_accvgpr_write_b32 a98, v74
    v_accvgpr_read_b32 v75, a99
    v_mul_f32 v75, v70, v75
    v_accvgpr_write_b32 a99, v75
    v_accvgpr_read_b32 v72, a100
    v_mul_f32 v72, v70, v72
    v_accvgpr_write_b32 a100, v72
    v_accvgpr_read_b32 v73, a101
    v_mul_f32 v73, v70, v73
    v_accvgpr_write_b32 a101, v73
    v_accvgpr_read_b32 v74, a102
    v_mul_f32 v74, v70, v74
    v_accvgpr_write_b32 a102, v74
    v_accvgpr_read_b32 v75, a103
    v_mul_f32 v75, v70, v75
    v_accvgpr_write_b32 a103, v75
    v_accvgpr_read_b32 v72, a104
    v_mul_f32 v72, v70, v72
    v_accvgpr_write_b32 a104, v72
    v_accvgpr_read_b32 v73, a105
    v_mul_f32 v73, v70, v73
    v_accvgpr_write_b32 a105, v73
    v_accvgpr_read_b32 v74, a106
    v_mul_f32 v74, v70, v74
    v_accvgpr_write_b32 a106, v74
    v_accvgpr_read_b32 v75, a107
    v_mul_f32 v75, v70, v75
    v_accvgpr_write_b32 a107, v75
    v_accvgpr_read_b32 v72, a108
    v_mul_f32 v72, v70, v72
    v_accvgpr_write_b32 a108, v72
    v_accvgpr_read_b32 v73, a109
    v_mul_f32 v73, v70, v73
    v_accvgpr_write_b32 a109, v73
    v_accvgpr_read_b32 v74, a110
    v_mul_f32 v74, v70, v74
    v_accvgpr_write_b32 a110, v74
    v_accvgpr_read_b32 v75, a111
    v_mul_f32 v75, v70, v75
    v_accvgpr_write_b32 a111, v75
    v_accvgpr_read_b32 v72, a112
    v_mul_f32 v72, v70, v72
    v_accvgpr_write_b32 a112, v72
    v_accvgpr_read_b32 v73, a113
    v_mul_f32 v73, v70, v73
    v_accvgpr_write_b32 a113, v73
    v_accvgpr_read_b32 v74, a114
    v_mul_f32 v74, v70, v74
    v_accvgpr_write_b32 a114, v74
    v_accvgpr_read_b32 v75, a115
    v_mul_f32 v75, v70, v75
    v_accvgpr_write_b32 a115, v75
    v_accvgpr_read_b32 v72, a116
    v_mul_f32 v72, v70, v72
    v_accvgpr_write_b32 a116, v72
    v_accvgpr_read_b32 v73, a117
    v_mul_f32 v73, v70, v73
    v_accvgpr_write_b32 a117, v73
    v_accvgpr_read_b32 v74, a118
    v_mul_f32 v74, v70, v74
    v_accvgpr_write_b32 a118, v74
    v_accvgpr_read_b32 v75, a119
    v_mul_f32 v75, v70, v75
    v_accvgpr_write_b32 a119, v75
    v_accvgpr_read_b32 v72, a120
    v_mul_f32 v72, v70, v72
    v_accvgpr_write_b32 a120, v72
    v_accvgpr_read_b32 v73, a121
    v_mul_f32 v73, v70, v73
    v_accvgpr_write_b32 a121, v73
    v_accvgpr_read_b32 v74, a122
    v_mul_f32 v74, v70, v74
    v_accvgpr_write_b32 a122, v74
    v_accvgpr_read_b32 v75, a123
    v_mul_f32 v75, v70, v75
    v_accvgpr_write_b32 a123, v75
    v_accvgpr_read_b32 v72, a124
    v_mul_f32 v72, v70, v72
    v_accvgpr_write_b32 a124, v72
    v_accvgpr_read_b32 v73, a125
    v_mul_f32 v73, v70, v73
    v_accvgpr_write_b32 a125, v73
    v_accvgpr_read_b32 v74, a126
    v_mul_f32 v74, v70, v74
    v_accvgpr_write_b32 a126, v74
    v_accvgpr_read_b32 v75, a127
    v_mul_f32 v75, v70, v75
    v_accvgpr_write_b32 a127, v75
    v_mov_b32 v68, v67
    v_mov_b32 v69, v67
    s_nop 0
    s_nop 0
    v_permlane32_swap_b32 v68, v69
    v_max_f32 v68, v68, v69
    v_mov_b32 v69, v68
    s_nop 0
    s_nop 0
    v_permlane16_swap_b32 v68, v69
    v_max_f32 v67, v68, v69
    v_max_f32 v67, v52, v67
    v_sub_f32 v70, v52, v67
    v_mul_f32 v70, s30, v70
    v_exp_f32 v70, v70
    v_mov_b32 v52, v67
    v_mul_f32 v57, s30, v52
    v_sub_f32 v57, 0, v57
    v_add_f32 v62, s31, v52
    v_mul_f32 v44, v70, v44
    v_mul_f32 v45, v70, v45
    v_mul_f32 v46, v70, v46
    v_mul_f32 v47, v70, v47
    v_accvgpr_read_b32 v72, a128
    v_mul_f32 v72, v70, v72
    v_accvgpr_write_b32 a128, v72
    v_accvgpr_read_b32 v73, a129
    v_mul_f32 v73, v70, v73
    v_accvgpr_write_b32 a129, v73
    v_accvgpr_read_b32 v74, a130
    v_mul_f32 v74, v70, v74
    v_accvgpr_write_b32 a130, v74
    v_accvgpr_read_b32 v75, a131
    v_mul_f32 v75, v70, v75
    v_accvgpr_write_b32 a131, v75
    v_accvgpr_read_b32 v72, a132
    v_mul_f32 v72, v70, v72
    v_accvgpr_write_b32 a132, v72
    v_accvgpr_read_b32 v73, a133
    v_mul_f32 v73, v70, v73
    v_accvgpr_write_b32 a133, v73
    v_accvgpr_read_b32 v74, a134
    v_mul_f32 v74, v70, v74
    v_accvgpr_write_b32 a134, v74
    v_accvgpr_read_b32 v75, a135
    v_mul_f32 v75, v70, v75
    v_accvgpr_write_b32 a135, v75
    v_accvgpr_read_b32 v72, a136
    v_mul_f32 v72, v70, v72
    v_accvgpr_write_b32 a136, v72
    v_accvgpr_read_b32 v73, a137
    v_mul_f32 v73, v70, v73
    v_accvgpr_write_b32 a137, v73
    v_accvgpr_read_b32 v74, a138
    v_mul_f32 v74, v70, v74
    v_accvgpr_write_b32 a138, v74
    v_accvgpr_read_b32 v75, a139
    v_mul_f32 v75, v70, v75
    v_accvgpr_write_b32 a139, v75
    v_accvgpr_read_b32 v72, a140
    v_mul_f32 v72, v70, v72
    v_accvgpr_write_b32 a140, v72
    v_accvgpr_read_b32 v73, a141
    v_mul_f32 v73, v70, v73
    v_accvgpr_write_b32 a141, v73
    v_accvgpr_read_b32 v74, a142
    v_mul_f32 v74, v70, v74
    v_accvgpr_write_b32 a142, v74
    v_accvgpr_read_b32 v75, a143
    v_mul_f32 v75, v70, v75
    v_accvgpr_write_b32 a143, v75
    v_accvgpr_read_b32 v72, a144
    v_mul_f32 v72, v70, v72
    v_accvgpr_write_b32 a144, v72
    v_accvgpr_read_b32 v73, a145
    v_mul_f32 v73, v70, v73
    v_accvgpr_write_b32 a145, v73
    v_accvgpr_read_b32 v74, a146
    v_mul_f32 v74, v70, v74
    v_accvgpr_write_b32 a146, v74
    v_accvgpr_read_b32 v75, a147
    v_mul_f32 v75, v70, v75
    v_accvgpr_write_b32 a147, v75
    v_accvgpr_read_b32 v72, a148
    v_mul_f32 v72, v70, v72
    v_accvgpr_write_b32 a148, v72
    v_accvgpr_read_b32 v73, a149
    v_mul_f32 v73, v70, v73
    v_accvgpr_write_b32 a149, v73
    v_accvgpr_read_b32 v74, a150
    v_mul_f32 v74, v70, v74
    v_accvgpr_write_b32 a150, v74
    v_accvgpr_read_b32 v75, a151
    v_mul_f32 v75, v70, v75
    v_accvgpr_write_b32 a151, v75
    v_accvgpr_read_b32 v72, a152
    v_mul_f32 v72, v70, v72
    v_accvgpr_write_b32 a152, v72
    v_accvgpr_read_b32 v73, a153
    v_mul_f32 v73, v70, v73
    v_accvgpr_write_b32 a153, v73
    v_accvgpr_read_b32 v74, a154
    v_mul_f32 v74, v70, v74
    v_accvgpr_write_b32 a154, v74
    v_accvgpr_read_b32 v75, a155
    v_mul_f32 v75, v70, v75
    v_accvgpr_write_b32 a155, v75
    v_accvgpr_read_b32 v72, a156
    v_mul_f32 v72, v70, v72
    v_accvgpr_write_b32 a156, v72
    v_accvgpr_read_b32 v73, a157
    v_mul_f32 v73, v70, v73
    v_accvgpr_write_b32 a157, v73
    v_accvgpr_read_b32 v74, a158
    v_mul_f32 v74, v70, v74
    v_accvgpr_write_b32 a158, v74
    v_accvgpr_read_b32 v75, a159
    v_mul_f32 v75, v70, v75
    v_accvgpr_write_b32 a159, v75
    s_nop 3
    s_branch L_ret7
L_end:
    s_endpgm
.section .rodata,"a"
.p2align 6
.amdhsa_kernel standalone__gqa_softmax__near_ridge_kernel
  .amdhsa_next_free_vgpr 512
  .amdhsa_next_free_sgpr 72
  .amdhsa_accum_offset 256
  .amdhsa_group_segment_fixed_size 0
  .amdhsa_kernarg_size 48
  .amdhsa_user_sgpr_count 2
  .amdhsa_user_sgpr_kernarg_segment_ptr 1
  .amdhsa_system_sgpr_workgroup_id_x 1
.end_amdhsa_kernel
```
